```python
import torch

def _softmax(x, axis=-1):
    return torch.softmax(x, dim=axis)
def _gelu(x):
    return torch.nn.functional.gelu(x, approximate="tanh")
def _silu(x):
    return torch.nn.functional.silu(x)
def _sigmoid(x):
    return torch.sigmoid(x)
def _layernorm(x, axis=-1, eps=1e-5):
    m = x.mean(dim=axis, keepdim=True)
    v = x.var(dim=axis, keepdim=True, unbiased=False)
    return (x - m) / torch.sqrt(v + eps)
def _scatter_add(tgt, idx, src, axis=0):
    return tgt.clone().index_add_(axis, idx, src)
def _segment_sum(src, seg, n):
    out = torch.zeros((n,) + src.shape[1:], dtype=src.dtype)
    return out.index_add_(0, seg, src)
def _pad(x, pw):
    flat = tuple(v for pair in reversed(pw) for v in pair)
    return torch.nn.functional.pad(x, flat)

kernel_name = 'interleave_layers__sliding_local_dilated__glu_gated_glu__prompt'

def setup_inputs():

    _w = (lambda a: (lambda t: t.to(torch.bfloat16) if t.is_floating_point() else t)(torch.as_tensor(a)))
    def _A_setup():
        B, S, D = 1, 2048, 640
        return {
            "x": _w((lambda *s: torch.randn(*s, dtype=torch.bfloat16) * 0.05)(B, S, D)),
            "wqkv": _w((lambda *s: torch.randn(*s, dtype=torch.bfloat16) * 0.05)(D, 3 * D)),
            "wo": _w((lambda *s: torch.randn(*s, dtype=torch.bfloat16) * 0.05)(D, D)),
        }
    _A_in = _A_setup()

    def _B_setup():
        B, S, D, F = 1, 2048, 640, 1536
        return {
            "x": _w((lambda *s: torch.randn(*s, dtype=torch.bfloat16) * 0.05)(B, S, D)),
            "w_gate": _w((lambda *s: torch.randn(*s, dtype=torch.bfloat16) * 0.05)(D, F)),
            "w_up": _w((lambda *s: torch.randn(*s, dtype=torch.bfloat16) * 0.05)(D, F)),
            "w_down": _w((lambda *s: torch.randn(*s, dtype=torch.bfloat16) * 0.05)(F, D)),
        }
    _B_in = _B_setup()

    return {
        "A_x": _A_in["x"],
        "A_wqkv": _A_in["wqkv"],
        "A_wo": _A_in["wo"],
        "B_x": _B_in["x"],
        "B_w_gate": _B_in["w_gate"],
        "B_w_up": _B_in["w_up"],
        "B_w_down": _B_in["w_down"],
    }

def reference(A_x, A_wqkv, A_wo, B_x, B_w_gate, B_w_up, B_w_down):
    def _A_ref(x, wqkv, wo):
        B, S, D = x.shape
        H = 32; Dh = D // H
        W, dil = 8, 2
        qkv = (lambda x, *d: x.permute(*d))((x @ wqkv).reshape(B, S, 3, H, Dh), 2, 0, 3, 1, 4)
        q, k, v = qkv[0], qkv[1], qkv[2]
        scale = Dh ** -0.5
        pos = torch.arange(S)
        off = torch.arange(W) * dil
        idx = pos[:, None] - off[None, :]
        mask = idx >= 0
        idx_c = torch.where(mask, idx, 0).reshape(-1)
        kg = k[:, :, idx_c, :].reshape(B, H, S, W, Dh)
        vg = v[:, :, idx_c, :].reshape(B, H, S, W, Dh)
        logits = torch.einsum("bhsd,bhswd->bhsw", q, kg) * scale
        logits = torch.where(mask[None, None, :, :], logits, -1e9)
        attn = _softmax(logits, axis=-1)
        o = torch.einsum("bhsw,bhswd->bhsd", attn, vg)
        return (lambda x, *d: x.permute(*d))(o, 0, 2, 1, 3).reshape(B, S, D) @ wo

    def _B_ref(x, w_gate, w_up, w_down):
        g = torch.einsum("bsd,df->bsf", x, w_gate)
        u = torch.einsum("bsd,df->bsf", x, w_up)
        h = _sigmoid(g) * u
        return torch.einsum("bsf,fd->bsd", h, w_down)

    x = A_x
    x = x + _A_ref(_layernorm(x, axis=-1), A_wqkv, A_wo)
    x = x + _B_ref(_layernorm(x, axis=-1), B_w_gate, B_w_up, B_w_down)
    x = x + _A_ref(_layernorm(x, axis=-1), A_wqkv, A_wo)
    x = x + _B_ref(_layernorm(x, axis=-1), B_w_gate, B_w_up, B_w_down)
    return x
```

```asm
; @launch grid=(256,1,1) block=(256,1,1) lds=163840
.amdgcn_target "amdgcn-amd-amdhsa--gfx950"
.text
.globl interleave_layers__sliding_local_dilated__glu_gated_glu__prompt_kernel
.p2align 8
.type interleave_layers__sliding_local_dilated__glu_gated_glu__prompt_kernel,@function
interleave_layers__sliding_local_dilated__glu_gated_glu__prompt_kernel:
s_cmp_lt_u32 s2, 256
s_cbranch_scc1 K0_go
s_endpgm
K0_go:
s_load_dwordx4 s[80:83], s[0:1], 0
s_load_dwordx4 s[16:19], s[0:1], 64
s_load_dwordx2 s[8:9], s[0:1], 16
s_load_dwordx4 s[12:15], s[0:1], 32
s_load_dwordx2 s[10:11], s[0:1], 48
s_memrealtime s[90:91]
s_getpc_b64 s[86:87]
M_pc:
v_lshrrev_b32 v250, 6, v0
s_lshr_b32 s50, s2, 3
s_lshl_b32 s50, s50, 2
v_add_u32 v250, s50, v250
v_and_b32 v251, 3, v0
v_lshl_add_u32 v250, v250, 2, v251
v_lshlrev_b32 v250, 7, v250
v_min_u32 v250, M_last-M_pc-4, v250
global_load_dword v251, v250, s[86:87]
v_lshrrev_b32 v181, 6, v0
v_and_b32 v180, 63, v0
s_nop 0
v_readfirstlane_b32 s96, v181
v_lshlrev_b32 v182, 4, v180
v_lshrrev_b32 v183, 4, v180
v_and_b32 v184, 15, v180
v_lshrrev_b32 v185, 2, v184
v_and_b32 v186, 3, v184
s_lshr_b32 s56, s2, 1
s_and_b32 s57, s2, 1
s_lshl_b32 s58, s56, 4
s_lshl_b32 s59, s96, 2
s_add_u32 s58, s58, s59
s_and_b32 s59, s58, 1023
s_lshr_b32 s58, s58, 10
s_lshl_b32 s59, s59, 1
s_add_u32 s58, s58, s59
s_mul_i32 s58, s58, 1280
s_mul_i32 s60, s57, 640
s_add_u32 s60, s60, s58
v_mul_u32_u24 v188, 2560, v183
v_lshl_add_u32 v188, v184, 4, v188
v_lshrrev_b32 v189, 3, v180
v_and_b32 v189, 3, v189
v_and_b32 v190, 7, v180
v_lshlrev_b32 v190, 4, v190
v_mul_u32_u24 v191, 656, v189
v_mul_u32_u24 v189, 2560, v189
v_add_u32 v189, v189, v190
v_add_u32 v223, v191, v190
s_lshr_b32 s41, s96, 1
s_and_b32 s42, s96, 1
s_mul_i32 s59, s57, 10
s_add_u32 s59, s59, s96
s_min_u32 s76, s2, 239
s_mul_i32 s72, s76, 171
s_lshr_b32 s72, s72, 11
s_mul_i32 s73, s72, 12
s_sub_u32 s73, s76, s73
s_and_b32 s74, s73, 3
s_lshr_b32 s73, s73, 2
s_mul_i32 s50, s72, 13
s_lshr_b32 s50, s50, 6
s_mul_i32 s50, s50, 5
s_sub_u32 s50, s72, s50
s_lshl_b32 s36, s96, 3
s_lshl_b32 s51, s42, 2
s_add_u32 s51, s51, s41
s_lshl_b32 s51, s51, 2
s_movk_i32 s37, 15360
s_cmp_eq_u32 s50, 2
s_cselect_b32 s36, s51, s36
s_cselect_b32 s37, 30720, s37
s_lshl_b32 s50, s72, 5
s_add_u32 s36, s36, s50
s_mul_i32 s36, s36, 3840
s_mul_i32 s50, s73, 1280
s_add_u32 s36, s36, s50
s_mul_i32 s50, s74, 320
s_add_u32 s36, s36, s50
s_add_u32 s38, s36, s37
v_mul_u32_u24 v210, 3840, v183
v_lshl_add_u32 v210, v184, 4, v210
v_lshrrev_b32 v211, 2, v180
v_and_b32 v211, 3, v211
v_mul_u32_u24 v211, 3840, v211
v_lshl_add_u32 v211, v186, 4, v211
v_and_b32 v212, 1, v183
v_mul_lo_u32 v212, v212, s37
v_add3_u32 v211, v211, v212, 64
v_add_u32 v211, 192, v211
s_nop 0
s_mov_b32 s98, 0
s_mov_b32 s22, 0
s_mov_b32 s97, 0
s_mov_b32 s44, 1280
s_mov_b32 s45, 0
s_mov_b32 s46, 4
s_mov_b32 s47, 0
s_mov_b32 s100, 0
s_mov_b32 s99, 0
s_cmp_ge_u32 s2, 188
s_cbranch_scc1 K0_load
s_cmp_ge_u32 s2, 140
s_cbranch_scc1 K0_t4
s_cmp_ge_u32 s2, 20
s_cbranch_scc1 K0_t3
s_mov_b32 s97, s2
s_mov_b32 s22, 819200
s_mov_b32 s98, 2
s_cmp_ge_u32 s97, 16
s_cbranch_scc1 K0_t2x
s_mul_i32 s45, s97, 40
s_mul_i32 s50, s41, 20
s_add_u32 s45, s45, s50
s_lshl_b32 s50, s42, 3
s_add_u32 s45, s45, s50
s_branch K0_load
K0_t2x:
s_sub_u32 s50, s97, 16
s_lshl_b32 s50, s50, 3
s_lshl_b32 s51, s42, 2
s_add_u32 s50, s50, s51
s_add_u32 s50, s50, s41
s_mul_i32 s45, s50, 20
s_add_u32 s45, s45, 16
s_mov_b32 s46, 40
s_branch K0_load
K0_t4:
s_sub_u32 s97, s2, 140
s_mov_b32 s22, 1966080
s_mov_b32 s98, 4
s_lshl_b32 s45, s97, 5
s_lshl_b32 s50, s96, 3
s_add_u32 s45, s45, s50
s_branch K0_load
K0_t3:
s_sub_u32 s50, s2, 20
s_cmp_ge_u32 s50, 60
s_cselect_b32 s100, 1, 0
s_cselect_b32 s51, 60, 0
s_sub_u32 s50, s50, s51
s_mul_i32 s97, s50, 43
s_lshr_b32 s97, s97, 7
s_mul_i32 s99, s97, 3
s_sub_u32 s99, s50, s99
s_mov_b32 s22, 1966080
s_mov_b32 s44, 3072
s_lshl_b32 s47, s99, 10
s_mov_b32 s98, 3
s_mul_i32 s50, s97, 13
s_lshr_b32 s50, s50, 6
s_mul_i32 s50, s50, 5
s_sub_u32 s50, s97, s50
s_lshl_b32 s45, s96, 3
s_lshl_b32 s51, s42, 2
s_add_u32 s51, s51, s41
s_lshl_b32 s51, s51, 2
s_cmp_eq_u32 s50, 2
s_cselect_b32 s45, s51, s45
s_cselect_b32 s46, 8, 4
s_lshl_b32 s50, s97, 5
s_add_u32 s45, s45, s50
K0_load:
s_mul_i32 s53, s45, s44
s_add_u32 s53, s53, s47
s_mul_i32 s54, s46, s44
s_add_u32 s54, s54, s53
s_mov_b32 s55, s53
s_waitcnt lgkmcnt(0)
s_mov_b32 s24, s80
s_mov_b32 s25, s81
s_mov_b32 s26, 2621440
s_mov_b32 s27, 0x20000
s_mov_b32 s32, s82
s_mov_b32 s33, s83
s_mov_b32 s34, 2457600
s_mov_b32 s35, 0x20000
s_nop 0
s_mov_b32 s92, s16
s_mov_b32 s93, s17
s_mov_b32 s94, 256
s_mov_b32 s95, 0x20000
s_lshl_b32 s89, s90, 4
s_or_b32 s89, s89, 16
v_mov_b32 v213, s89
s_mov_b32 s91, s89
s_add_u32 s50, s2, s96
s_cmp_lg_u32 s50, 0
s_cbranch_scc1 K0_nn
s_mov_b64 exec, 1
buffer_store_dword v213, off, s[92:95], 0 sc1
s_mov_b64 exec, -1
K0_nn:
buffer_load_dwordx4 v[228:231], v210, s[32:35], s36 offen nt
buffer_load_dwordx4 v[232:235], v210, s[32:35], s38 offen nt
buffer_load_dwordx4 v[236:239], v211, s[32:35], s36 offen nt
buffer_load_dwordx4 v[196:199], v188, s[24:27], s60 offen nt
buffer_load_dwordx4 v[200:203], v188, s[24:27], s60 offen offset:256 nt
buffer_load_dwordx4 v[204:207], v189, s[24:27], s60 offen offset:512 nt
s_add_u32 s4, s18, 0
s_addc_u32 s5, s19, 0
s_mov_b32 s6, 26214400
s_mov_b32 s7, 0x20000
s_mov_b32 s23, 0x20000
s_mul_i32 s61, s96, 2816
s_add_u32 s61, s61, 45056
v_mul_u32_u24 v215, 352, v183
v_lshl_add_u32 v215, v184, 4, v215
v_add_u32 v215, s61, v215
v_lshrrev_b32 v216, 2, v180
v_and_b32 v216, 7, v216
v_mul_u32_u24 v216, 352, v216
v_lshl_add_u32 v216, v186, 4, v216
v_add_u32 v216, s61, v216
v_lshl_add_u32 v194, v183, 2, v185
v_mul_u32_u24 v217, 352, v194
s_mul_i32 s61, s96, 80
s_add_u32 s61, s61, 45056
v_add_u32 v217, s61, v217
v_and_b32 v218, 1, v186
v_mul_u32_u24 v218, 40, v218
v_add_u32 v218, v218, v217
v_lshl_add_u32 v217, v186, 3, v217
s_mul_i32 s61, s96, 10496
v_add_u32 v190, s61, v182
v_mul_u32_u24 v191, 1312, v183
v_lshl_add_u32 v191, v184, 4, v191
v_add_u32 v191, s61, v191
v_add_u32 v191, 1024, v191
v_mov_b32 v240, 0x3f803f80
v_mov_b32 v241, v240
v_mov_b32 v242, v240
v_mov_b32 v243, v240
s_cmp_eq_u32 s73, 1
s_cselect_b32 s61, 2, 0
s_cselect_b32 s66, 8, 0
s_cmp_eq_u32 s73, 2
s_cselect_b32 s61, 5, s61
s_cselect_b32 s62, 7, 4
s_lshl_b32 s63, s74, 2
s_add_u32 s63, s63, s96
s_mul_i32 s64, s63, 163840
s_lshl_b32 s65, s72, 13
s_add_u32 s64, s64, s65
s_add_u32 s64, s64, 11534336
s_lshl_b32 s65, s61, 10
s_add_u32 s65, s65, s64
s_lshl_b32 s67, s62, 10
s_add_u32 s67, s67, s64
s_lshl_b32 s68, s66, 4
s_add_u32 s67, s67, s68
s_mul_i32 s69, s63, 25600
s_mul_i32 s70, s72, 1280
s_add_u32 s69, s69, s70
s_add_u32 s69, s69, 21233664
s_lshl_b32 s70, s61, 6
s_add_u32 s70, s70, s69
s_lshl_b32 s71, s62, 4
s_add_u32 s71, s71, s66
s_lshl_b32 s71, s71, 2
s_add_u32 s71, s71, s69
v_lshlrev_b32 v219, 2, v184
s_mul_i32 s61, s56, 20480
s_lshl_b32 s62, s59, 10
s_add_u32 s61, s61, s62
s_add_u32 s61, s61, 0
s_nop 0
s_mul_i32 s50, s96, 2624
s_add_u32 s50, s50, 57344
v_mul_u32_u24 v222, 656, v183
v_lshl_add_u32 v222, v184, 4, v222
v_add_u32 v222, s50, v222
v_add_u32 v223, s50, v223
v_mul_u32_u24 v226, 656, v184
s_lshl_b32 s50, s96, 6
s_add_u32 s50, s50, 57344
v_add_u32 v226, s50, v226
s_cmp_eq_u32 s96, 2
s_cselect_b32 s50, 16, 8
s_cselect_b32 s51, 8, 32
v_mad_u32_u24 v224, v183, s50, v226
v_add_u32 v227, s51, v224
s_cmp_eq_u32 s96, 3
s_cselect_b32 s50, 16, 8
s_cselect_b32 s51, 8, 32
v_mad_u32_u24 v225, v183, s50, v226
v_add_u32 v221, s51, v225
v_lshl_add_u32 v226, v183, 3, v226
s_waitcnt vmcnt(5)
ds_write_b128 v215, v[228:231]
s_waitcnt vmcnt(4)
ds_write_b128 v215, v[232:235] offset:1408
s_waitcnt vmcnt(3)
ds_write_b128 v216, v[236:239] offset:256
s_waitcnt vmcnt(2)
ds_write_b128 v222, v[196:199]
s_waitcnt vmcnt(1)
ds_write_b128 v222, v[200:203] offset:256
s_waitcnt vmcnt(0)
ds_write_b128 v223, v[204:207] offset:512
s_waitcnt lgkmcnt(0)
s_barrier
ds_read_b64 v[196:197], v224
ds_read_b64 v[198:199], v227
ds_read_b64 v[200:201], v225 offset:256
ds_read_b64 v[202:203], v221 offset:256
ds_read_b64 v[204:205], v226 offset:512
ds_read_b64 v[206:207], v226 offset:544
ds_read_b64_tr_b16 v[32:33], v217 offset:0
ds_read_b64_tr_b16 v[34:35], v217 offset:5632
ds_read_b64_tr_b16 v[36:37], v217 offset:40
ds_read_b64_tr_b16 v[38:39], v217 offset:5672
ds_read_b64_tr_b16 v[40:41], v218 offset:32
ds_read_b64_tr_b16 v[42:43], v218 offset:5664
s_waitcnt lgkmcnt(6)
buffer_store_dwordx4 v[196:199], v182, s[4:7], s61 offen sc1
s_add_u32 s61, s61, 4096
buffer_store_dwordx4 v[200:203], v182, s[4:7], s61 offen sc1
s_add_u32 s61, s61, 4096
s_cmp_ge_u32 s96, 2
s_cbranch_scc1 K0_x4
buffer_store_dwordx4 v[204:207], v182, s[4:7], s61 offen sc1
K0_x4:
s_cmp_ge_u32 s96, 2
s_cselect_b64 vcc, 0, -1
v_cndmask_b32 v204, 0, v204, vcc
v_cndmask_b32 v205, 0, v205, vcc
v_cndmask_b32 v206, 0, v206, vcc
v_cndmask_b32 v207, 0, v207, vcc
v_mov_b32 v192, 0
v_mov_b32 v193, 0
v_dot2_f32_bf16 v192, v196, v240, v192
v_dot2_f32_bf16 v193, v196, v196, v193
v_dot2_f32_bf16 v192, v197, v240, v192
v_dot2_f32_bf16 v193, v197, v197, v193
v_dot2_f32_bf16 v192, v198, v240, v192
v_dot2_f32_bf16 v193, v198, v198, v193
v_dot2_f32_bf16 v192, v199, v240, v192
v_dot2_f32_bf16 v193, v199, v199, v193
v_dot2_f32_bf16 v192, v200, v240, v192
v_dot2_f32_bf16 v193, v200, v200, v193
v_dot2_f32_bf16 v192, v201, v240, v192
v_dot2_f32_bf16 v193, v201, v201, v193
v_dot2_f32_bf16 v192, v202, v240, v192
v_dot2_f32_bf16 v193, v202, v202, v193
v_dot2_f32_bf16 v192, v203, v240, v192
v_dot2_f32_bf16 v193, v203, v203, v193
v_dot2_f32_bf16 v192, v204, v240, v192
v_dot2_f32_bf16 v193, v204, v204, v193
v_dot2_f32_bf16 v192, v205, v240, v192
v_dot2_f32_bf16 v193, v205, v205, v193
v_dot2_f32_bf16 v192, v206, v240, v192
v_dot2_f32_bf16 v193, v206, v206, v193
v_dot2_f32_bf16 v192, v207, v240, v192
v_dot2_f32_bf16 v193, v207, v207, v193
s_waitcnt lgkmcnt(0)
s_cmp_ge_u32 s2, 240
s_cbranch_scc1 K0_now1
buffer_store_dwordx4 v[32:35], v182, s[4:7], s65 offen sc1
buffer_store_dwordx4 v[36:39], v182, s[4:7], s65 offen offset:1024 sc1
v_cmp_gt_u32 vcc, 8, v184
s_nop 1
v_cndmask_b32 v40, 0, v40, vcc
v_cndmask_b32 v41, 0, v41, vcc
v_cndmask_b32 v42, 0, v42, vcc
v_cndmask_b32 v43, 0, v43, vcc
s_cmp_eq_u32 s73, 2
s_cselect_b64 exec, -1, vcc
buffer_store_dwordx4 v[40:43], v182, s[4:7], s67 offen sc1
s_mov_b64 exec, -1
s_nop 3
v_mfma_f32_16x16x32_bf16 v[48:51], v[240:243], v[32:35], 0
v_mfma_f32_16x16x32_bf16 v[52:55], v[240:243], v[36:39], 0
v_mfma_f32_16x16x32_bf16 v[56:59], v[240:243], v[40:43], 0
s_nop 7
s_mov_b32 exec_lo, 0xffff
s_mov_b32 exec_hi, 0
buffer_store_dword v48, v219, s[4:7], s70 offen sc1
buffer_store_dword v52, v219, s[4:7], s70 offen offset:64 sc1
s_movk_i32 s50, 0xff
s_cmp_eq_u32 s73, 2
s_cselect_b32 exec_lo, 0xffff, s50
buffer_store_dword v56, v219, s[4:7], s71 offen sc1
s_mov_b64 exec, -1
K0_now1:
v_permlane16_swap_b32 v192, v193
v_add_f32 v192, v192, v193
v_mov_b32 v193, v192
s_nop 1
v_permlane32_swap_b32 v192, v193
v_add_f32 v192, v192, v193
v_mov_b32 v193, v192
s_nop 1
v_permlane16_swap_b32 v192, v193
s_lshl_b32 s62, s57, 2
s_add_u32 s62, s62, s96
s_lshl_b32 s62, s62, 7
s_lshl_b32 s61, s56, 10
s_add_u32 s61, s61, s62
s_add_u32 s61, s61, 21102592
v_lshlrev_b32 v195, 3, v180
s_mov_b32 exec_lo, 0xffff
s_mov_b32 exec_hi, 0
buffer_store_dwordx2 v[192:193], v195, s[4:7], s61 offen sc1
s_mov_b64 exec, -1
buffer_load_dword v214, off, s[92:95], 0 sc1
s_cmp_eq_u32 s100, 1
s_cselect_b32 s20, s14, s12
s_cselect_b32 s21, s15, s13
s_cmp_eq_u32 s98, 3
s_cselect_b32 s20, s20, s8
s_cselect_b32 s21, s21, s9
s_cmp_eq_u32 s98, 4
s_cselect_b32 s20, s10, s20
s_cselect_b32 s21, s11, s21
buffer_load_dwordx4 v[112:115], v182, s[20:23], s55 offen nt
s_add_u32 s55, s55, s44
buffer_load_dwordx4 v[116:119], v182, s[20:23], s55 offen nt
s_add_u32 s55, s55, s44
buffer_load_dwordx4 v[120:123], v182, s[20:23], s55 offen nt
s_add_u32 s55, s55, s44
buffer_load_dwordx4 v[124:127], v182, s[20:23], s55 offen nt
s_mov_b32 s55, s54
buffer_load_dwordx4 v[128:131], v182, s[20:23], s55 offen nt
s_add_u32 s55, s55, s44
buffer_load_dwordx4 v[132:135], v182, s[20:23], s55 offen nt
s_add_u32 s55, s55, s44
buffer_load_dwordx4 v[136:139], v182, s[20:23], s55 offen nt
s_add_u32 s55, s55, s44
buffer_load_dwordx4 v[140:143], v182, s[20:23], s55 offen nt
v_mul_lo_u32 v187, v183, s44
v_lshl_add_u32 v187, v184, 4, v187
v_add_u32 v187, 1024, v187
s_cmp_eq_u32 s98, 3
s_cselect_b32 s53, 0x1000000, s53
s_cselect_b32 s54, 0x1000000, s54
buffer_load_dwordx4 v[144:147], v187, s[20:23], s53 offen nt
buffer_load_dwordx4 v[148:151], v187, s[20:23], s54 offen nt
s_load_dwordx2 s[8:9], s[0:1], 56
v_lshrrev_b32 v1, 6, v0
v_and_b32 v3, 63, v0
v_readfirstlane_b32 s12, v1
v_lshlrev_b32 v0, 4, v3
v_add_u32 v1, 20480, v0
s_and_b32 s48, s2, 7
s_lshr_b32 s49, s2, 3
s_lshr_b32 s50, s49, 4
s_lshl_b32 s48, s48, 1
s_add_u32 s13, s48, s50
s_and_b32 s14, s49, 15
s_lshl_b32 s52, s13, 3
s_lshl_b32 s53, s12, 1
s_add_u32 s53, s53, s52
s_mul_i32 s16, s53, 20480
s_lshl_b32 s44, s12, 10
s_lshl_b32 s42, s12, 11
s_mul_i32 s35, s14, 163840
s_add_u32 s35, s35, 11534336
s_add_u32 s18, s35, s42
s_and_b32 s54, s13, 7
s_cmp_eq_u32 s54, 0
s_cselect_b32 s54, 0, 1
s_sub_u32 s55, s13, s54
s_lshl_b32 s17, s55, 4
s_add_u32 s17, s17, s14
s_lshl_b32 s17, s17, 12
s_add_u32 s17, s17, 24117248
v_add_u32 v4, 0x10000, v0
v_add_u32 v5, 0x20000, v0
s_mov_b32 s10, 2621440
s_mov_b32 s11, 0x20000
s_mov_b32 s45, 0x20000
s_lshl_b32 s33, s53, 10
s_add_u32 s33, s33, 21102592
s_mul_i32 s39, s53, 49152
s_mul_i32 s50, s14, 3072
s_add_u32 s39, s39, s50
s_add_u32 s39, s39, 5242880
s_lshl_b32 s50, s14, 10
s_add_u32 s37, s16, s50
s_add_u32 s37, s37, 2621440
s_lshr_b32 s50, s14, 2
s_lshl_b32 s50, s50, 10
s_and_b32 s48, s14, 3
s_lshl_b32 s48, s48, 8
s_add_u32 s50, s50, s48
s_add_u32 s38, s16, s50
s_add_u32 s38, s38, 2637824
s_mul_i32 s43, s12, 3072
s_lshl_b32 s85, s12, 12
s_sub_u32 s48, s12, 1
s_max_i32 s48, s48, 0
s_lshl_b32 s78, s48, 12
s_lshl_b32 s79, s48, 13
s_add_u32 s35, s35, s79
s_mul_i32 s36, s14, 245760
s_add_u32 s36, s36, 15204352
s_add_u32 s19, s36, s43
s_add_u32 s36, s36, s78
s_mul_i32 s84, s14, 25600
s_add_u32 s84, s84, 21233664
s_lshl_b32 s40, s13, 7
s_add_u32 s40, s40, 22413312
s_lshl_b32 s41, s13, 4
s_add_u32 s41, s41, s14
s_lshl_b32 s41, s41, 12
s_add_u32 s41, s41, 24117248
s_cmp_eq_u32 s12, 0
s_cselect_b32 s34, s54, 0
s_add_u32 s50, s54, s12
s_cmp_eq_u32 s50, 0
s_cselect_b32 s88, 1, 0
s_and_b32 s54, s14, 7
s_lshr_b32 s53, s14, 3
s_mul_i32 s20, s54, 102400
s_mul_i32 s50, s12, 25600
s_add_u32 s20, s20, s50
s_add_u32 s20, s20, 14155776
s_mul_i32 s21, s54, 245760
s_mul_i32 s50, s12, 61440
s_add_u32 s21, s21, s50
s_add_u32 s21, s21, 19136512
s_lshl_b32 s50, s53, 2
s_add_u32 s52, s52, s50
s_add_u32 s50, s12, 1
s_and_b32 s50, s50, 3
s_add_u32 s50, s50, s52
s_mul_i32 s22, s50, 20480
s_mul_i32 s48, s12, 5120
s_add_u32 s22, s22, s48
s_mul_i32 s26, s50, 49152
s_mul_i32 s48, s12, 12288
s_add_u32 s26, s26, s48
s_add_u32 s50, s12, 2
s_and_b32 s50, s50, 3
s_add_u32 s50, s50, s52
s_mul_i32 s23, s50, 20480
s_mul_i32 s48, s12, 5120
s_add_u32 s23, s23, s48
s_mul_i32 s27, s50, 49152
s_mul_i32 s48, s12, 12288
s_add_u32 s27, s27, s48
s_add_u32 s50, s12, 3
s_and_b32 s50, s50, 3
s_add_u32 s50, s50, s52
s_mul_i32 s24, s50, 20480
s_mul_i32 s48, s12, 5120
s_add_u32 s24, s24, s48
s_mul_i32 s28, s50, 49152
s_mul_i32 s48, s12, 12288
s_add_u32 s28, s28, s48
s_add_u32 s50, s12, 4
s_and_b32 s50, s50, 3
s_add_u32 s50, s50, s52
s_mul_i32 s25, s50, 20480
s_mul_i32 s48, s12, 5120
s_add_u32 s25, s25, s48
s_mul_i32 s29, s50, 49152
s_mul_i32 s48, s12, 12288
s_add_u32 s29, s29, s48
s_add_u32 s52, s52, s12
s_lshr_b32 s50, s54, 1
s_and_b32 s55, s54, 1
s_lshl_b32 s32, s52, 10
s_lshl_b32 s53, s54, 7
s_add_u32 s32, s32, s53
s_mul_i32 s31, s52, 20480
s_mul_i32 s50, s50, 5120
s_add_u32 s31, s31, s50
s_mul_i32 s50, s55, 3072
s_add_u32 s30, s31, s50
s_add_u32 s31, s31, 2048
s_lshl_b32 s53, s55, 9
s_add_u32 s31, s31, s53
s_and_b32 s50, s52, 63
s_lshl_b32 s50, s50, 5
s_lshr_b32 s53, s52, 6
s_add_u32 s50, s50, s53
s_mul_i32 s50, s50, 1280
s_mul_i32 s53, s54, 160
s_add_u32 s50, s50, s53
s_lshl_b32 s53, s55, 5
s_add_u32 s46, s50, s53
s_cmp_eq_u32 s55, 0
s_cselect_b32 s53, 128, 0
s_add_u32 s47, s50, s53
v_lshrrev_b32 v80, 4, v3
v_and_b32 v81, 15, v3
v_lshlrev_b32 v9, 2, v81
v_and_b32 v82, 1, v80
v_lshrrev_b32 v84, 1, v80
v_lshlrev_b32 v83, 8, v84
v_lshl_add_u32 v83, v81, 4, v83
v_lshl_add_u32 v11, v82, 3, v83
v_add_u32 v12, 49152, v0
v_lshlrev_b32 v13, 3, v81
v_lshl_add_u32 v13, v80, 8, v13
v_lshrrev_b32 v100, 8, v0
v_lshrrev_b32 v101, 2, v9
v_lshlrev_b32 v100, 2, v100
v_sub_u32 v100, v101, v100
v_mov_b32 v101, 0xf149f2ca
v_subrev_u32 v103, 0, v100
v_cmp_gt_u32 vcc, 8, v103
v_cmp_gt_i32 s[52:53], -8, v103
v_mov_b32 v102, 0x3f803f80
v_cndmask_b32_e64 v88, v101, 0, vcc
v_cndmask_b32_e64 v92, v101, 0, s[52:53]
v_subrev_u32 v103, 1, v100
v_cmp_gt_u32 vcc, 8, v103
v_cmp_gt_i32 s[52:53], -8, v103
v_lshlrev_b32 v110, 3, v0
v_cndmask_b32_e64 v89, v101, 0, vcc
v_cndmask_b32_e64 v93, v101, 0, s[52:53]
v_subrev_u32 v103, 2, v100
v_cmp_gt_u32 vcc, 8, v103
v_cmp_gt_i32 s[52:53], -8, v103
v_and_b32 v111, 0x380, v110
v_cndmask_b32_e64 v90, v101, 0, vcc
v_cndmask_b32_e64 v94, v101, 0, s[52:53]
v_subrev_u32 v103, 3, v100
v_cmp_gt_u32 vcc, 8, v103
v_cmp_gt_i32 s[52:53], -8, v103
v_and_b32 v110, 0x400, v110
v_cndmask_b32_e64 v91, v101, 0, vcc
v_cndmask_b32_e64 v95, v101, 0, s[52:53]
s_cmp_eq_u32 s88, 1
s_cselect_b64 vcc, -1, 0
v_cndmask_b32 v96, v92, v101, vcc
v_cndmask_b32 v97, v93, v101, vcc
v_cndmask_b32 v98, v94, v101, vcc
v_cndmask_b32 v99, v95, v101, vcc
v_mov_b32 v103, 0xffff
v_cmp_le_i32 vcc, 0, v100
v_cmp_le_i32 s[52:53], 1, v100
v_mov_b32 v104, 0
v_cndmask_b32 v104, v104, v103, vcc
v_cndmask_b32_e64 v104, v104, -1, s[52:53]
v_cmp_le_i32 vcc, 2, v100
v_cmp_le_i32 s[52:53], 3, v100
v_mov_b32 v105, 0
v_cndmask_b32 v105, v105, v103, vcc
v_cndmask_b32_e64 v105, v105, -1, s[52:53]
v_mul_u32_u24 v110, 20, v110
v_and_b32 v100, 0x80, v111
v_add_u32 v111, v110, v111
v_add_u32 v110, v110, v100
v_lshrrev_b32 v106, 8, v0
v_lshlrev_b32 v106, 4, v106
s_lshl_b32 s48, s12, 8
s_add_u32 s48, s48, 161024
v_add_u32 v109, s48, v106
v_and_b32 v108, 0x100, v0
v_lshrrev_b32 v108, 2, v108
v_add3_u32 v108, v108, v9, s48
v_add_u32 v106, 159744, v106
v_add_u32 v107, 159744, v9
v_lshrrev_b32 v100, 1, v0
s_add_u32 s48, s43, 126976
v_add_u32 v101, s48, v100
s_add_u32 s48, s12, 1
s_and_b32 s48, s48, 3
s_mul_i32 s48, s48, 3072
s_add_u32 s48, s48, 126976
v_add_u32 v100, s48, v100
s_mul_i32 s61, s72, 3
s_add_u32 s61, s61, s73
s_lshr_b32 s62, s61, 3
s_lshl_b32 s62, s62, 7
s_and_b32 s61, s61, 7
s_lshl_b32 s61, s61, 2
s_add_u32 s61, s61, s62
s_lshl_b32 s62, s74, 10
s_add_u32 s61, s61, s62
s_cmp_ge_u32 s2, 240
s_cselect_b32 s61, 4092, s61
s_lshr_b32 s62, s2, 3
s_lshl_b32 s62, s62, 7
s_and_b32 s63, s2, 7
s_lshl_b32 s63, s63, 2
s_add_u32 s62, s62, s63
s_add_u32 s62, s62, 4096
v_mov_b32 v220, s61
v_mov_b32 v222, s62
v_cmp_eq_u32 vcc, 0, v180
s_nop 1
v_cndmask_b32 v220, v222, v220, vcc
s_mov_b32 s77, 22511616
s_waitcnt vmcnt(10)
s_barrier
s_mov_b32 s101, 0x20000
K0_npz:
v_readfirstlane_b32 s89, v214
s_sub_u32 s55, s89, s91
s_add_u32 s55, s55, 32000
s_cmp_lt_u32 s55, 64000
s_cselect_b32 s55, 0, s101
s_cmp_lt_u32 s55, 130772
s_cselect_b32 s55, s89, 0
s_cmp_lg_u32 s55, 0
s_cbranch_scc1 K0_ndz
buffer_load_dword v214, off, s[92:95], 0 sc1
s_waitcnt vmcnt(0)
s_sub_u32 s101, s101, 1
s_cbranch_scc0 K0_npz
K0_ndz:
s_cmp_lg_u32 s96, 0
s_cbranch_scc1 K0_faz
s_mov_b64 exec, 3
buffer_store_dword v214, v220, s[4:7], s77 offen sc1
s_mov_b64 exec, -1
K0_faz:
s_waitcnt vmcnt(0)
ds_write_b128 v190, v[112:115] offset:0
ds_write_b128 v190, v[116:119] offset:1312
ds_write_b128 v190, v[120:123] offset:2624
ds_write_b128 v190, v[124:127] offset:3936
ds_write_b128 v190, v[128:131] offset:5248
ds_write_b128 v190, v[132:135] offset:6560
ds_write_b128 v190, v[136:139] offset:7872
ds_write_b128 v190, v[140:143] offset:9184
ds_write_b128 v191, v[144:147]
ds_write_b128 v191, v[148:151] offset:5248
s_waitcnt lgkmcnt(0)
s_barrier
s_cmp_eq_u32 s98, 0
s_cbranch_scc1 K0_b0
s_cmp_eq_u32 s98, 3
s_cbranch_scc1 K0_b3
v_mul_u32_u24 v194, 1312, v194
s_mul_i32 s61, s96, 320
v_add_u32 v195, s61, v194
v_lshl_add_u32 v194, v186, 3, v195
ds_read_b64_tr_b16 v[112:113], v194 offset:0
ds_read_b64_tr_b16 v[114:115], v194 offset:20992
ds_read_b64_tr_b16 v[116:117], v194 offset:32
ds_read_b64_tr_b16 v[118:119], v194 offset:21024
ds_read_b64_tr_b16 v[120:121], v194 offset:64
ds_read_b64_tr_b16 v[122:123], v194 offset:21056
ds_read_b64_tr_b16 v[124:125], v194 offset:96
ds_read_b64_tr_b16 v[126:127], v194 offset:21088
ds_read_b64_tr_b16 v[128:129], v194 offset:128
ds_read_b64_tr_b16 v[130:131], v194 offset:21120
ds_read_b64_tr_b16 v[132:133], v194 offset:160
ds_read_b64_tr_b16 v[134:135], v194 offset:21152
ds_read_b64_tr_b16 v[136:137], v194 offset:192
ds_read_b64_tr_b16 v[138:139], v194 offset:21184
ds_read_b64_tr_b16 v[140:141], v194 offset:224
ds_read_b64_tr_b16 v[142:143], v194 offset:21216
ds_read_b64_tr_b16 v[144:145], v194 offset:256
ds_read_b64_tr_b16 v[146:147], v194 offset:21248
ds_read_b64_tr_b16 v[148:149], v194 offset:288
ds_read_b64_tr_b16 v[150:151], v194 offset:21280
s_cmp_eq_u32 s98, 2
s_mov_b32 s62, 245760
s_mov_b32 s63, 19136512
s_cselect_b32 s62, 102400, s62
s_cselect_b32 s63, 14155776, s63
s_lshl_b32 s64, s96, 1
s_mul_i32 s64, s64, s62
s_add_u32 s63, s63, s64
s_mul_i32 s64, s97, 5120
s_add_u32 s63, s63, s64
s_add_u32 s64, s63, 4096
s_waitcnt lgkmcnt(15)
buffer_store_dwordx4 v[112:115], v182, s[4:7], s63 offen offset:0 sc1
buffer_store_dwordx4 v[116:119], v182, s[4:7], s63 offen offset:1024 sc1
s_waitcnt lgkmcnt(14)
buffer_store_dwordx4 v[120:123], v182, s[4:7], s63 offen offset:2048 sc1
s_waitcnt lgkmcnt(12)
buffer_store_dwordx4 v[124:127], v182, s[4:7], s63 offen offset:3072 sc1
s_waitcnt lgkmcnt(10)
buffer_store_dwordx4 v[128:131], v182, s[4:7], s64 offen sc1
s_add_u32 s63, s63, s62
s_add_u32 s64, s63, 4096
s_waitcnt lgkmcnt(8)
buffer_store_dwordx4 v[132:135], v182, s[4:7], s64 offen sc1
s_waitcnt lgkmcnt(6)
buffer_store_dwordx4 v[136:139], v182, s[4:7], s63 offen offset:0 sc1
s_waitcnt lgkmcnt(4)
buffer_store_dwordx4 v[140:143], v182, s[4:7], s63 offen offset:1024 sc1
s_waitcnt lgkmcnt(2)
buffer_store_dwordx4 v[144:147], v182, s[4:7], s63 offen offset:2048 sc1
s_waitcnt lgkmcnt(0)
buffer_store_dwordx4 v[148:151], v182, s[4:7], s63 offen offset:3072 sc1
s_branch K0_tail
K0_b3:
v_mul_u32_u24 v194, 1312, v194
v_lshl_add_u32 v194, v186, 3, v194
s_lshl_b32 s61, s96, 8
v_add_u32 v194, s61, v194
ds_read_b64_tr_b16 v[112:113], v194 offset:0
ds_read_b64_tr_b16 v[114:115], v194 offset:20992
ds_read_b64_tr_b16 v[116:117], v194 offset:32
ds_read_b64_tr_b16 v[118:119], v194 offset:21024
ds_read_b64_tr_b16 v[120:121], v194 offset:64
ds_read_b64_tr_b16 v[122:123], v194 offset:21056
ds_read_b64_tr_b16 v[124:125], v194 offset:96
ds_read_b64_tr_b16 v[126:127], v194 offset:21088
ds_read_b64_tr_b16 v[128:129], v194 offset:128
ds_read_b64_tr_b16 v[130:131], v194 offset:21120
ds_read_b64_tr_b16 v[132:133], v194 offset:160
ds_read_b64_tr_b16 v[134:135], v194 offset:21152
ds_read_b64_tr_b16 v[136:137], v194 offset:192
ds_read_b64_tr_b16 v[138:139], v194 offset:21184
ds_read_b64_tr_b16 v[140:141], v194 offset:224
ds_read_b64_tr_b16 v[142:143], v194 offset:21216
s_lshl_b32 s61, s99, 5
s_lshl_b32 s62, s96, 3
s_add_u32 s61, s61, s62
s_mul_i32 s65, s97, 12288
s_add_u32 s65, s65, 15204352
s_mul_i32 s66, s97, 1280
s_add_u32 s66, s66, 21234176
s_mul_i32 s62, s61, 43
s_lshr_b32 s62, s62, 8
s_mul_i32 s63, s62, 6
s_sub_u32 s63, s61, s63
s_lshl_b32 s63, s63, 1
s_add_u32 s63, s63, s100
s_mul_i32 s64, s62, 245760
s_add_u32 s64, s64, s65
s_lshl_b32 s67, s63, 10
s_add_u32 s64, s64, s67
s_mul_i32 s62, s62, 25600
s_lshl_b32 s63, s63, 6
s_add_u32 s62, s62, s63
s_add_u32 s68, s62, s66
s_add_u32 s61, s61, 1
s_waitcnt lgkmcnt(14)
buffer_store_dwordx4 v[112:115], v182, s[4:7], s64 offen sc1
v_mfma_f32_16x16x32_bf16 v[16:19], v[240:243], v[112:115], 0
s_mul_i32 s62, s61, 43
s_lshr_b32 s62, s62, 8
s_mul_i32 s63, s62, 6
s_sub_u32 s63, s61, s63
s_lshl_b32 s63, s63, 1
s_add_u32 s63, s63, s100
s_mul_i32 s64, s62, 245760
s_add_u32 s64, s64, s65
s_lshl_b32 s67, s63, 10
s_add_u32 s64, s64, s67
s_mul_i32 s62, s62, 25600
s_lshl_b32 s63, s63, 6
s_add_u32 s62, s62, s63
s_add_u32 s69, s62, s66
s_add_u32 s61, s61, 1
s_waitcnt lgkmcnt(12)
buffer_store_dwordx4 v[116:119], v182, s[4:7], s64 offen sc1
v_mfma_f32_16x16x32_bf16 v[20:23], v[240:243], v[116:119], 0
s_mul_i32 s62, s61, 43
s_lshr_b32 s62, s62, 8
s_mul_i32 s63, s62, 6
s_sub_u32 s63, s61, s63
s_lshl_b32 s63, s63, 1
s_add_u32 s63, s63, s100
s_mul_i32 s64, s62, 245760
s_add_u32 s64, s64, s65
s_lshl_b32 s67, s63, 10
s_add_u32 s64, s64, s67
s_mul_i32 s62, s62, 25600
s_lshl_b32 s63, s63, 6
s_add_u32 s62, s62, s63
s_add_u32 s70, s62, s66
s_add_u32 s61, s61, 1
s_waitcnt lgkmcnt(10)
buffer_store_dwordx4 v[120:123], v182, s[4:7], s64 offen sc1
v_mfma_f32_16x16x32_bf16 v[24:27], v[240:243], v[120:123], 0
s_mul_i32 s62, s61, 43
s_lshr_b32 s62, s62, 8
s_mul_i32 s63, s62, 6
s_sub_u32 s63, s61, s63
s_lshl_b32 s63, s63, 1
s_add_u32 s63, s63, s100
s_mul_i32 s64, s62, 245760
s_add_u32 s64, s64, s65
s_lshl_b32 s67, s63, 10
s_add_u32 s64, s64, s67
s_mul_i32 s62, s62, 25600
s_lshl_b32 s63, s63, 6
s_add_u32 s62, s62, s63
s_add_u32 s71, s62, s66
s_add_u32 s61, s61, 1
s_waitcnt lgkmcnt(8)
buffer_store_dwordx4 v[124:127], v182, s[4:7], s64 offen sc1
v_mfma_f32_16x16x32_bf16 v[28:31], v[240:243], v[124:127], 0
s_mul_i32 s62, s61, 43
s_lshr_b32 s62, s62, 8
s_mul_i32 s63, s62, 6
s_sub_u32 s63, s61, s63
s_lshl_b32 s63, s63, 1
s_add_u32 s63, s63, s100
s_mul_i32 s64, s62, 245760
s_add_u32 s64, s64, s65
s_lshl_b32 s67, s63, 10
s_add_u32 s64, s64, s67
s_mul_i32 s62, s62, 25600
s_lshl_b32 s63, s63, 6
s_add_u32 s62, s62, s63
s_add_u32 s72, s62, s66
s_add_u32 s61, s61, 1
s_waitcnt lgkmcnt(6)
buffer_store_dwordx4 v[128:131], v182, s[4:7], s64 offen sc1
v_mfma_f32_16x16x32_bf16 v[32:35], v[240:243], v[128:131], 0
s_mul_i32 s62, s61, 43
s_lshr_b32 s62, s62, 8
s_mul_i32 s63, s62, 6
s_sub_u32 s63, s61, s63
s_lshl_b32 s63, s63, 1
s_add_u32 s63, s63, s100
s_mul_i32 s64, s62, 245760
s_add_u32 s64, s64, s65
s_lshl_b32 s67, s63, 10
s_add_u32 s64, s64, s67
s_mul_i32 s62, s62, 25600
s_lshl_b32 s63, s63, 6
s_add_u32 s62, s62, s63
s_add_u32 s73, s62, s66
s_add_u32 s61, s61, 1
s_waitcnt lgkmcnt(4)
buffer_store_dwordx4 v[132:135], v182, s[4:7], s64 offen sc1
v_mfma_f32_16x16x32_bf16 v[36:39], v[240:243], v[132:135], 0
s_mul_i32 s62, s61, 43
s_lshr_b32 s62, s62, 8
s_mul_i32 s63, s62, 6
s_sub_u32 s63, s61, s63
s_lshl_b32 s63, s63, 1
s_add_u32 s63, s63, s100
s_mul_i32 s64, s62, 245760
s_add_u32 s64, s64, s65
s_lshl_b32 s67, s63, 10
s_add_u32 s64, s64, s67
s_mul_i32 s62, s62, 25600
s_lshl_b32 s63, s63, 6
s_add_u32 s62, s62, s63
s_add_u32 s74, s62, s66
s_add_u32 s61, s61, 1
s_waitcnt lgkmcnt(2)
buffer_store_dwordx4 v[136:139], v182, s[4:7], s64 offen sc1
v_mfma_f32_16x16x32_bf16 v[40:43], v[240:243], v[136:139], 0
s_mul_i32 s62, s61, 43
s_lshr_b32 s62, s62, 8
s_mul_i32 s63, s62, 6
s_sub_u32 s63, s61, s63
s_lshl_b32 s63, s63, 1
s_add_u32 s63, s63, s100
s_mul_i32 s64, s62, 245760
s_add_u32 s64, s64, s65
s_lshl_b32 s67, s63, 10
s_add_u32 s64, s64, s67
s_mul_i32 s62, s62, 25600
s_lshl_b32 s63, s63, 6
s_add_u32 s62, s62, s63
s_add_u32 s75, s62, s66
s_add_u32 s61, s61, 1
s_waitcnt lgkmcnt(0)
buffer_store_dwordx4 v[140:143], v182, s[4:7], s64 offen sc1
v_mfma_f32_16x16x32_bf16 v[44:47], v[240:243], v[140:143], 0
v_cmp_eq_u32 vcc, 1, v183
v_cmp_eq_u32 s[62:63], 2, v183
v_cmp_eq_u32 s[64:65], 3, v183
v_mov_b32 v196, s68
v_mov_b32 v197, s69
v_mov_b32 v198, s70
v_mov_b32 v199, s71
v_cndmask_b32 v196, v196, v197, vcc
v_cndmask_b32 v196, v196, v198, s[62:63]
v_cndmask_b32 v196, v196, v199, s[64:65]
v_add_u32 v200, v196, v219
v_cndmask_b32 v16, v16, v20, vcc
v_cndmask_b32 v16, v16, v24, s[62:63]
v_cndmask_b32 v16, v16, v28, s[64:65]
buffer_store_dword v16, v200, s[4:7], 0 offen sc1
v_mov_b32 v196, s72
v_mov_b32 v197, s73
v_mov_b32 v198, s74
v_mov_b32 v199, s75
v_cndmask_b32 v196, v196, v197, vcc
v_cndmask_b32 v196, v196, v198, s[62:63]
v_cndmask_b32 v196, v196, v199, s[64:65]
v_add_u32 v201, v196, v219
v_cndmask_b32 v32, v32, v36, vcc
v_cndmask_b32 v32, v32, v40, s[62:63]
v_cndmask_b32 v32, v32, v44, s[64:65]
buffer_store_dword v32, v201, s[4:7], 0 offen sc1
s_branch K0_tail
K0_b0:
K0_tail:
s_waitcnt lgkmcnt(0)
M_go:
v_lshrrev_b32 v80, 8, v0
v_lshrrev_b32 v81, 2, v9
v_mov_b32 v10, s89
v_cmp_eq_u32 s[56:57], 0, v80
v_cmp_eq_u32 s[58:59], 1, v80
v_cmp_gt_u32 s[60:61], 2, v80
v_cmp_lt_u32 s[62:63], 7, v81
v_and_b32 v80, 1, v80
v_cmp_eq_u32 s[66:67], 1, v80
v_lshrrev_b32 v17, 4, v0
v_lshrrev_b32 v18, 2, v17
v_lshlrev_b32 v18, 7, v18
v_and_b32 v19, 3, v17
v_lshl_add_u32 v18, v19, 3, v18
s_lshr_b32 s50, s14, 2
s_lshl_b32 s50, s50, 10
s_lshl_b32 s51, s13, 8
s_add_u32 s51, s51, 3072
v_add_u32 v19, s51, v18
v_add_u32 v18, s50, v18
v_mov_b32 v20, s50
v_cmp_gt_u32 vcc, 30, v17
s_nop 1
v_cndmask_b32 v18, v20, v18, vcc
v_and_b32 v20, 56, v17
v_cmp_eq_u32 vcc, 32, v20
s_nop 1
v_cndmask_b32 v18, v18, v19, vcc
s_mov_b32 s51, 22511616
s_getreg_b32 s50, hwreg(HW_REG_XCC_ID)
s_and_b32 s50, s50, 15
s_or_b32 s50, s50, s89
v_mov_b32 v16, s50
s_lshl_b32 s48, s13, 4
s_add_u32 s48, s48, s14
s_lshl_b32 s48, s48, 7
s_add_u32 s48, s48, 22446080
s_cmp_lg_u32 s12, 0
s_cbranch_scc1 M_pw2
M_pw1:
buffer_load_dwordx2 v[20:21], v18, s[4:7], s51 offen sc1
s_waitcnt vmcnt(0)
v_cmp_ne_u32 vcc, s89, v20
v_cmp_ne_u32 s[52:53], s89, v21
s_nop 1
s_or_b64 vcc, vcc, s[52:53]
s_cbranch_scc0 M_pw2
s_sub_u32 s45, s45, 1
s_cbranch_scc0 M_pw1
s_mov_b32 s45, 0
M_pw2:
s_waitcnt vmcnt(0)
s_barrier
s_cmp_lg_u32 s12, 0
s_cbranch_scc1 M_reg
s_mov_b64 exec, 1
buffer_store_dword v16, off, s[4:7], s48 sc1
s_lshl_b32 s50, s2, 2
s_add_u32 s50, s50, 22519808
buffer_store_dword v10, off, s[4:7], s50 sc1
s_mov_b64 exec, -1
M_reg:
s_add_u32 m0, s42, 0
s_add_u32 s49, s18, 0
buffer_load_dwordx4 v0, s[4:7], s49 offen offset:0 sc1 lds
buffer_load_dwordx4 v0, s[4:7], s49 offen offset:1024 sc1 lds
s_add_u32 m0, s42, 8192
s_add_u32 s49, s18, 8192
buffer_load_dwordx4 v0, s[4:7], s49 offen offset:0 sc1 lds
buffer_load_dwordx4 v0, s[4:7], s49 offen offset:1024 sc1 lds
s_add_u32 s51, s16, 0
buffer_load_dwordx4 v[180:183], v0, s[4:7], s51 offen offset:0 sc1
buffer_load_dwordx4 v[184:187], v1, s[4:7], s51 offen offset:0 sc1
s_add_u32 m0, s42, 16384
s_add_u32 s49, s18, 16384
buffer_load_dwordx4 v0, s[4:7], s49 offen offset:0 sc1 lds
buffer_load_dwordx4 v0, s[4:7], s49 offen offset:1024 sc1 lds
s_add_u32 m0, s42, 24576
s_add_u32 s49, s18, 24576
buffer_load_dwordx4 v0, s[4:7], s49 offen offset:0 sc1 lds
buffer_load_dwordx4 v0, s[4:7], s49 offen offset:1024 sc1 lds
buffer_load_dwordx4 v[188:191], v0, s[4:7], s51 offen offset:1024 sc1
buffer_load_dwordx4 v[192:195], v1, s[4:7], s51 offen offset:1024 sc1
buffer_load_dwordx4 v[196:199], v0, s[4:7], s51 offen offset:2048 sc1
buffer_load_dwordx4 v[200:203], v1, s[4:7], s51 offen offset:2048 sc1
s_add_u32 m0, s42, 32768
s_add_u32 s49, s18, 32768
buffer_load_dwordx4 v0, s[4:7], s49 offen offset:0 sc1 lds
buffer_load_dwordx4 v0, s[4:7], s49 offen offset:1024 sc1 lds
s_add_u32 m0, s42, 40960
s_add_u32 s49, s18, 40960
buffer_load_dwordx4 v0, s[4:7], s49 offen offset:0 sc1 lds
buffer_load_dwordx4 v0, s[4:7], s49 offen offset:1024 sc1 lds
buffer_load_dwordx4 v[204:207], v0, s[4:7], s51 offen offset:3072 sc1
buffer_load_dwordx4 v[208:211], v1, s[4:7], s51 offen offset:3072 sc1
s_and_b32 s52, s12, 1
s_lshl_b32 s52, s52, 8
s_add_u32 s53, s52, s84
v_lshrrev_b32 v3, 8, v0
v_mul_u32_u24 v3, 1280, v3
v_and_b32 v14, 0xf0, v0
v_add_u32 v3, v3, v14
s_add_u32 s52, s52, 159744
v_add_u32 v14, s52, v14
s_waitcnt vmcnt(16)
s_barrier
ds_read_b128 v[136:139], v0 offset:0
ds_read_b128 v[140:143], v0 offset:1024
ds_read_b128 v[144:147], v0 offset:2048
ds_read_b128 v[148:151], v0 offset:3072
ds_read_b128 v[152:155], v0 offset:4096
ds_read_b128 v[156:159], v0 offset:5120
ds_read_b128 v[160:163], v0 offset:6144
ds_read_b128 v[164:167], v0 offset:7168
s_waitcnt lgkmcnt(5)
s_waitcnt vmcnt(15)
v_mfma_f32_16x16x32_bf16 v[16:19], v[136:139], v[180:183], 0
s_add_u32 s51, s16, 4096
buffer_load_dwordx4 v[212:215], v0, s[4:7], s51 offen offset:0 sc1
s_waitcnt vmcnt(15)
v_mfma_f32_16x16x32_bf16 v[20:23], v[136:139], v[184:187], 0
ds_read_b128 v[168:171], v0 offset:8192
ds_read_b128 v[172:175], v0 offset:9216
v_mfma_f32_16x16x32_bf16 v[24:27], v[140:143], v[180:183], 0
ds_read_b128 v[176:179], v0 offset:10240
v_mfma_f32_16x16x32_bf16 v[28:31], v[140:143], v[184:187], 0
buffer_load_dwordx4 v[216:219], v1, s[4:7], s51 offen offset:0 sc1
v_mfma_f32_16x16x32_bf16 v[32:35], v[144:147], v[180:183], 0
s_add_u32 m0, s42, 49152
s_add_u32 s49, s18, 49152
v_mfma_f32_16x16x32_bf16 v[36:39], v[144:147], v[184:187], 0
ds_read_b128 v[136:139], v0 offset:11264
s_waitcnt lgkmcnt(6)
v_mfma_f32_16x16x32_bf16 v[40:43], v[148:151], v[180:183], 0
buffer_load_dwordx4 v0, s[4:7], s49 offen offset:0 sc1 lds
v_mfma_f32_16x16x32_bf16 v[44:47], v[148:151], v[184:187], 0
ds_read_b128 v[140:143], v0 offset:12288
v_mfma_f32_16x16x32_bf16 v[48:51], v[152:155], v[180:183], 0
buffer_load_dwordx4 v0, s[4:7], s49 offen offset:1024 sc1 lds
v_mfma_f32_16x16x32_bf16 v[52:55], v[152:155], v[184:187], 0
s_add_u32 m0, s42, 57344
s_add_u32 s49, s18, 57344
v_mfma_f32_16x16x32_bf16 v[56:59], v[180:183], v[156:159], 0
buffer_load_dwordx4 v0, s[4:7], s49 offen offset:0 sc1 lds
v_mfma_f32_16x16x32_bf16 v[60:63], v[184:187], v[156:159], 0
ds_read_b128 v[144:147], v0 offset:13312
s_waitcnt lgkmcnt(5)
v_mfma_f32_16x16x32_bf16 v[64:67], v[180:183], v[160:163], 0
ds_read_b128 v[148:151], v0 offset:14336
ds_read_b128 v[152:155], v0 offset:15360
v_mfma_f32_16x16x32_bf16 v[68:71], v[184:187], v[160:163], 0
buffer_load_dwordx4 v0, s[4:7], s49 offen offset:1024 sc1 lds
v_mfma_f32_16x16x32_bf16 v[72:75], v[180:183], v[164:167], 0
v_mfma_f32_16x16x32_bf16 v[76:79], v[184:187], v[164:167], 0
buffer_load_dwordx4 v[220:223], v0, s[4:7], s51 offen offset:1024 sc1
s_waitcnt vmcnt(16)
v_mfma_f32_16x16x32_bf16 v[16:19], v[168:171], v[188:191], v[16:19]
s_barrier
s_waitcnt vmcnt(15)
v_mfma_f32_16x16x32_bf16 v[20:23], v[168:171], v[192:195], v[20:23]
s_lshl_b32 s55, s14, 10
s_add_u32 s55, s55, C_p1e0-M_pc
v_lshlrev_b32 v85, 5, v9
v_and_b32 v85, 0x380, v85
v_add_u32 v85, s55, v85
v_min_u32 v85, M_last-M_pc-4, v85
global_load_dword v85, v85, s[86:87]
s_waitcnt lgkmcnt(4)
v_mfma_f32_16x16x32_bf16 v[24:27], v[172:175], v[188:191], v[24:27]
ds_read_b128 v[156:159], v0 offset:16384
ds_read_b128 v[160:163], v0 offset:17408
v_mfma_f32_16x16x32_bf16 v[28:31], v[172:175], v[192:195], v[28:31]
buffer_load_dwordx4 v[224:227], v1, s[4:7], s51 offen offset:1024 sc1
v_mfma_f32_16x16x32_bf16 v[32:35], v[176:179], v[188:191], v[32:35]
ds_read_b128 v[164:167], v0 offset:18432
ds_read_b128 v[168:171], v0 offset:19456
v_mfma_f32_16x16x32_bf16 v[36:39], v[176:179], v[192:195], v[36:39]
buffer_load_dwordx4 v[228:231], v0, s[4:7], s51 offen offset:2048 sc1
v_mfma_f32_16x16x32_bf16 v[40:43], v[136:139], v[188:191], v[40:43]
ds_read_b128 v[172:175], v0 offset:20480
v_mfma_f32_16x16x32_bf16 v[44:47], v[136:139], v[192:195], v[44:47]
s_waitcnt lgkmcnt(6)
v_mfma_f32_16x16x32_bf16 v[48:51], v[140:143], v[188:191], v[48:51]
buffer_load_dwordx4 v[232:235], v1, s[4:7], s51 offen offset:2048 sc1
v_mfma_f32_16x16x32_bf16 v[52:55], v[140:143], v[192:195], v[52:55]
s_add_u32 m0, s42, 65536
s_add_u32 s49, s18, 65536
v_mfma_f32_16x16x32_bf16 v[56:59], v[188:191], v[144:147], v[56:59]
buffer_load_dwordx4 v0, s[4:7], s49 offen offset:0 sc1 lds
v_mfma_f32_16x16x32_bf16 v[60:63], v[192:195], v[144:147], v[60:63]
ds_read_b128 v[176:179], v0 offset:21504
ds_read_b128 v[136:139], v0 offset:22528
v_mfma_f32_16x16x32_bf16 v[64:67], v[188:191], v[148:151], v[64:67]
buffer_load_dwordx4 v0, s[4:7], s49 offen offset:1024 sc1 lds
v_mfma_f32_16x16x32_bf16 v[68:71], v[192:195], v[148:151], v[68:71]
s_add_u32 m0, s42, 73728
s_add_u32 s49, s18, 73728
s_waitcnt lgkmcnt(5)
v_mfma_f32_16x16x32_bf16 v[72:75], v[188:191], v[152:155], v[72:75]
buffer_load_dwordx4 v0, s[4:7], s49 offen offset:0 sc1 lds
v_mfma_f32_16x16x32_bf16 v[76:79], v[192:195], v[152:155], v[76:79]
ds_read_b128 v[140:143], v0 offset:23552
ds_read_b128 v[144:147], v0 offset:24576
s_waitcnt vmcnt(21)
v_mfma_f32_16x16x32_bf16 v[16:19], v[156:159], v[196:199], v[16:19]
ds_read_b128 v[148:151], v0 offset:25600
s_waitcnt vmcnt(20)
v_mfma_f32_16x16x32_bf16 v[20:23], v[156:159], v[200:203], v[20:23]
buffer_load_dwordx4 v0, s[4:7], s49 offen offset:1024 sc1 lds
v_mfma_f32_16x16x32_bf16 v[24:27], v[160:163], v[196:199], v[24:27]
ds_read_b128 v[152:155], v0 offset:26624
v_mfma_f32_16x16x32_bf16 v[28:31], v[160:163], v[200:203], v[28:31]
s_waitcnt lgkmcnt(6)
v_mfma_f32_16x16x32_bf16 v[32:35], v[164:167], v[196:199], v[32:35]
buffer_load_dwordx4 v[112:115], v3, s[4:7], s53 offen sc1
s_add_u32 s53, s53, 5120
v_mfma_f32_16x16x32_bf16 v[36:39], v[164:167], v[200:203], v[36:39]
ds_read_b128 v[156:159], v0 offset:27648
v_mfma_f32_16x16x32_bf16 v[40:43], v[168:171], v[196:199], v[40:43]
buffer_load_dwordx4 v[116:119], v3, s[4:7], s53 offen sc1
s_add_u32 s53, s53, 5120
v_mfma_f32_16x16x32_bf16 v[44:47], v[168:171], v[200:203], v[44:47]
ds_read_b128 v[160:163], v0 offset:28672
v_mfma_f32_16x16x32_bf16 v[48:51], v[172:175], v[196:199], v[48:51]
buffer_load_dwordx4 v[120:123], v3, s[4:7], s53 offen sc1
s_add_u32 s53, s53, 5120
v_mfma_f32_16x16x32_bf16 v[52:55], v[172:175], v[200:203], v[52:55]
ds_read_b128 v[164:167], v0 offset:29696
s_waitcnt lgkmcnt(6)
v_mfma_f32_16x16x32_bf16 v[56:59], v[196:199], v[176:179], v[56:59]
ds_read_b128 v[168:171], v0 offset:30720
v_mfma_f32_16x16x32_bf16 v[60:63], v[200:203], v[176:179], v[60:63]
buffer_load_dwordx4 v[124:127], v3, s[4:7], s53 offen sc1
s_add_u32 s53, s53, 5120
v_mfma_f32_16x16x32_bf16 v[64:67], v[196:199], v[136:139], v[64:67]
ds_read_b128 v[172:175], v0 offset:31744
v_mfma_f32_16x16x32_bf16 v[68:71], v[200:203], v[136:139], v[68:71]
buffer_load_dwordx4 v[128:131], v3, s[4:7], s53 offen sc1
v_mfma_f32_16x16x32_bf16 v[72:75], v[196:199], v[140:143], v[72:75]
v_mfma_f32_16x16x32_bf16 v[76:79], v[200:203], v[140:143], v[76:79]
s_waitcnt lgkmcnt(5)
s_waitcnt vmcnt(21)
v_mfma_f32_16x16x32_bf16 v[16:19], v[144:147], v[204:207], v[16:19]
s_barrier
s_waitcnt vmcnt(20)
v_mfma_f32_16x16x32_bf16 v[20:23], v[144:147], v[208:211], v[20:23]
buffer_load_dwordx4 v[180:183], v0, s[4:7], s51 offen offset:3072 sc1
v_mfma_f32_16x16x32_bf16 v[24:27], v[148:151], v[204:207], v[24:27]
ds_read_b128 v[176:179], v0 offset:32768
ds_read_b128 v[136:139], v0 offset:33792
v_mfma_f32_16x16x32_bf16 v[28:31], v[148:151], v[208:211], v[28:31]
buffer_load_dwordx4 v[184:187], v1, s[4:7], s51 offen offset:3072 sc1
v_mfma_f32_16x16x32_bf16 v[32:35], v[152:155], v[204:207], v[32:35]
s_add_u32 s51, s16, 8192
ds_read_b128 v[140:143], v0 offset:34816
v_mfma_f32_16x16x32_bf16 v[36:39], v[152:155], v[208:211], v[36:39]
ds_read_b128 v[144:147], v0 offset:35840
s_waitcnt lgkmcnt(6)
v_mfma_f32_16x16x32_bf16 v[40:43], v[156:159], v[204:207], v[40:43]
buffer_load_dwordx4 v[188:191], v0, s[4:7], s51 offen offset:0 sc1
v_mfma_f32_16x16x32_bf16 v[44:47], v[156:159], v[208:211], v[44:47]
ds_read_b128 v[148:151], v0 offset:36864
v_mfma_f32_16x16x32_bf16 v[48:51], v[160:163], v[204:207], v[48:51]
buffer_load_dwordx4 v[192:195], v1, s[4:7], s51 offen offset:0 sc1
v_mfma_f32_16x16x32_bf16 v[52:55], v[160:163], v[208:211], v[52:55]
s_add_u32 m0, s42, 81920
s_add_u32 s49, s18, 81920
v_mfma_f32_16x16x32_bf16 v[56:59], v[204:207], v[164:167], v[56:59]
buffer_load_dwordx4 v0, s[4:7], s49 offen offset:0 sc1 lds
v_mfma_f32_16x16x32_bf16 v[60:63], v[208:211], v[164:167], v[60:63]
ds_read_b128 v[152:155], v0 offset:37888
s_waitcnt lgkmcnt(5)
v_mfma_f32_16x16x32_bf16 v[64:67], v[204:207], v[168:171], v[64:67]
buffer_load_dwordx4 v0, s[4:7], s49 offen offset:1024 sc1 lds
v_mfma_f32_16x16x32_bf16 v[68:71], v[208:211], v[168:171], v[68:71]
s_add_u32 m0, s42, 90112
s_add_u32 s49, s18, 90112
v_mfma_f32_16x16x32_bf16 v[72:75], v[204:207], v[172:175], v[72:75]
ds_read_b128 v[156:159], v0 offset:38912
ds_read_b128 v[160:163], v0 offset:39936
v_mfma_f32_16x16x32_bf16 v[76:79], v[208:211], v[172:175], v[76:79]
buffer_load_dwordx4 v0, s[4:7], s49 offen offset:0 sc1 lds
s_waitcnt vmcnt(26)
v_mfma_f32_16x16x32_bf16 v[16:19], v[176:179], v[212:215], v[16:19]
ds_read_b128 v[164:167], v0 offset:40960
ds_read_b128 v[168:171], v0 offset:41984
s_waitcnt vmcnt(25)
v_mfma_f32_16x16x32_bf16 v[20:23], v[176:179], v[216:219], v[20:23]
s_waitcnt lgkmcnt(6)
v_mfma_f32_16x16x32_bf16 v[24:27], v[136:139], v[212:215], v[24:27]
buffer_load_dwordx4 v0, s[4:7], s49 offen offset:1024 sc1 lds
v_mfma_f32_16x16x32_bf16 v[28:31], v[136:139], v[216:219], v[28:31]
ds_read_b128 v[172:175], v0 offset:43008
v_mfma_f32_16x16x32_bf16 v[32:35], v[140:143], v[212:215], v[32:35]
ds_read_b128 v[176:179], v0 offset:44032
v_mfma_f32_16x16x32_bf16 v[36:39], v[140:143], v[216:219], v[36:39]
v_mfma_f32_16x16x32_bf16 v[40:43], v[144:147], v[212:215], v[40:43]
buffer_load_dwordx4 v[196:199], v0, s[4:7], s51 offen offset:1024 sc1
v_mfma_f32_16x16x32_bf16 v[44:47], v[144:147], v[216:219], v[44:47]
ds_read_b128 v[136:139], v0 offset:45056
s_waitcnt lgkmcnt(6)
v_mfma_f32_16x16x32_bf16 v[48:51], v[148:151], v[212:215], v[48:51]
ds_read_b128 v[140:143], v0 offset:46080
v_mfma_f32_16x16x32_bf16 v[52:55], v[148:151], v[216:219], v[52:55]
buffer_load_dwordx4 v[200:203], v1, s[4:7], s51 offen offset:1024 sc1
v_mfma_f32_16x16x32_bf16 v[56:59], v[212:215], v[152:155], v[56:59]
ds_read_b128 v[144:147], v0 offset:47104
v_mfma_f32_16x16x32_bf16 v[60:63], v[216:219], v[152:155], v[60:63]
v_mfma_f32_16x16x32_bf16 v[64:67], v[212:215], v[156:159], v[64:67]
ds_read_b128 v[148:151], v0 offset:48128
v_mfma_f32_16x16x32_bf16 v[68:71], v[216:219], v[156:159], v[68:71]
s_waitcnt lgkmcnt(6)
v_mfma_f32_16x16x32_bf16 v[72:75], v[212:215], v[160:163], v[72:75]
buffer_load_dwordx4 v[204:207], v0, s[4:7], s51 offen offset:2048 sc1
v_mfma_f32_16x16x32_bf16 v[76:79], v[216:219], v[160:163], v[76:79]
s_waitcnt vmcnt(24)
v_mfma_f32_16x16x32_bf16 v[16:19], v[164:167], v[220:223], v[16:19]
s_barrier
s_waitcnt vmcnt(22)
v_mfma_f32_16x16x32_bf16 v[20:23], v[164:167], v[224:227], v[20:23]
buffer_load_dwordx4 v[208:211], v1, s[4:7], s51 offen offset:2048 sc1
v_mfma_f32_16x16x32_bf16 v[24:27], v[168:171], v[220:223], v[24:27]
s_add_u32 m0, s42, 98304
s_add_u32 s49, s18, 98304
v_mfma_f32_16x16x32_bf16 v[28:31], v[168:171], v[224:227], v[28:31]
ds_read_b128 v[152:155], v0 offset:49152
s_waitcnt lgkmcnt(4)
v_mfma_f32_16x16x32_bf16 v[32:35], v[172:175], v[220:223], v[32:35]
buffer_load_dwordx4 v0, s[4:7], s49 offen offset:0 sc1 lds
v_mfma_f32_16x16x32_bf16 v[36:39], v[172:175], v[224:227], v[36:39]
ds_read_b128 v[156:159], v0 offset:50176
ds_read_b128 v[160:163], v0 offset:51200
v_mfma_f32_16x16x32_bf16 v[40:43], v[176:179], v[220:223], v[40:43]
ds_read_b128 v[164:167], v0 offset:52224
ds_read_b128 v[168:171], v0 offset:53248
v_mfma_f32_16x16x32_bf16 v[44:47], v[176:179], v[224:227], v[44:47]
buffer_load_dwordx4 v0, s[4:7], s49 offen offset:1024 sc1 lds
v_mfma_f32_16x16x32_bf16 v[48:51], v[136:139], v[220:223], v[48:51]
s_add_u32 m0, s42, 106496
s_add_u32 s49, s18, 106496
v_mfma_f32_16x16x32_bf16 v[52:55], v[136:139], v[224:227], v[52:55]
ds_read_b128 v[172:175], v0 offset:54272
s_waitcnt lgkmcnt(6)
v_mfma_f32_16x16x32_bf16 v[56:59], v[220:223], v[140:143], v[56:59]
ds_read_b128 v[176:179], v0 offset:55296
v_mfma_f32_16x16x32_bf16 v[60:63], v[224:227], v[140:143], v[60:63]
buffer_load_dwordx4 v0, s[4:7], s49 offen offset:0 sc1 lds
v_mfma_f32_16x16x32_bf16 v[64:67], v[220:223], v[144:147], v[64:67]
ds_read_b128 v[136:139], v0 offset:56320
v_mfma_f32_16x16x32_bf16 v[68:71], v[224:227], v[144:147], v[68:71]
v_mfma_f32_16x16x32_bf16 v[72:75], v[220:223], v[148:151], v[72:75]
buffer_load_dwordx4 v0, s[4:7], s49 offen offset:1024 sc1 lds
v_mfma_f32_16x16x32_bf16 v[76:79], v[224:227], v[148:151], v[76:79]
ds_read_b128 v[140:143], v0 offset:57344
s_waitcnt lgkmcnt(6)
s_waitcnt vmcnt(26)
v_mfma_f32_16x16x32_bf16 v[16:19], v[152:155], v[228:231], v[16:19]
ds_read_b128 v[144:147], v0 offset:58368
s_waitcnt vmcnt(25)
v_mfma_f32_16x16x32_bf16 v[20:23], v[152:155], v[232:235], v[20:23]
v_mfma_f32_16x16x32_bf16 v[24:27], v[156:159], v[228:231], v[24:27]
buffer_load_dwordx4 v[212:215], v0, s[4:7], s51 offen offset:3072 sc1
v_mfma_f32_16x16x32_bf16 v[28:31], v[156:159], v[232:235], v[28:31]
ds_read_b128 v[148:151], v0 offset:59392
v_mfma_f32_16x16x32_bf16 v[32:35], v[160:163], v[228:231], v[32:35]
ds_read_b128 v[152:155], v0 offset:60416
v_mfma_f32_16x16x32_bf16 v[36:39], v[160:163], v[232:235], v[36:39]
s_waitcnt lgkmcnt(6)
v_mfma_f32_16x16x32_bf16 v[40:43], v[164:167], v[228:231], v[40:43]
buffer_load_dwordx4 v[216:219], v1, s[4:7], s51 offen offset:3072 sc1
v_mfma_f32_16x16x32_bf16 v[44:47], v[164:167], v[232:235], v[44:47]
s_add_u32 s51, s16, 12288
ds_read_b128 v[156:159], v0 offset:61440
v_mfma_f32_16x16x32_bf16 v[48:51], v[168:171], v[228:231], v[48:51]
ds_read_b128 v[160:163], v0 offset:62464
v_mfma_f32_16x16x32_bf16 v[52:55], v[168:171], v[232:235], v[52:55]
buffer_load_dwordx4 v[220:223], v0, s[4:7], s51 offen offset:0 sc1
v_mfma_f32_16x16x32_bf16 v[56:59], v[228:231], v[172:175], v[56:59]
ds_read_b128 v[164:167], v0 offset:63488
v_mfma_f32_16x16x32_bf16 v[60:63], v[232:235], v[172:175], v[60:63]
s_waitcnt lgkmcnt(6)
v_mfma_f32_16x16x32_bf16 v[64:67], v[228:231], v[176:179], v[64:67]
buffer_load_dwordx4 v[224:227], v1, s[4:7], s51 offen offset:0 sc1
v_mfma_f32_16x16x32_bf16 v[68:71], v[232:235], v[176:179], v[68:71]
s_add_u32 m0, s42, 114688
s_add_u32 s49, s18, 114688
v_mfma_f32_16x16x32_bf16 v[72:75], v[228:231], v[136:139], v[72:75]
ds_read_b128 v[168:171], v0 offset:64512
v_mfma_f32_16x16x32_bf16 v[76:79], v[232:235], v[136:139], v[76:79]
s_waitcnt vmcnt(19)
v_mfma_f32_16x16x32_bf16 v[16:19], v[140:143], v[180:183], v[16:19]
s_barrier
v_mov_b32 v84, v0
s_mov_b32 s55, 22519808
buffer_load_dwordx4 v0, s[4:7], s49 offen offset:0 sc1 lds
s_waitcnt vmcnt(19)
v_mfma_f32_16x16x32_bf16 v[20:23], v[140:143], v[184:187], v[20:23]
ds_read_b128 v[172:175], v4 offset:0
s_waitcnt lgkmcnt(5)
v_mfma_f32_16x16x32_bf16 v[24:27], v[144:147], v[180:183], v[24:27]
ds_read_b128 v[176:179], v4 offset:1024
ds_read_b128 v[136:139], v4 offset:2048
v_mfma_f32_16x16x32_bf16 v[28:31], v[144:147], v[184:187], v[28:31]
buffer_load_dwordx4 v0, s[4:7], s49 offen offset:1024 sc1 lds
v_mfma_f32_16x16x32_bf16 v[32:35], v[148:151], v[180:183], v[32:35]
s_add_u32 m0, s42, 122880
s_add_u32 s49, s18, 122880
v_mfma_f32_16x16x32_bf16 v[36:39], v[148:151], v[184:187], v[36:39]
ds_read_b128 v[140:143], v4 offset:3072
v_mfma_f32_16x16x32_bf16 v[40:43], v[152:155], v[180:183], v[40:43]
ds_read_b128 v[144:147], v4 offset:4096
v_mfma_f32_16x16x32_bf16 v[44:47], v[152:155], v[184:187], v[44:47]
s_waitcnt lgkmcnt(6)
v_mfma_f32_16x16x32_bf16 v[48:51], v[156:159], v[180:183], v[48:51]
buffer_load_dwordx4 v0, s[4:7], s49 offen offset:0 sc1 lds
v_mfma_f32_16x16x32_bf16 v[52:55], v[156:159], v[184:187], v[52:55]
ds_read_b128 v[148:151], v4 offset:5120
v_mfma_f32_16x16x32_bf16 v[56:59], v[180:183], v[160:163], v[56:59]
ds_read_b128 v[152:155], v4 offset:6144
v_mfma_f32_16x16x32_bf16 v[60:63], v[184:187], v[160:163], v[60:63]
buffer_load_dwordx4 v0, s[4:7], s49 offen offset:1024 sc1 lds
v_mfma_f32_16x16x32_bf16 v[64:67], v[180:183], v[164:167], v[64:67]
ds_read_b128 v[156:159], v4 offset:7168
v_mfma_f32_16x16x32_bf16 v[68:71], v[184:187], v[164:167], v[68:71]
s_waitcnt lgkmcnt(6)
v_mfma_f32_16x16x32_bf16 v[72:75], v[180:183], v[168:171], v[72:75]
buffer_load_dwordx4 v[228:231], v0, s[4:7], s51 offen offset:1024 sc1
v_mfma_f32_16x16x32_bf16 v[76:79], v[184:187], v[168:171], v[76:79]
ds_read_b128 v[160:163], v4 offset:8192
s_waitcnt vmcnt(22)
v_mfma_f32_16x16x32_bf16 v[16:19], v[172:175], v[188:191], v[16:19]
ds_read_b128 v[164:167], v4 offset:9216
s_waitcnt vmcnt(21)
v_mfma_f32_16x16x32_bf16 v[20:23], v[172:175], v[192:195], v[20:23]
buffer_load_dwordx4 v[80:83], v84, s[4:7], s55 offen sc1
v_mfma_f32_16x16x32_bf16 v[24:27], v[176:179], v[188:191], v[24:27]
ds_read_b128 v[168:171], v4 offset:10240
v_mfma_f32_16x16x32_bf16 v[28:31], v[176:179], v[192:195], v[28:31]
s_waitcnt lgkmcnt(6)
v_mfma_f32_16x16x32_bf16 v[32:35], v[136:139], v[188:191], v[32:35]
ds_read_b128 v[172:175], v4 offset:11264
v_mfma_f32_16x16x32_bf16 v[36:39], v[136:139], v[192:195], v[36:39]
buffer_load_dwordx4 v[232:235], v1, s[4:7], s51 offen offset:1024 sc1
v_mfma_f32_16x16x32_bf16 v[40:43], v[140:143], v[188:191], v[40:43]
ds_read_b128 v[176:179], v4 offset:12288
v_mfma_f32_16x16x32_bf16 v[44:47], v[140:143], v[192:195], v[44:47]
v_mfma_f32_16x16x32_bf16 v[48:51], v[144:147], v[188:191], v[48:51]
buffer_load_dwordx4 v[180:183], v0, s[4:7], s51 offen offset:2048 sc1
v_mfma_f32_16x16x32_bf16 v[52:55], v[144:147], v[192:195], v[52:55]
ds_read_b128 v[136:139], v4 offset:13312
s_waitcnt lgkmcnt(6)
v_mfma_f32_16x16x32_bf16 v[56:59], v[188:191], v[148:151], v[56:59]
ds_read_b128 v[140:143], v4 offset:14336
v_mfma_f32_16x16x32_bf16 v[60:63], v[192:195], v[148:151], v[60:63]
v_mfma_f32_16x16x32_bf16 v[64:67], v[188:191], v[152:155], v[64:67]
buffer_load_dwordx4 v[184:187], v1, s[4:7], s51 offen offset:2048 sc1
v_mfma_f32_16x16x32_bf16 v[68:71], v[192:195], v[152:155], v[68:71]
s_add_u32 m0, s42, 131072
s_add_u32 s49, s18, 131072
v_mfma_f32_16x16x32_bf16 v[72:75], v[188:191], v[156:159], v[72:75]
ds_read_b128 v[144:147], v4 offset:15360
v_mfma_f32_16x16x32_bf16 v[76:79], v[192:195], v[156:159], v[76:79]
buffer_load_dwordx4 v0, s[4:7], s49 offen offset:0 sc1 lds
s_waitcnt lgkmcnt(5)
s_waitcnt vmcnt(21)
v_mfma_f32_16x16x32_bf16 v[16:19], v[160:163], v[196:199], v[16:19]
s_barrier
s_waitcnt vmcnt(20)
v_mfma_f32_16x16x32_bf16 v[20:23], v[160:163], v[200:203], v[20:23]
ds_read_b128 v[148:151], v4 offset:16384
ds_read_b128 v[152:155], v4 offset:17408
v_mfma_f32_16x16x32_bf16 v[24:27], v[164:167], v[196:199], v[24:27]
ds_read_b128 v[156:159], v4 offset:18432
v_add_f32 v112, v112, v116
v_mfma_f32_16x16x32_bf16 v[28:31], v[164:167], v[200:203], v[28:31]
buffer_load_dwordx4 v0, s[4:7], s49 offen offset:1024 sc1 lds
v_mfma_f32_16x16x32_bf16 v[32:35], v[168:171], v[196:199], v[32:35]
s_add_u32 m0, s42, 139264
s_add_u32 s49, s18, 139264
v_mfma_f32_16x16x32_bf16 v[36:39], v[168:171], v[200:203], v[36:39]
ds_read_b128 v[160:163], v4 offset:19456
s_waitcnt lgkmcnt(6)
v_mfma_f32_16x16x32_bf16 v[40:43], v[172:175], v[196:199], v[40:43]
buffer_load_dwordx4 v0, s[4:7], s49 offen offset:0 sc1 lds
v_mfma_f32_16x16x32_bf16 v[44:47], v[172:175], v[200:203], v[44:47]
ds_read_b128 v[164:167], v4 offset:20480
v_add_f32 v113, v113, v117
v_mfma_f32_16x16x32_bf16 v[48:51], v[176:179], v[196:199], v[48:51]
ds_read_b128 v[168:171], v4 offset:21504
v_add_f32 v114, v114, v118
v_mfma_f32_16x16x32_bf16 v[52:55], v[176:179], v[200:203], v[52:55]
v_add_f32 v115, v115, v119
v_add_f32 v112, v112, v120
v_mfma_f32_16x16x32_bf16 v[56:59], v[196:199], v[136:139], v[56:59]
buffer_load_dwordx4 v0, s[4:7], s49 offen offset:1024 sc1 lds
v_mfma_f32_16x16x32_bf16 v[60:63], v[200:203], v[136:139], v[60:63]
ds_read_b128 v[172:175], v4 offset:22528
s_waitcnt lgkmcnt(6)
v_mfma_f32_16x16x32_bf16 v[64:67], v[196:199], v[140:143], v[64:67]
ds_read_b128 v[176:179], v4 offset:23552
v_add_f32 v113, v113, v121
v_mfma_f32_16x16x32_bf16 v[68:71], v[200:203], v[140:143], v[68:71]
buffer_load_dwordx4 v[188:191], v0, s[4:7], s51 offen offset:3072 sc1
v_mfma_f32_16x16x32_bf16 v[72:75], v[196:199], v[144:147], v[72:75]
ds_read_b128 v[136:139], v4 offset:24576
v_add_f32 v114, v114, v122
v_mfma_f32_16x16x32_bf16 v[76:79], v[200:203], v[144:147], v[76:79]
v_add_f32 v115, v115, v123
v_add_f32 v112, v112, v124
s_waitcnt vmcnt(23)
v_mfma_f32_16x16x32_bf16 v[16:19], v[148:151], v[204:207], v[16:19]
ds_read_b128 v[140:143], v4 offset:25600
v_add_f32 v113, v113, v125
s_waitcnt vmcnt(22)
v_mfma_f32_16x16x32_bf16 v[20:23], v[148:151], v[208:211], v[20:23]
v_add_f32 v114, v114, v126
s_waitcnt lgkmcnt(6)
v_mfma_f32_16x16x32_bf16 v[24:27], v[152:155], v[204:207], v[24:27]
buffer_load_dwordx4 v[192:195], v1, s[4:7], s51 offen offset:3072 sc1
v_mfma_f32_16x16x32_bf16 v[28:31], v[152:155], v[208:211], v[28:31]
s_add_u32 s51, s16, 16384
ds_read_b128 v[144:147], v4 offset:26624
v_mfma_f32_16x16x32_bf16 v[32:35], v[156:159], v[204:207], v[32:35]
ds_read_b128 v[148:151], v4 offset:27648
v_add_f32 v115, v115, v127
v_mfma_f32_16x16x32_bf16 v[36:39], v[156:159], v[208:211], v[36:39]
buffer_load_dwordx4 v[196:199], v0, s[4:7], s51 offen offset:0 sc1
v_mfma_f32_16x16x32_bf16 v[40:43], v[160:163], v[204:207], v[40:43]
ds_read_b128 v[152:155], v4 offset:28672
v_add_f32 v112, v112, v128
v_mfma_f32_16x16x32_bf16 v[44:47], v[160:163], v[208:211], v[44:47]
v_add_f32 v113, v113, v129
s_waitcnt lgkmcnt(6)
v_mfma_f32_16x16x32_bf16 v[48:51], v[164:167], v[204:207], v[48:51]
buffer_load_dwordx4 v[200:203], v1, s[4:7], s51 offen offset:0 sc1
v_mfma_f32_16x16x32_bf16 v[52:55], v[164:167], v[208:211], v[52:55]
s_add_u32 m0, s42, 147456
s_add_u32 s49, s18, 147456
v_mfma_f32_16x16x32_bf16 v[56:59], v[204:207], v[168:171], v[56:59]
ds_read_b128 v[156:159], v4 offset:29696
ds_read_b128 v[160:163], v4 offset:30720
v_mfma_f32_16x16x32_bf16 v[60:63], v[208:211], v[168:171], v[60:63]
buffer_load_dwordx4 v0, s[4:7], s49 offen offset:0 sc1 lds
v_mfma_f32_16x16x32_bf16 v[64:67], v[204:207], v[172:175], v[64:67]
ds_read_b128 v[164:167], v4 offset:31744
v_add_f32 v114, v114, v130
v_mfma_f32_16x16x32_bf16 v[68:71], v[208:211], v[172:175], v[68:71]
v_add_f32 v115, v115, v131
s_waitcnt lgkmcnt(6)
v_mfma_f32_16x16x32_bf16 v[72:75], v[204:207], v[176:179], v[72:75]
v_mov_b32 v116, v112
v_mov_b32 v117, v113
v_mfma_f32_16x16x32_bf16 v[76:79], v[208:211], v[176:179], v[76:79]
buffer_load_dwordx4 v0, s[4:7], s49 offen offset:1024 sc1 lds
s_waitcnt vmcnt(22)
v_mfma_f32_16x16x32_bf16 v[16:19], v[136:139], v[212:215], v[16:19]
s_barrier
s_waitcnt vmcnt(13)
v_xor_b32 v80, s89, v80
v_xor_b32 v81, s89, v81
v_xor_b32 v82, s89, v82
v_xor_b32 v83, s89, v83
v_or3_b32 v80, v80, v81, v82
v_or_b32 v80, v80, v83
v_cmp_ne_u32 vcc, 0, v80
s_nop 0
s_cmp_eq_u64 vcc, 0
s_cbranch_scc1 M_fb2
M_fb1:
buffer_load_dwordx4 v[80:83], v84, s[4:7], s55 offen sc1
s_waitcnt vmcnt(0)
v_xor_b32 v80, s89, v80
v_xor_b32 v81, s89, v81
v_xor_b32 v82, s89, v82
v_xor_b32 v83, s89, v83
v_or3_b32 v80, v80, v81, v82
v_or_b32 v80, v80, v83
v_cmp_ne_u32 vcc, 0, v80
s_nop 1
s_cmp_eq_u64 vcc, 0
s_cbranch_scc1 M_fb2
s_sub_u32 s45, s45, 1
s_cbranch_scc0 M_fb1
s_mov_b32 s45, 0
M_fb2:
v_mfma_f32_16x16x32_bf16 v[20:23], v[136:139], v[216:219], v[20:23]
s_add_u32 m0, s42, 0
s_add_u32 s49, s18, 155648
v_mfma_f32_16x16x32_bf16 v[24:27], v[140:143], v[212:215], v[24:27]
buffer_load_dwordx4 v0, s[4:7], s49 offen offset:0 sc1 lds
v_mfma_f32_16x16x32_bf16 v[28:31], v[140:143], v[216:219], v[28:31]
ds_read_b128 v[168:171], v4 offset:32768
s_waitcnt lgkmcnt(4)
v_mfma_f32_16x16x32_bf16 v[32:35], v[144:147], v[212:215], v[32:35]
ds_read_b128 v[172:175], v4 offset:33792
ds_read_b128 v[176:179], v4 offset:34816
v_mfma_f32_16x16x32_bf16 v[36:39], v[144:147], v[216:219], v[36:39]
ds_read_b128 v[136:139], v4 offset:35840
v_mov_b32 v118, v114
v_mfma_f32_16x16x32_bf16 v[40:43], v[148:151], v[212:215], v[40:43]
buffer_load_dwordx4 v0, s[4:7], s49 offen offset:1024 sc1 lds
v_mfma_f32_16x16x32_bf16 v[44:47], v[148:151], v[216:219], v[44:47]
ds_read_b128 v[140:143], v4 offset:36864
v_mov_b32 v119, v115
v_mfma_f32_16x16x32_bf16 v[48:51], v[152:155], v[212:215], v[48:51]
ds_read_b128 v[144:147], v4 offset:37888
v_permlane16_swap_b32 v112, v116
v_mfma_f32_16x16x32_bf16 v[52:55], v[152:155], v[216:219], v[52:55]
v_permlane16_swap_b32 v113, v117
v_permlane16_swap_b32 v114, v118
v_permlane16_swap_b32 v115, v119
s_waitcnt lgkmcnt(6)
v_mfma_f32_16x16x32_bf16 v[56:59], v[212:215], v[156:159], v[56:59]
buffer_load_dwordx4 v[204:207], v0, s[4:7], s51 offen offset:1024 sc1
v_add_f32 v112, v112, v116
v_add_f32 v113, v113, v117
v_mfma_f32_16x16x32_bf16 v[60:63], v[216:219], v[156:159], v[60:63]
ds_read_b128 v[148:151], v4 offset:38912
v_add_f32 v114, v114, v118
v_add_f32 v115, v115, v119
v_mov_b32 v116, v112
v_mfma_f32_16x16x32_bf16 v[64:67], v[212:215], v[160:163], v[64:67]
ds_read_b128 v[152:155], v4 offset:39936
v_mov_b32 v117, v113
v_mov_b32 v118, v114
v_mov_b32 v119, v115
v_mfma_f32_16x16x32_bf16 v[68:71], v[216:219], v[160:163], v[68:71]
buffer_load_dwordx4 v[208:211], v1, s[4:7], s51 offen offset:1024 sc1
v_permlane32_swap_b32 v112, v116
v_permlane32_swap_b32 v113, v117
v_permlane32_swap_b32 v114, v118
v_mfma_f32_16x16x32_bf16 v[72:75], v[212:215], v[164:167], v[72:75]
ds_read_b128 v[156:159], v4 offset:40960
v_permlane32_swap_b32 v115, v119
v_add_f32 v112, v112, v116
v_add_f32 v113, v113, v117
v_mfma_f32_16x16x32_bf16 v[76:79], v[216:219], v[164:167], v[76:79]
v_add_f32 v114, v114, v118
v_add_f32 v115, v115, v119
ds_write_b128 v14, v[112:115]
s_waitcnt lgkmcnt(7)
v_mfma_f32_16x16x32_bf16 v[16:19], v[168:171], v[220:223], v[16:19]
buffer_load_dwordx2 v[112:113], v13, s[4:7], s33 offen offset:0 sc1
v_mfma_f32_16x16x32_bf16 v[20:23], v[168:171], v[224:227], v[20:23]
ds_read_b128 v[160:163], v4 offset:41984
v_mfma_f32_16x16x32_bf16 v[24:27], v[172:175], v[220:223], v[24:27]
ds_read_b128 v[164:167], v4 offset:43008
v_mfma_f32_16x16x32_bf16 v[28:31], v[172:175], v[224:227], v[28:31]
v_mfma_f32_16x16x32_bf16 v[32:35], v[176:179], v[220:223], v[32:35]
buffer_load_dwordx2 v[114:115], v13, s[4:7], s33 offen offset:128 sc1
v_mfma_f32_16x16x32_bf16 v[36:39], v[176:179], v[224:227], v[36:39]
ds_read_b128 v[168:171], v4 offset:44032
s_waitcnt lgkmcnt(7)
v_mfma_f32_16x16x32_bf16 v[40:43], v[136:139], v[220:223], v[40:43]
ds_read_b128 v[172:175], v4 offset:45056
v_mfma_f32_16x16x32_bf16 v[44:47], v[136:139], v[224:227], v[44:47]
buffer_load_dwordx2 v[116:117], v13, s[4:7], s33 offen offset:1024 sc1
v_mfma_f32_16x16x32_bf16 v[48:51], v[140:143], v[220:223], v[48:51]
ds_read_b128 v[176:179], v4 offset:46080
v_mfma_f32_16x16x32_bf16 v[52:55], v[140:143], v[224:227], v[52:55]
v_mfma_f32_16x16x32_bf16 v[56:59], v[220:223], v[144:147], v[56:59]
ds_read_b128 v[136:139], v4 offset:47104
v_mfma_f32_16x16x32_bf16 v[60:63], v[224:227], v[144:147], v[60:63]
s_waitcnt lgkmcnt(7)
v_mfma_f32_16x16x32_bf16 v[64:67], v[220:223], v[148:151], v[64:67]
buffer_load_dwordx2 v[118:119], v13, s[4:7], s33 offen offset:1152 sc1
v_mfma_f32_16x16x32_bf16 v[68:71], v[224:227], v[148:151], v[68:71]
ds_read_b128 v[140:143], v4 offset:48128
v_mfma_f32_16x16x32_bf16 v[72:75], v[220:223], v[152:155], v[72:75]
v_mfma_f32_16x16x32_bf16 v[76:79], v[224:227], v[152:155], v[76:79]
s_add_u32 s48, s40, 0
v_lshlrev_b32 v86, 9, v9
v_and_b32 v86, 2048, v86
buffer_load_dword v86, v86, s[4:7], s48 offen
v_mfma_f32_16x16x32_bf16 v[16:19], v[156:159], v[228:231], v[16:19]
s_waitcnt lgkmcnt(7)
s_barrier
s_waitcnt vmcnt(21)
v_mfma_f32_16x16x32_bf16 v[20:23], v[156:159], v[232:235], v[20:23]
ds_read_b128 v[144:147], v4 offset:49152
s_waitcnt lgkmcnt(5)
v_mfma_f32_16x16x32_bf16 v[24:27], v[160:163], v[228:231], v[24:27]
s_lshl_b32 s54, s13, 11
s_add_u32 s54, s54, 22446080
v_lshlrev_b32 v14, 5, v9
buffer_load_dword v3, v14, s[4:7], s54 offen sc1
v_mfma_f32_16x16x32_bf16 v[28:31], v[160:163], v[232:235], v[28:31]
ds_read_b128 v[148:151], v4 offset:50176
ds_read_b128 v[152:155], v4 offset:51200
v_mfma_f32_16x16x32_bf16 v[32:35], v[164:167], v[228:231], v[32:35]
ds_read_b128 v[156:159], v4 offset:52224
v_mfma_f32_16x16x32_bf16 v[36:39], v[164:167], v[232:235], v[36:39]
buffer_load_dwordx4 v[212:215], v0, s[4:7], s51 offen offset:2048 sc1
v_mfma_f32_16x16x32_bf16 v[40:43], v[168:171], v[228:231], v[40:43]
ds_read_b128 v[160:163], v4 offset:53248
v_mfma_f32_16x16x32_bf16 v[44:47], v[168:171], v[232:235], v[44:47]
s_waitcnt lgkmcnt(6)
v_mfma_f32_16x16x32_bf16 v[48:51], v[172:175], v[228:231], v[48:51]
ds_read_b128 v[164:167], v4 offset:54272
v_mfma_f32_16x16x32_bf16 v[52:55], v[172:175], v[232:235], v[52:55]
buffer_load_dwordx4 v[216:219], v1, s[4:7], s51 offen offset:2048 sc1
v_mfma_f32_16x16x32_bf16 v[56:59], v[228:231], v[176:179], v[56:59]
ds_read_b128 v[168:171], v4 offset:55296
v_mfma_f32_16x16x32_bf16 v[60:63], v[232:235], v[176:179], v[60:63]
v_mfma_f32_16x16x32_bf16 v[64:67], v[228:231], v[136:139], v[64:67]
buffer_load_dwordx4 v[220:223], v0, s[4:7], s51 offen offset:3072 sc1
v_mfma_f32_16x16x32_bf16 v[68:71], v[232:235], v[136:139], v[68:71]
ds_read_b128 v[172:175], v4 offset:56320
s_waitcnt lgkmcnt(6)
v_mfma_f32_16x16x32_bf16 v[72:75], v[228:231], v[140:143], v[72:75]
ds_read_b128 v[176:179], v4 offset:57344
v_mfma_f32_16x16x32_bf16 v[76:79], v[232:235], v[140:143], v[76:79]
s_waitcnt vmcnt(24)
v_mfma_f32_16x16x32_bf16 v[16:19], v[144:147], v[180:183], v[16:19]
buffer_load_dwordx4 v[224:227], v1, s[4:7], s51 offen offset:3072 sc1
s_waitcnt vmcnt(24)
v_mfma_f32_16x16x32_bf16 v[20:23], v[144:147], v[184:187], v[20:23]
s_add_u32 m0, s85, 24576
s_add_u32 s49, s20, 0
v_mfma_f32_16x16x32_bf16 v[24:27], v[148:151], v[180:183], v[24:27]
ds_read_b128 v[136:139], v4 offset:58368
ds_read_b128 v[140:143], v4 offset:59392
v_mfma_f32_16x16x32_bf16 v[28:31], v[148:151], v[184:187], v[28:31]
s_waitcnt lgkmcnt(6)
v_mfma_f32_16x16x32_bf16 v[32:35], v[152:155], v[180:183], v[32:35]
buffer_load_dwordx4 v0, s[4:7], s49 offen offset:0 sc1 lds
v_mfma_f32_16x16x32_bf16 v[36:39], v[152:155], v[184:187], v[36:39]
ds_read_b128 v[144:147], v4 offset:60416
v_mfma_f32_16x16x32_bf16 v[40:43], v[156:159], v[180:183], v[40:43]
ds_read_b128 v[148:151], v4 offset:61440
v_mfma_f32_16x16x32_bf16 v[44:47], v[156:159], v[184:187], v[44:47]
buffer_load_dwordx4 v0, s[4:7], s49 offen offset:1024 sc1 lds
v_mfma_f32_16x16x32_bf16 v[48:51], v[160:163], v[180:183], v[48:51]
ds_read_b128 v[152:155], v4 offset:62464
v_mfma_f32_16x16x32_bf16 v[52:55], v[160:163], v[184:187], v[52:55]
s_waitcnt lgkmcnt(6)
v_mfma_f32_16x16x32_bf16 v[56:59], v[180:183], v[164:167], v[56:59]
buffer_load_dwordx4 v0, s[4:7], s49 offen offset:2048 sc1 lds
v_mfma_f32_16x16x32_bf16 v[60:63], v[184:187], v[164:167], v[60:63]
ds_read_b128 v[156:159], v4 offset:63488
v_mfma_f32_16x16x32_bf16 v[64:67], v[180:183], v[168:171], v[64:67]
ds_read_b128 v[160:163], v4 offset:64512
v_mfma_f32_16x16x32_bf16 v[68:71], v[184:187], v[168:171], v[68:71]
v_mfma_f32_16x16x32_bf16 v[72:75], v[180:183], v[172:175], v[72:75]
buffer_load_dwordx4 v0, s[4:7], s49 offen offset:3072 sc1 lds
v_mfma_f32_16x16x32_bf16 v[76:79], v[184:187], v[172:175], v[76:79]
s_add_u32 m0, s85, 40960
s_add_u32 s49, s20, 4096
s_waitcnt lgkmcnt(5)
s_waitcnt vmcnt(23)
v_mfma_f32_16x16x32_bf16 v[16:19], v[176:179], v[188:191], v[16:19]
s_barrier
s_waitcnt vmcnt(22)
v_mfma_f32_16x16x32_bf16 v[20:23], v[176:179], v[192:195], v[20:23]
buffer_load_dwordx4 v0, s[4:7], s49 offen offset:0 sc1 lds
v_mfma_f32_16x16x32_bf16 v[24:27], v[136:139], v[188:191], v[24:27]
ds_read_b128 v[164:167], v5 offset:0
ds_read_b128 v[168:171], v5 offset:1024
v_mfma_f32_16x16x32_bf16 v[28:31], v[136:139], v[192:195], v[28:31]
ds_read_b128 v[172:175], v5 offset:2048
s_waitcnt vmcnt(13)
v_add_f32 v112, v112, v114
v_mfma_f32_16x16x32_bf16 v[32:35], v[140:143], v[188:191], v[32:35]
ds_read_b128 v[176:179], v5 offset:3072
s_waitcnt vmcnt(11)
v_add_f32 v116, v116, v118
v_mfma_f32_16x16x32_bf16 v[36:39], v[140:143], v[192:195], v[36:39]
v_add_f32 v113, v113, v115
s_waitcnt lgkmcnt(6)
v_mfma_f32_16x16x32_bf16 v[40:43], v[144:147], v[188:191], v[40:43]
buffer_load_dwordx4 v0, s[4:7], s49 offen offset:1024 sc1 lds
v_mfma_f32_16x16x32_bf16 v[44:47], v[144:147], v[192:195], v[44:47]
ds_read_b128 v[136:139], v5 offset:4096
v_add_f32 v117, v117, v119
v_mfma_f32_16x16x32_bf16 v[48:51], v[148:151], v[188:191], v[48:51]
ds_read_b128 v[140:143], v5 offset:5120
v_permlane16_swap_b32 v112, v113
v_mfma_f32_16x16x32_bf16 v[52:55], v[148:151], v[192:195], v[52:55]
buffer_load_dwordx4 v0, s[4:7], s49 offen offset:2048 sc1 lds
v_mfma_f32_16x16x32_bf16 v[56:59], v[188:191], v[152:155], v[56:59]
ds_read_b128 v[144:147], v5 offset:6144
v_permlane16_swap_b32 v116, v117
v_mfma_f32_16x16x32_bf16 v[60:63], v[192:195], v[152:155], v[60:63]
v_add_f32 v112, v112, v113
s_waitcnt lgkmcnt(6)
v_mfma_f32_16x16x32_bf16 v[64:67], v[188:191], v[156:159], v[64:67]
buffer_load_dwordx4 v0, s[4:7], s49 offen offset:3072 sc1 lds
v_mfma_f32_16x16x32_bf16 v[68:71], v[192:195], v[156:159], v[68:71]
s_add_u32 m0, s85, 57344
s_add_u32 s49, s20, 8192
v_mfma_f32_16x16x32_bf16 v[72:75], v[188:191], v[160:163], v[72:75]
ds_read_b128 v[148:151], v5 offset:7168
ds_read_b128 v[152:155], v5 offset:8192
v_mfma_f32_16x16x32_bf16 v[76:79], v[192:195], v[160:163], v[76:79]
buffer_load_dwordx4 v0, s[4:7], s49 offen offset:0 sc1 lds
v_mfma_f32_16x16x32_bf16 v[16:19], v[164:167], v[196:199], v[16:19]
s_waitcnt vmcnt(13)
v_xor_b32 v10, s89, v3
v_cmp_lt_u32 vcc, 15, v10
v_mov_b32 v10, s89
s_cmp_eq_u64 vcc, 0
s_cbranch_scc1 RC1
s_add_u32 s48, s54, 0
PL2:
buffer_load_dword v3, v14, s[4:7], s48 offen sc1
s_waitcnt vmcnt(0)
v_xor_b32 v10, s89, v3
v_cmp_lt_u32 vcc, 15, v10
v_mov_b32 v10, s89
s_nop 1
s_cmp_eq_u64 vcc, 0
s_cbranch_scc1 PL3
s_sub_u32 s45, s45, 1
s_cbranch_scc0 PL2
s_mov_b32 s45, 0
PL3:
RC1:
s_nop 0
v_readfirstlane_b32 s48, v3
s_nop 1
v_cmp_ne_u32 vcc, s48, v3
s_nop 0
s_cmp_eq_u64 vcc, 0
s_cselect_b32 s15, 1, 0
v_mfma_f32_16x16x32_bf16 v[20:23], v[164:167], v[200:203], v[20:23]
ds_read_b128 v[156:159], v5 offset:9216
s_waitcnt lgkmcnt(6)
v_mfma_f32_16x16x32_bf16 v[24:27], v[168:171], v[196:199], v[24:27]
ds_read_b128 v[160:163], v5 offset:10240
v_add_f32 v116, v116, v117
v_mfma_f32_16x16x32_bf16 v[28:31], v[168:171], v[200:203], v[28:31]
buffer_load_dword v3, v111, s[4:7], s37 offen
v_mfma_f32_16x16x32_bf16 v[32:35], v[172:175], v[196:199], v[32:35]
ds_read_b128 v[164:167], v5 offset:11264
v_mov_b32 v113, v112
v_mfma_f32_16x16x32_bf16 v[36:39], v[172:175], v[200:203], v[36:39]
v_mov_b32 v117, v116
v_permlane32_swap_b32 v112, v113
v_mfma_f32_16x16x32_bf16 v[40:43], v[176:179], v[196:199], v[40:43]
buffer_load_dword v14, v110, s[4:7], s38 offen
v_mfma_f32_16x16x32_bf16 v[44:47], v[176:179], v[200:203], v[44:47]
ds_read_b128 v[168:171], v5 offset:12288
s_waitcnt lgkmcnt(6)
v_mfma_f32_16x16x32_bf16 v[48:51], v[136:139], v[196:199], v[48:51]
ds_read_b128 v[172:175], v5 offset:13312
v_permlane32_swap_b32 v116, v117
v_mfma_f32_16x16x32_bf16 v[52:55], v[136:139], v[200:203], v[52:55]
v_add_f32 v112, v112, v113
v_add_f32 v116, v116, v117
v_mfma_f32_16x16x32_bf16 v[56:59], v[196:199], v[140:143], v[56:59]
buffer_load_dwordx4 v0, s[4:7], s49 offen offset:1024 sc1 lds
v_mfma_f32_16x16x32_bf16 v[60:63], v[200:203], v[140:143], v[60:63]
ds_read_b128 v[176:179], v5 offset:14336
v_mov_b32 v113, v112
v_mfma_f32_16x16x32_bf16 v[64:67], v[196:199], v[144:147], v[64:67]
ds_read_b128 v[136:139], v5 offset:15360
v_mov_b32 v117, v116
v_mfma_f32_16x16x32_bf16 v[68:71], v[200:203], v[144:147], v[68:71]
v_permlane16_swap_b32 v112, v113
s_waitcnt lgkmcnt(6)
v_mfma_f32_16x16x32_bf16 v[72:75], v[196:199], v[148:151], v[72:75]
buffer_load_dwordx4 v0, s[4:7], s49 offen offset:2048 sc1 lds
v_mfma_f32_16x16x32_bf16 v[76:79], v[200:203], v[148:151], v[76:79]
v_permlane16_swap_b32 v116, v117
v_mul_f32 v236, 0x3acccccd, v112
v_mfma_f32_16x16x32_bf16 v[16:19], v[152:155], v[204:207], v[16:19]
s_barrier
v_mfma_f32_16x16x32_bf16 v[20:23], v[152:155], v[208:211], v[20:23]
buffer_load_dwordx4 v0, s[4:7], s49 offen offset:3072 sc1 lds
v_mfma_f32_16x16x32_bf16 v[24:27], v[156:159], v[204:207], v[24:27]
s_add_u32 m0, s85, 73728
s_add_u32 s49, s20, 12288
v_mfma_f32_16x16x32_bf16 v[28:31], v[156:159], v[208:211], v[28:31]
ds_read_b128 v[140:143], v5 offset:16384
s_waitcnt lgkmcnt(4)
v_mfma_f32_16x16x32_bf16 v[32:35], v[160:163], v[204:207], v[32:35]
buffer_load_dwordx4 v0, s[4:7], s49 offen offset:0 sc1 lds
v_mfma_f32_16x16x32_bf16 v[36:39], v[160:163], v[208:211], v[36:39]
ds_read_b128 v[144:147], v5 offset:17408
ds_read_b128 v[148:151], v5 offset:18432
v_mfma_f32_16x16x32_bf16 v[40:43], v[164:167], v[204:207], v[40:43]
ds_read_b128 v[152:155], v5 offset:19456
ds_read_b128 v[156:159], v5 offset:20480
v_mfma_f32_16x16x32_bf16 v[44:47], v[164:167], v[208:211], v[44:47]
v_mul_f32 v238, 0x3acccccd, v116
v_mul_f32 v113, 0x3acccccd, v113
v_mfma_f32_16x16x32_bf16 v[48:51], v[168:171], v[204:207], v[48:51]
buffer_load_dwordx4 v0, s[4:7], s49 offen offset:1024 sc1 lds
v_mfma_f32_16x16x32_bf16 v[52:55], v[168:171], v[208:211], v[52:55]
ds_read_b128 v[160:163], v5 offset:21504
s_waitcnt lgkmcnt(6)
v_mfma_f32_16x16x32_bf16 v[56:59], v[204:207], v[172:175], v[56:59]
ds_read_b128 v[164:167], v5 offset:22528
v_mul_f32 v117, 0x3acccccd, v117
v_mfma_f32_16x16x32_bf16 v[60:63], v[208:211], v[172:175], v[60:63]
buffer_load_dwordx4 v0, s[4:7], s49 offen offset:2048 sc1 lds
v_mfma_f32_16x16x32_bf16 v[64:67], v[204:207], v[176:179], v[64:67]
ds_read_b128 v[168:171], v5 offset:23552
v_fma_f32 v113, -v236, v236, v113
v_mfma_f32_16x16x32_bf16 v[68:71], v[208:211], v[176:179], v[68:71]
v_fma_f32 v117, -v238, v238, v117
v_max_f32 v113, 0, v113
v_mfma_f32_16x16x32_bf16 v[72:75], v[204:207], v[136:139], v[72:75]
ds_read_b128 v[172:175], v0 offset:0
v_max_f32 v117, 0, v117
v_mfma_f32_16x16x32_bf16 v[76:79], v[208:211], v[136:139], v[76:79]
v_add_f32 v113, 0x3727c5ac, v113
s_waitcnt lgkmcnt(6)
s_waitcnt vmcnt(20)
v_mfma_f32_16x16x32_bf16 v[16:19], v[140:143], v[212:215], v[16:19]
buffer_load_dwordx4 v0, s[4:7], s49 offen offset:3072 sc1 lds
s_waitcnt vmcnt(20)
v_mfma_f32_16x16x32_bf16 v[20:23], v[140:143], v[216:219], v[20:23]
ds_read_b128 v[176:179], v0 offset:1024
v_add_f32 v117, 0x3727c5ac, v117
v_mfma_f32_16x16x32_bf16 v[24:27], v[144:147], v[212:215], v[24:27]
ds_read_b128 v[136:139], v0 offset:2048
v_mfma_f32_16x16x32_bf16 v[28:31], v[144:147], v[216:219], v[28:31]
v_rsq_f32 v237, v113
v_mfma_f32_16x16x32_bf16 v[32:35], v[148:151], v[212:215], v[32:35]
ds_read_b128 v[140:143], v0 offset:3072
ds_read_b128 v[188:191], v106 offset:128
v_mfma_f32_16x16x32_bf16 v[36:39], v[148:151], v[216:219], v[36:39]
ds_read_b128 v[192:195], v106 offset:192
s_waitcnt lgkmcnt(8)
v_mfma_f32_16x16x32_bf16 v[40:43], v[152:155], v[212:215], v[40:43]
ds_read_b128 v[144:147], v0 offset:4096
ds_read_b128 v[196:199], v106 offset:256
v_mfma_f32_16x16x32_bf16 v[44:47], v[152:155], v[216:219], v[44:47]
v_rsq_f32 v239, v117
v_mfma_f32_16x16x32_bf16 v[48:51], v[156:159], v[212:215], v[48:51]
ds_read_b128 v[148:151], v0 offset:5120
v_cndmask_b32 v114, v236, v237, s[66:67]
v_mfma_f32_16x16x32_bf16 v[52:55], v[156:159], v[216:219], v[52:55]
v_cndmask_b32 v118, v238, v239, s[66:67]
ds_write_b32 v108, v114 offset:0
v_mfma_f32_16x16x32_bf16 v[56:59], v[212:215], v[160:163], v[56:59]
ds_read_b128 v[152:155], v0 offset:6144
ds_write_b32 v108, v118 offset:128
v_mfma_f32_16x16x32_bf16 v[60:63], v[216:219], v[160:163], v[60:63]
v_mul_f32 v240, 0x3ea52b5c, v237
s_waitcnt lgkmcnt(11)
v_mfma_f32_16x16x32_bf16 v[64:67], v[212:215], v[164:167], v[64:67]
ds_read_b128 v[156:159], v0 offset:7168
v_mul_f32 v241, 0x3ea52b5c, v239
v_mfma_f32_16x16x32_bf16 v[68:71], v[216:219], v[164:167], v[68:71]
v_cndmask_b32_e64 v242, v237, 1.0, s[60:61]
v_cndmask_b32_e64 v243, v239, 1.0, s[60:61]
v_mfma_f32_16x16x32_bf16 v[72:75], v[212:215], v[168:171], v[72:75]
s_waitcnt lgkmcnt(1)
ds_read_b128 v[112:115], v109 offset:0
ds_read_b128 v[116:119], v109 offset:64
v_mfma_f32_16x16x32_bf16 v[76:79], v[216:219], v[168:171], v[76:79]
ds_read_b128 v[120:123], v109 offset:128
ds_read_b128 v[124:127], v109 offset:192
s_waitcnt vmcnt(19)
v_mfma_f32_16x16x32_bf16 v[16:19], v[172:175], v[220:223], v[16:19]
ds_read_b32 v228, v107 offset:320
ds_read_b32 v229, v107 offset:384
s_waitcnt vmcnt(18)
v_mfma_f32_16x16x32_bf16 v[20:23], v[172:175], v[224:227], v[20:23]
ds_read_b32 v230, v107 offset:448
v_mfma_f32_16x16x32_bf16 v[24:27], v[176:179], v[220:223], v[24:27]
ds_read_b128 v[180:183], v106 offset:0
ds_read_b128 v[184:187], v106 offset:64
v_mfma_f32_16x16x32_bf16 v[28:31], v[176:179], v[224:227], v[28:31]
v_mfma_f32_16x16x32_bf16 v[32:35], v[136:139], v[220:223], v[32:35]
v_mfma_f32_16x16x32_bf16 v[36:39], v[136:139], v[224:227], v[36:39]
v_mfma_f32_16x16x32_bf16 v[40:43], v[140:143], v[220:223], v[40:43]
v_mfma_f32_16x16x32_bf16 v[44:47], v[140:143], v[224:227], v[44:47]
v_mfma_f32_16x16x32_bf16 v[48:51], v[144:147], v[220:223], v[48:51]
v_mfma_f32_16x16x32_bf16 v[52:55], v[144:147], v[224:227], v[52:55]
v_mfma_f32_16x16x32_bf16 v[56:59], v[220:223], v[148:151], v[56:59]
v_mfma_f32_16x16x32_bf16 v[60:63], v[224:227], v[148:151], v[60:63]
v_mfma_f32_16x16x32_bf16 v[64:67], v[220:223], v[152:155], v[64:67]
v_mfma_f32_16x16x32_bf16 v[68:71], v[224:227], v[152:155], v[68:71]
s_waitcnt lgkmcnt(9)
v_mfma_f32_16x16x32_bf16 v[72:75], v[220:223], v[156:159], v[72:75]
v_mfma_f32_16x16x32_bf16 v[76:79], v[224:227], v[156:159], v[76:79]
C_p1e0:
v_pk_fma_f32 v[36:37], v[188:189], v[238:239], v[36:37] op_sel_hi:[1,0,1] neg_lo:[0,1,0] neg_hi:[0,1,0]
v_pk_fma_f32 v[38:39], v[190:191], v[238:239], v[38:39] op_sel_hi:[1,0,1] neg_lo:[0,1,0] neg_hi:[0,1,0]
v_pk_mul_f32 v[36:37], v[36:37], v[238:239] op_sel:[0,1] op_sel_hi:[1,1]
v_pk_mul_f32 v[38:39], v[38:39], v[238:239] op_sel:[0,1] op_sel_hi:[1,1]
v_cvt_pk_bf16_f32 v164, v36, v37
v_cvt_pk_bf16_f32 v165, v38, v39
v_pk_fma_f32 v[44:45], v[192:193], v[238:239], v[44:45] op_sel_hi:[1,0,1] neg_lo:[0,1,0] neg_hi:[0,1,0]
v_pk_fma_f32 v[46:47], v[194:195], v[238:239], v[46:47] op_sel_hi:[1,0,1] neg_lo:[0,1,0] neg_hi:[0,1,0]
v_pk_mul_f32 v[44:45], v[44:45], v[238:239] op_sel:[0,1] op_sel_hi:[1,1]
v_pk_mul_f32 v[46:47], v[46:47], v[238:239] op_sel:[0,1] op_sel_hi:[1,1]
v_cvt_pk_bf16_f32 v168, v44, v45
v_cvt_pk_bf16_f32 v169, v46, v47
v_pk_fma_f32 v[52:53], v[196:197], v[238:239], v[52:53] op_sel_hi:[1,0,1] neg_lo:[0,1,0] neg_hi:[0,1,0]
v_pk_fma_f32 v[54:55], v[198:199], v[238:239], v[54:55] op_sel_hi:[1,0,1] neg_lo:[0,1,0] neg_hi:[0,1,0]
v_pk_mul_f32 v[52:53], v[52:53], v[242:243] op_sel:[0,1] op_sel_hi:[1,1]
v_pk_mul_f32 v[54:55], v[54:55], v[242:243] op_sel:[0,1] op_sel_hi:[1,1]
v_cvt_pk_bf16_f32 v172, v52, v53
v_cvt_pk_bf16_f32 v173, v54, v55
v_cvt_pk_bf16_f32 v166, v52, v53
v_cvt_pk_bf16_f32 v167, v54, v55
v_cndmask_b32_e64 v146, 0, v172, s[56:57]
v_cndmask_b32_e64 v148, 0, v172, s[58:59]
v_cndmask_b32_e64 v147, 0, v173, s[56:57]
v_cndmask_b32_e64 v149, 0, v173, s[58:59]
s_waitcnt lgkmcnt(3)
v_pk_fma_f32 v[60:61], v[120:121], v[228:229], v[60:61] op_sel:[0,0,0] op_sel_hi:[1,0,1] neg_lo:[1,0,0] neg_hi:[1,0,0]
v_pk_fma_f32 v[62:63], v[122:123], v[228:229], v[62:63] op_sel:[0,0,0] op_sel_hi:[1,0,1] neg_lo:[1,0,0] neg_hi:[1,0,0]
v_pk_mul_f32 v[60:61], v[60:61], v[124:125]
v_pk_mul_f32 v[62:63], v[62:63], v[126:127]
v_cvt_pk_bf16_f32 v208, v60, v61
v_cvt_pk_bf16_f32 v209, v62, v63
v_pk_fma_f32 v[68:69], v[120:121], v[228:229], v[68:69] op_sel:[0,1,0] op_sel_hi:[1,1,1] neg_lo:[1,0,0] neg_hi:[1,0,0]
v_pk_fma_f32 v[70:71], v[122:123], v[228:229], v[70:71] op_sel:[0,1,0] op_sel_hi:[1,1,1] neg_lo:[1,0,0] neg_hi:[1,0,0]
v_pk_mul_f32 v[68:69], v[68:69], v[124:125]
v_pk_mul_f32 v[70:71], v[70:71], v[126:127]
v_cvt_pk_bf16_f32 v214, v68, v69
v_cvt_pk_bf16_f32 v215, v70, v71
s_waitcnt lgkmcnt(2)
v_pk_fma_f32 v[76:77], v[120:121], v[230:231], v[76:77] op_sel:[0,0,0] op_sel_hi:[1,0,1] neg_lo:[1,0,0] neg_hi:[1,0,0]
v_pk_fma_f32 v[78:79], v[122:123], v[230:231], v[78:79] op_sel:[0,0,0] op_sel_hi:[1,0,1] neg_lo:[1,0,0] neg_hi:[1,0,0]
v_pk_mul_f32 v[76:77], v[76:77], v[124:125]
v_pk_mul_f32 v[78:79], v[78:79], v[126:127]
v_cvt_pk_bf16_f32 v220, v76, v77
v_cvt_pk_bf16_f32 v221, v78, v79
v_permlane32_swap_b32 v172, v166
v_permlane32_swap_b32 v173, v167
v_cndmask_b32 v220, v220, v102, s[62:63]
v_cndmask_b32 v221, v221, v102, s[62:63]
s_add_u32 s54, s41, 0
s_cmp_lg_u32 s12, 3
s_cbranch_scc1 KX4
v_mov_b32 v80, v164
v_mov_b32 v81, v165
v_mov_b32 v82, v166
v_mov_b32 v83, s89
buffer_store_dwordx4 v[80:83], v0, s[4:7], s54 offen offset:0 sc1
v_mov_b32 v84, v167
v_mov_b32 v85, v168
v_mov_b32 v86, v169
v_mov_b32 v87, s89
buffer_store_dwordx4 v[84:87], v0, s[4:7], s54 offen offset:1024 sc1
v_mov_b32 v128, v208
v_mov_b32 v129, v209
v_mov_b32 v130, v214
v_mov_b32 v131, s89
buffer_store_dwordx4 v[128:131], v0, s[4:7], s54 offen offset:2048 sc1
v_mov_b32 v132, v215
v_mov_b32 v133, v220
v_mov_b32 v134, v221
v_mov_b32 v135, s89
buffer_store_dwordx4 v[132:135], v0, s[4:7], s54 offen offset:3072 sc1
KX4:
ds_write_b64 v100, v[164:165] offset:0
ds_write_b64 v100, v[166:167] offset:512
ds_write_b64 v100, v[168:169] offset:1024
ds_write_b64 v100, v[208:209] offset:1536
ds_write_b64 v100, v[214:215] offset:2048
ds_write_b64 v100, v[220:221] offset:2560
v_pk_fma_f32 v[32:33], v[188:189], v[236:237], v[32:33] op_sel_hi:[1,0,1] neg_lo:[0,1,0] neg_hi:[0,1,0]
v_pk_fma_f32 v[34:35], v[190:191], v[236:237], v[34:35] op_sel_hi:[1,0,1] neg_lo:[0,1,0] neg_hi:[0,1,0]
s_add_u32 m0, s85, 90112
s_add_u32 s49, s20, 16384
buffer_load_dwordx4 v0, s[4:7], s49 offen offset:0 sc1 lds
v_pk_mul_f32 v[32:33], v[32:33], v[236:237] op_sel:[0,1] op_sel_hi:[1,1]
v_pk_mul_f32 v[34:35], v[34:35], v[236:237] op_sel:[0,1] op_sel_hi:[1,1]
v_cvt_pk_bf16_f32 v158, v32, v33
v_cvt_pk_bf16_f32 v159, v34, v35
v_pk_fma_f32 v[40:41], v[192:193], v[236:237], v[40:41] op_sel_hi:[1,0,1] neg_lo:[0,1,0] neg_hi:[0,1,0]
v_pk_fma_f32 v[42:43], v[194:195], v[236:237], v[42:43] op_sel_hi:[1,0,1] neg_lo:[0,1,0] neg_hi:[0,1,0]
v_pk_mul_f32 v[40:41], v[40:41], v[236:237] op_sel:[0,1] op_sel_hi:[1,1]
v_pk_mul_f32 v[42:43], v[42:43], v[236:237] op_sel:[0,1] op_sel_hi:[1,1]
buffer_load_dwordx4 v0, s[4:7], s49 offen offset:1024 sc1 lds
v_cvt_pk_bf16_f32 v162, v40, v41
v_cvt_pk_bf16_f32 v163, v42, v43
v_pk_fma_f32 v[48:49], v[196:197], v[236:237], v[48:49] op_sel_hi:[1,0,1] neg_lo:[0,1,0] neg_hi:[0,1,0]
v_pk_fma_f32 v[50:51], v[198:199], v[236:237], v[50:51] op_sel_hi:[1,0,1] neg_lo:[0,1,0] neg_hi:[0,1,0]
v_pk_mul_f32 v[48:49], v[48:49], v[242:243] op_sel:[0,0] op_sel_hi:[1,0]
v_pk_mul_f32 v[50:51], v[50:51], v[242:243] op_sel:[0,0] op_sel_hi:[1,0]
v_cvt_pk_bf16_f32 v170, v48, v49
v_cvt_pk_bf16_f32 v171, v50, v51
buffer_load_dwordx4 v0, s[4:7], s49 offen offset:2048 sc1 lds
v_cvt_pk_bf16_f32 v160, v48, v49
v_cvt_pk_bf16_f32 v161, v50, v51
v_cndmask_b32_e64 v138, 0, v170, s[56:57]
v_cndmask_b32_e64 v140, 0, v170, s[58:59]
v_cndmask_b32_e64 v139, 0, v171, s[56:57]
v_cndmask_b32_e64 v141, 0, v171, s[58:59]
v_pk_fma_f32 v[56:57], v[112:113], v[228:229], v[56:57] op_sel:[0,0,0] op_sel_hi:[1,0,1] neg_lo:[1,0,0] neg_hi:[1,0,0]
v_pk_fma_f32 v[58:59], v[114:115], v[228:229], v[58:59] op_sel:[0,0,0] op_sel_hi:[1,0,1] neg_lo:[1,0,0] neg_hi:[1,0,0]
buffer_load_dwordx4 v0, s[4:7], s49 offen offset:3072 sc1 lds
v_pk_mul_f32 v[56:57], v[56:57], v[116:117]
v_pk_mul_f32 v[58:59], v[58:59], v[118:119]
v_cvt_pk_bf16_f32 v206, v56, v57
v_cvt_pk_bf16_f32 v207, v58, v59
v_pk_fma_f32 v[64:65], v[112:113], v[228:229], v[64:65] op_sel:[0,1,0] op_sel_hi:[1,1,1] neg_lo:[1,0,0] neg_hi:[1,0,0]
v_pk_fma_f32 v[66:67], v[114:115], v[228:229], v[66:67] op_sel:[0,1,0] op_sel_hi:[1,1,1] neg_lo:[1,0,0] neg_hi:[1,0,0]
v_pk_mul_f32 v[64:65], v[64:65], v[116:117]
v_pk_mul_f32 v[66:67], v[66:67], v[118:119]
s_add_u32 m0, s85, 106496
s_add_u32 s49, s20, 20480
buffer_load_dwordx4 v0, s[4:7], s49 offen offset:0 sc1 lds
v_cvt_pk_bf16_f32 v212, v64, v65
v_cvt_pk_bf16_f32 v213, v66, v67
v_pk_fma_f32 v[72:73], v[112:113], v[230:231], v[72:73] op_sel:[0,0,0] op_sel_hi:[1,0,1] neg_lo:[1,0,0] neg_hi:[1,0,0]
v_pk_fma_f32 v[74:75], v[114:115], v[230:231], v[74:75] op_sel:[0,0,0] op_sel_hi:[1,0,1] neg_lo:[1,0,0] neg_hi:[1,0,0]
v_pk_mul_f32 v[72:73], v[72:73], v[116:117]
v_pk_mul_f32 v[74:75], v[74:75], v[118:119]
v_cvt_pk_bf16_f32 v218, v72, v73
v_cvt_pk_bf16_f32 v219, v74, v75
buffer_load_dwordx4 v0, s[4:7], s49 offen offset:1024 sc1 lds
v_permlane32_swap_b32 v170, v160
v_permlane32_swap_b32 v171, v161
v_cndmask_b32 v218, v218, v102, s[62:63]
v_cndmask_b32 v219, v219, v102, s[62:63]
s_waitcnt lgkmcnt(7)
v_pk_fma_f32 v[20:21], v[180:181], v[238:239], v[20:21] op_sel_hi:[1,0,1] neg_lo:[0,1,0] neg_hi:[0,1,0]
v_pk_fma_f32 v[22:23], v[182:183], v[238:239], v[22:23] op_sel_hi:[1,0,1] neg_lo:[0,1,0] neg_hi:[0,1,0]
v_cvt_pk_bf16_f32 v144, v20, v21
v_cvt_pk_bf16_f32 v145, v22, v23
buffer_load_dwordx4 v0, s[4:7], s49 offen offset:2048 sc1 lds
s_waitcnt lgkmcnt(6)
v_pk_fma_f32 v[28:29], v[184:185], v[238:239], v[28:29] op_sel_hi:[1,0,1] neg_lo:[0,1,0] neg_hi:[0,1,0]
v_pk_fma_f32 v[30:31], v[186:187], v[238:239], v[30:31] op_sel_hi:[1,0,1] neg_lo:[0,1,0] neg_hi:[0,1,0]
v_cvt_pk_bf16_f32 v150, v28, v29
v_cvt_pk_bf16_f32 v151, v30, v31
v_pk_fma_f32 v[16:17], v[180:181], v[236:237], v[16:17] op_sel_hi:[1,0,1] neg_lo:[0,1,0] neg_hi:[0,1,0]
v_pk_fma_f32 v[18:19], v[182:183], v[236:237], v[18:19] op_sel_hi:[1,0,1] neg_lo:[0,1,0] neg_hi:[0,1,0]
v_cvt_pk_bf16_f32 v136, v16, v17
v_cvt_pk_bf16_f32 v137, v18, v19
buffer_load_dwordx4 v0, s[4:7], s49 offen offset:3072 sc1 lds
v_mfma_f32_16x16x32_bf16 v[36:39], v[164:167], v[144:147], v[88:91]
v_mfma_f32_16x16x32_bf16 v[32:35], v[158:161], v[144:147], v[92:95]
v_mfma_f32_16x16x32_bf16 v[44:47], v[166:169], v[148:151], v[88:91]
v_mfma_f32_16x16x32_bf16 v[40:43], v[160:163], v[148:151], v[92:95]
v_pk_fma_f32 v[24:25], v[184:185], v[236:237], v[24:25] op_sel_hi:[1,0,1] neg_lo:[0,1,0] neg_hi:[0,1,0]
v_pk_fma_f32 v[26:27], v[186:187], v[236:237], v[26:27] op_sel_hi:[1,0,1] neg_lo:[0,1,0] neg_hi:[0,1,0]
v_cvt_pk_bf16_f32 v142, v24, v25
v_cvt_pk_bf16_f32 v143, v26, v27
s_add_u32 m0, s44, 122880
s_add_u32 s49, s20, 24576
buffer_load_dwordx4 v0, s[4:7], s49 offen offset:0 sc1 lds
s_waitcnt lgkmcnt(0)
s_barrier
ds_read_b64 v[152:153], v101 offset:0
ds_read_b64 v[154:155], v101 offset:512
ds_read_b64 v[156:157], v101 offset:1024
ds_read_b64 v[204:205], v101 offset:1536
ds_read_b64 v[210:211], v101 offset:2048
ds_read_b64 v[216:217], v101 offset:2560
v_mfma_f32_16x16x32_bf16 v[20:23], v[158:161], v[136:139], v[88:91]
v_mfma_f32_16x16x32_bf16 v[28:31], v[160:163], v[140:143], v[88:91]
s_add_u32 s55, s17, 0
v_max_f32 v32, v32, v36
v_max_f32 v33, v33, v37
v_max_f32 v34, v34, v38
v_max_f32 v35, v35, v39
v_max_f32 v40, v40, v44
v_max_f32 v41, v41, v45
s_add_u32 m0, s43, 0
s_add_u32 s49, s19, 0
buffer_load_dwordx4 v0, s[4:7], s49 offen offset:0 sc1 lds
v_max_f32 v42, v42, v46
v_max_f32 v43, v43, v47
v_max3_f32 v172, v32, v33, v34
v_max3_f32 v173, v40, v41, v42
v_max_f32 v172, v172, v35
v_max_f32 v173, v173, v43
s_nop 1
v_permlane16_swap_b32 v172, v173
v_max_f32 v172, v172, v173
buffer_load_dwordx4 v0, s[4:7], s49 offen offset:1024 sc1 lds
v_mov_b32 v173, v172
s_nop 1
v_permlane32_swap_b32 v172, v173
v_max_f32 v172, v172, v173
v_mul_f32_e64 v172, -v172, v241
v_mov_b32 v173, v172
s_nop 1
v_permlane16_swap_b32 v172, v173
v_fma_f32 v32, v32, v241, v172
v_fma_f32 v33, v33, v241, v172
buffer_load_dwordx4 v0, s[4:7], s49 offen offset:2048 sc1 lds
v_fma_f32 v34, v34, v241, v172
v_fma_f32 v35, v35, v241, v172
v_exp_f32 v32, v32
v_exp_f32 v33, v33
v_exp_f32 v34, v34
v_exp_f32 v35, v35
v_fma_f32 v40, v40, v241, v173
v_fma_f32 v41, v41, v241, v173
s_add_u32 m0, s43, 12288
s_add_u32 s49, s19, 12288
buffer_load_dwordx4 v0, s[4:7], s49 offen offset:0 sc1 lds
v_fma_f32 v42, v42, v241, v173
v_fma_f32 v43, v43, v241, v173
v_exp_f32 v40, v40
v_exp_f32 v41, v41
v_exp_f32 v42, v42
v_exp_f32 v43, v43
v_cvt_pk_bf16_f32 v36, v32, v33
v_cvt_pk_bf16_f32 v37, v34, v35
buffer_load_dwordx4 v0, s[4:7], s49 offen offset:1024 sc1 lds
v_and_b32 v58, v104, v36
v_and_b32 v59, v105, v37
v_bfi_b32 v56, v104, 0, v36
v_bfi_b32 v57, v105, 0, v37
v_cvt_pk_bf16_f32 v44, v40, v41
v_cvt_pk_bf16_f32 v45, v42, v43
v_and_b32 v62, v104, v44
v_and_b32 v63, v105, v45
buffer_load_dwordx4 v0, s[4:7], s49 offen offset:2048 sc1 lds
v_bfi_b32 v60, v104, 0, v44
v_bfi_b32 v61, v105, 0, v45
v_mfma_f32_16x16x32_bf16 v[120:123], v[218:221], v[56:59], 0
s_nop 0
v_mfma_f32_16x16x32_bf16 v[124:127], v[218:221], v[60:63], 0
v_mfma_f32_16x16x32_bf16 v[72:75], v[206:209], v[56:59], 0
v_mfma_f32_16x16x32_bf16 v[76:79], v[212:215], v[60:63], 0
v_add_u32 v196, 20480, v11
s_nop 2
v_mov_b32 v176, v120
s_nop 0
v_mov_b32 v177, v124
v_permlane32_swap_b32 v120, v176
s_nop 0
v_permlane32_swap_b32 v124, v177
v_rcp_f32 v176, v176
v_rcp_f32 v177, v177
v_cndmask_b32 v120, v124, v120, s[56:57]
v_cndmask_b32 v121, v125, v121, s[56:57]
v_cndmask_b32 v122, v126, v122, s[56:57]
v_cndmask_b32 v123, v127, v123, s[56:57]
v_pk_mul_f32 v[72:73], v[72:73], v[176:177] op_sel:[0,0] op_sel_hi:[1,0]
v_pk_mul_f32 v[74:75], v[74:75], v[176:177] op_sel:[0,0] op_sel_hi:[1,0]
v_cvt_pk_bf16_f32 v184, v72, v73
v_cvt_pk_bf16_f32 v185, v74, v75
v_pk_mul_f32 v[76:77], v[76:77], v[176:177] op_sel:[0,1] op_sel_hi:[1,1]
v_pk_mul_f32 v[78:79], v[78:79], v[176:177] op_sel:[0,1] op_sel_hi:[1,1]
v_cvt_pk_bf16_f32 v186, v76, v77
v_cvt_pk_bf16_f32 v187, v78, v79
buffer_store_dwordx4 v[184:187], v1, s[4:7], s37 offen
v_cndmask_b32 v194, v177, v176, s[56:57]
v_pk_mul_f32 v[120:121], v[120:121], v[194:195] op_sel_hi:[1,0]
v_pk_mul_f32 v[122:123], v[122:123], v[194:195] op_sel_hi:[1,0]
v_cvt_pk_bf16_f32 v190, v120, v121
v_cvt_pk_bf16_f32 v191, v122, v123
s_mov_b32 exec_hi, 0
buffer_store_dwordx2 v[190:191], v196, s[4:7], s38 offen
s_mov_b32 exec_hi, -1
s_waitcnt lgkmcnt(0)
s_cmp_eq_u32 s34, 0
s_cbranch_scc1 KX7
KX6:
buffer_load_dwordx4 v[80:83], v0, s[4:7], s55 offen offset:0 sc1
buffer_load_dwordx4 v[84:87], v0, s[4:7], s55 offen offset:1024 sc1
buffer_load_dwordx4 v[128:131], v0, s[4:7], s55 offen offset:2048 sc1
buffer_load_dwordx4 v[132:135], v0, s[4:7], s55 offen offset:3072 sc1
s_waitcnt vmcnt(0)
v_xor_b32 v83, s89, v83
v_xor_b32 v87, s89, v87
v_xor_b32 v131, s89, v131
v_xor_b32 v135, s89, v135
v_or3_b32 v83, v83, v87, v131
v_or_b32 v83, v83, v135
v_cmp_ne_u32 vcc, 0, v83
s_nop 1
s_cmp_eq_u64 vcc, 0
s_cbranch_scc1 KX7a
s_sub_u32 s45, s45, 1
s_cbranch_scc0 KX6
s_mov_b32 s45, 0
KX7a:
v_mov_b32 v152, v80
v_mov_b32 v153, v81
v_mov_b32 v154, v82
v_mov_b32 v155, v84
v_mov_b32 v156, v85
v_mov_b32 v157, v86
v_mov_b32 v204, v128
v_mov_b32 v205, v129
v_mov_b32 v210, v130
v_mov_b32 v211, v132
v_mov_b32 v216, v133
v_mov_b32 v217, v134
s_nop 1
KX7:
v_mfma_f32_16x16x32_bf16 v[16:19], v[152:155], v[136:139], v[96:99]
v_mfma_f32_16x16x32_bf16 v[24:27], v[154:157], v[140:143], v[96:99]
s_nop 6
v_max_f32 v16, v16, v20
v_max_f32 v17, v17, v21
v_max_f32 v18, v18, v22
v_max_f32 v19, v19, v23
v_max_f32 v24, v24, v28
v_max_f32 v25, v25, v29
v_max_f32 v26, v26, v30
v_max_f32 v27, v27, v31
v_max3_f32 v170, v16, v17, v18
v_max3_f32 v171, v24, v25, v26
v_max_f32 v170, v170, v19
v_max_f32 v171, v171, v27
s_nop 1
v_permlane16_swap_b32 v170, v171
v_max_f32 v170, v170, v171
v_mov_b32 v171, v170
s_nop 1
v_permlane32_swap_b32 v170, v171
v_max_f32 v170, v170, v171
v_mul_f32_e64 v170, -v170, v240
v_mov_b32 v171, v170
s_nop 1
v_permlane16_swap_b32 v170, v171
v_fma_f32 v16, v16, v240, v170
v_fma_f32 v17, v17, v240, v170
v_fma_f32 v18, v18, v240, v170
v_fma_f32 v19, v19, v240, v170
v_exp_f32 v16, v16
v_exp_f32 v17, v17
v_exp_f32 v18, v18
v_exp_f32 v19, v19
v_fma_f32 v24, v24, v240, v171
v_fma_f32 v25, v25, v240, v171
v_fma_f32 v26, v26, v240, v171
v_fma_f32 v27, v27, v240, v171
v_exp_f32 v24, v24
v_exp_f32 v25, v25
v_exp_f32 v26, v26
v_exp_f32 v27, v27
v_cvt_pk_bf16_f32 v20, v16, v17
v_cvt_pk_bf16_f32 v21, v18, v19
v_and_b32 v50, v104, v20
v_and_b32 v51, v105, v21
v_bfi_b32 v48, v104, 0, v20
v_bfi_b32 v49, v105, 0, v21
v_cvt_pk_bf16_f32 v28, v24, v25
v_cvt_pk_bf16_f32 v29, v26, v27
v_and_b32 v54, v104, v28
v_and_b32 v55, v105, v29
v_bfi_b32 v52, v104, 0, v28
v_bfi_b32 v53, v105, 0, v29
v_mfma_f32_16x16x32_bf16 v[112:115], v[216:219], v[48:51], 0
s_nop 0
v_mfma_f32_16x16x32_bf16 v[116:119], v[216:219], v[52:55], 0
v_mfma_f32_16x16x32_bf16 v[64:67], v[204:207], v[48:51], 0
v_mfma_f32_16x16x32_bf16 v[68:71], v[210:213], v[52:55], 0
s_nop 3
v_mov_b32 v174, v112
s_nop 0
v_mov_b32 v175, v116
v_permlane32_swap_b32 v112, v174
s_nop 0
v_permlane32_swap_b32 v116, v175
v_rcp_f32 v174, v174
v_rcp_f32 v175, v175
v_cndmask_b32 v112, v116, v112, s[56:57]
v_cndmask_b32 v113, v117, v113, s[56:57]
v_cndmask_b32 v114, v118, v114, s[56:57]
v_cndmask_b32 v115, v119, v115, s[56:57]
v_pk_mul_f32 v[64:65], v[64:65], v[174:175] op_sel:[0,0] op_sel_hi:[1,0]
v_pk_mul_f32 v[66:67], v[66:67], v[174:175] op_sel:[0,0] op_sel_hi:[1,0]
v_cvt_pk_bf16_f32 v180, v64, v65
v_cvt_pk_bf16_f32 v181, v66, v67
v_pk_mul_f32 v[68:69], v[68:69], v[174:175] op_sel:[0,1] op_sel_hi:[1,1]
v_pk_mul_f32 v[70:71], v[70:71], v[174:175] op_sel:[0,1] op_sel_hi:[1,1]
v_cvt_pk_bf16_f32 v182, v68, v69
v_cvt_pk_bf16_f32 v183, v70, v71
buffer_store_dwordx4 v[180:183], v0, s[4:7], s37 offen
v_cndmask_b32 v192, v175, v174, s[56:57]
v_pk_mul_f32 v[112:113], v[112:113], v[192:193] op_sel_hi:[1,0]
v_pk_mul_f32 v[114:115], v[114:115], v[192:193] op_sel_hi:[1,0]
v_cvt_pk_bf16_f32 v188, v112, v113
v_cvt_pk_bf16_f32 v189, v114, v115
s_mov_b32 exec_hi, 0
buffer_store_dwordx2 v[188:189], v11, s[4:7], s38 offen
s_mov_b32 exec_hi, -1
v_add_u32 v16, s85, v0
v_add_u32 v17, s85, v4
v_add_u32 v18, s44, v4
s_waitcnt vmcnt(10)
ds_read_b128 v[128:131], v16 offset:24576
ds_read_b128 v[132:135], v16 offset:25600
ds_read_b128 v[136:139], v16 offset:26624
ds_read_b128 v[140:143], v16 offset:27648
ds_read_b128 v[144:147], v16 offset:40960
ds_read_b128 v[148:151], v16 offset:41984
ds_read_b128 v[152:155], v16 offset:43008
ds_read_b128 v[156:159], v16 offset:44032
ds_read_b128 v[160:163], v16 offset:57344
ds_read_b128 v[164:167], v16 offset:58368
ds_read_b128 v[168:171], v16 offset:59392
ds_read_b128 v[172:175], v16 offset:60416
ds_read_b128 v[176:179], v17 offset:8192
ds_read_b128 v[180:183], v17 offset:9216
ds_read_b128 v[184:187], v17 offset:10240
ds_read_b128 v[188:191], v17 offset:11264
ds_read_b128 v[192:195], v17 offset:24576
ds_read_b128 v[196:199], v17 offset:25600
ds_read_b128 v[200:203], v17 offset:26624
ds_read_b128 v[204:207], v17 offset:27648
ds_read_b128 v[208:211], v17 offset:40960
ds_read_b128 v[212:215], v17 offset:41984
ds_read_b128 v[216:219], v17 offset:43008
ds_read_b128 v[220:223], v17 offset:44032
ds_read_b128 v[224:227], v18 offset:57344
s_add_u32 s48, s12, 1
s_and_b32 s48, s48, 3
s_mul_i32 s48, s48, 15360
s_add_u32 s48, s48, 98304
v_add_u32 v228, s48, v0
s_add_u32 s48, s12, 2
s_and_b32 s48, s48, 3
s_mul_i32 s48, s48, 15360
s_add_u32 s48, s48, 103424
v_add_u32 v229, s48, v0
s_add_u32 s48, s12, 3
s_and_b32 s48, s48, 3
s_mul_i32 s48, s48, 15360
s_add_u32 s48, s48, 108544
v_add_u32 v230, s48, v0
s_mul_i32 s48, s12, 15360
s_add_u32 s48, s48, 98304
v_add_u32 v231, s48, v0
v_lshlrev_b32 v232, 5, v9
v_and_b32 v233, 0x180, v232
s_lshl_b32 s54, s14, 2
s_add_u32 s54, s54, s40
s_add_u32 s54, s54, 0
s_waitcnt vmcnt(0) lgkmcnt(0)
s_barrier
s_cmp_lg_u32 s12, 0
s_cbranch_scc1 SY8
s_mov_b64 exec, 1
s_cmp_eq_u32 s15, 0
s_cbranch_scc1 SY10
buffer_store_dword v10, off, s[4:7], s54
s_branch SY11
SY10:
buffer_wbl2 sc1
s_waitcnt vmcnt(0)
buffer_store_dword v10, off, s[4:7], s54 sc1
SY11:
s_mov_b64 exec, -1
s_add_u32 s48, s40, 0
PL12:
buffer_load_dword v18, v9, s[4:7], s48 offen sc1
s_waitcnt vmcnt(0)
v_cmp_ne_u32 vcc, s89, v18
s_nop 1
s_cmp_eq_u64 vcc, 0
s_cbranch_scc1 PL13
s_sub_u32 s45, s45, 1
s_cbranch_scc0 PL12
s_mov_b32 s45, 0
PL13:
s_cmp_lg_u32 s15, 0
s_cbranch_scc1 SY9
buffer_inv sc1
s_waitcnt vmcnt(0)
s_branch SY9
SY8:
SY9:
s_barrier
s_add_u32 s51, s22, 2621440
buffer_load_dwordx4 v[56:59], v0, s[4:7], s51 offen offset:0 sc1
buffer_load_dwordx4 v[60:63], v0, s[4:7], s51 offen offset:1024 sc1
buffer_load_dwordx4 v[64:67], v0, s[4:7], s51 offen offset:2048 sc1
buffer_load_dwordx4 v[68:71], v0, s[4:7], s51 offen offset:3072 sc1
s_add_u32 s51, s22, 2625536
buffer_load_dwordx4 v[72:75], v0, s[4:7], s51 offen offset:0 sc1
s_add_u32 s51, s23, 2621440
buffer_load_dwordx4 v[76:79], v0, s[4:7], s51 offen offset:0 sc1
s_waitcnt vmcnt(5)
v_mfma_f32_16x16x32_bf16 v[16:19], v[128:131], v[56:59], 0
buffer_load_dwordx4 v[80:83], v0, s[4:7], s51 offen offset:1024 sc1
v_mfma_f32_16x16x32_bf16 v[20:23], v[132:135], v[56:59], 0
v_mfma_f32_16x16x32_bf16 v[24:27], v[136:139], v[56:59], 0
buffer_load_dwordx4 v[246:249], v0, s[4:7], s30 offen sc1
v_mfma_f32_16x16x32_bf16 v[28:31], v[140:143], v[56:59], 0
v_mfma_f32_16x16x32_bf16 v[32:35], v[144:147], v[56:59], 0
s_waitcnt vmcnt(6)
v_mfma_f32_16x16x32_bf16 v[16:19], v[148:151], v[60:63], v[16:19]
buffer_load_dwordx4 v[84:87], v0, s[4:7], s51 offen offset:2048 sc1
v_mfma_f32_16x16x32_bf16 v[20:23], v[152:155], v[60:63], v[20:23]
v_mfma_f32_16x16x32_bf16 v[24:27], v[156:159], v[60:63], v[24:27]
buffer_load_dwordx4 v[250:253], v0, s[4:7], s30 offen offset:1024 sc1
v_mfma_f32_16x16x32_bf16 v[28:31], v[160:163], v[60:63], v[28:31]
v_mfma_f32_16x16x32_bf16 v[32:35], v[164:167], v[60:63], v[32:35]
s_waitcnt vmcnt(7)
v_mfma_f32_16x16x32_bf16 v[16:19], v[168:171], v[64:67], v[16:19]
buffer_load_dwordx4 v[88:91], v0, s[4:7], s51 offen offset:3072 sc1
v_mfma_f32_16x16x32_bf16 v[20:23], v[172:175], v[64:67], v[20:23]
v_mfma_f32_16x16x32_bf16 v[24:27], v[176:179], v[64:67], v[24:27]
buffer_load_dwordx2 v[254:255], v11, s[4:7], s31 offen sc1
v_mfma_f32_16x16x32_bf16 v[28:31], v[180:183], v[64:67], v[28:31]
s_add_u32 s51, s23, 2625536
v_mfma_f32_16x16x32_bf16 v[32:35], v[184:187], v[64:67], v[32:35]
s_waitcnt vmcnt(8)
v_mfma_f32_16x16x32_bf16 v[16:19], v[188:191], v[68:71], v[16:19]
buffer_load_dwordx4 v[92:95], v0, s[4:7], s51 offen offset:0 sc1
v_mfma_f32_16x16x32_bf16 v[20:23], v[192:195], v[68:71], v[20:23]
v_mfma_f32_16x16x32_bf16 v[24:27], v[196:199], v[68:71], v[24:27]
s_add_u32 s53, s32, 21102592
buffer_load_dword v234, off, s[4:7], s53
v_mfma_f32_16x16x32_bf16 v[28:31], v[200:203], v[68:71], v[28:31]
s_add_u32 s51, s24, 2621440
v_mfma_f32_16x16x32_bf16 v[32:35], v[204:207], v[68:71], v[32:35]
s_waitcnt vmcnt(9)
v_mfma_f32_16x16x32_bf16 v[16:19], v[208:211], v[72:75], v[16:19]
buffer_load_dwordx4 v[96:99], v0, s[4:7], s51 offen offset:0 sc1
v_mfma_f32_16x16x32_bf16 v[20:23], v[212:215], v[72:75], v[20:23]
v_mfma_f32_16x16x32_bf16 v[24:27], v[216:219], v[72:75], v[24:27]
v_mfma_f32_16x16x32_bf16 v[28:31], v[220:223], v[72:75], v[28:31]
v_mfma_f32_16x16x32_bf16 v[32:35], v[224:227], v[72:75], v[32:35]
s_waitcnt vmcnt(9)
v_mfma_f32_16x16x32_bf16 v[36:39], v[128:131], v[76:79], 0
buffer_load_dwordx4 v[100:103], v0, s[4:7], s51 offen offset:1024 sc1
v_mfma_f32_16x16x32_bf16 v[40:43], v[132:135], v[76:79], 0
v_mfma_f32_16x16x32_bf16 v[44:47], v[136:139], v[76:79], 0
v_mfma_f32_16x16x32_bf16 v[48:51], v[140:143], v[76:79], 0
ds_write_b128 v228, v[16:19] offset:0
v_mfma_f32_16x16x32_bf16 v[52:55], v[144:147], v[76:79], 0
s_waitcnt vmcnt(9)
v_mfma_f32_16x16x32_bf16 v[36:39], v[148:151], v[80:83], v[36:39]
buffer_load_dwordx4 v[104:107], v0, s[4:7], s51 offen offset:2048 sc1
v_mfma_f32_16x16x32_bf16 v[40:43], v[152:155], v[80:83], v[40:43]
ds_write_b128 v228, v[20:23] offset:1024
v_mfma_f32_16x16x32_bf16 v[44:47], v[156:159], v[80:83], v[44:47]
ds_write_b128 v228, v[24:27] offset:2048
v_mfma_f32_16x16x32_bf16 v[48:51], v[160:163], v[80:83], v[48:51]
ds_write_b128 v228, v[28:31] offset:3072
v_mfma_f32_16x16x32_bf16 v[52:55], v[164:167], v[80:83], v[52:55]
s_waitcnt vmcnt(8)
v_mfma_f32_16x16x32_bf16 v[36:39], v[168:171], v[84:87], v[36:39]
buffer_load_dwordx4 v[108:111], v0, s[4:7], s51 offen offset:3072 sc1
v_mfma_f32_16x16x32_bf16 v[40:43], v[172:175], v[84:87], v[40:43]
s_add_u32 s51, s24, 2625536
v_mfma_f32_16x16x32_bf16 v[44:47], v[176:179], v[84:87], v[44:47]
ds_write_b128 v228, v[32:35] offset:4096
v_mfma_f32_16x16x32_bf16 v[48:51], v[180:183], v[84:87], v[48:51]
v_mfma_f32_16x16x32_bf16 v[52:55], v[184:187], v[84:87], v[52:55]
s_waitcnt vmcnt(7)
v_mfma_f32_16x16x32_bf16 v[36:39], v[188:191], v[88:91], v[36:39]
buffer_load_dwordx4 v[112:115], v0, s[4:7], s51 offen offset:0 sc1
v_mfma_f32_16x16x32_bf16 v[40:43], v[192:195], v[88:91], v[40:43]
s_add_u32 s51, s25, 2621440
v_mfma_f32_16x16x32_bf16 v[44:47], v[196:199], v[88:91], v[44:47]
v_mfma_f32_16x16x32_bf16 v[48:51], v[200:203], v[88:91], v[48:51]
v_mfma_f32_16x16x32_bf16 v[52:55], v[204:207], v[88:91], v[52:55]
s_waitcnt vmcnt(6)
v_mfma_f32_16x16x32_bf16 v[36:39], v[208:211], v[92:95], v[36:39]
buffer_load_dwordx4 v[116:119], v0, s[4:7], s51 offen offset:0 sc1
v_mfma_f32_16x16x32_bf16 v[40:43], v[212:215], v[92:95], v[40:43]
v_mfma_f32_16x16x32_bf16 v[44:47], v[216:219], v[92:95], v[44:47]
v_mfma_f32_16x16x32_bf16 v[48:51], v[220:223], v[92:95], v[48:51]
v_mfma_f32_16x16x32_bf16 v[52:55], v[224:227], v[92:95], v[52:55]
s_waitcnt vmcnt(5)
v_mfma_f32_16x16x32_bf16 v[16:19], v[128:131], v[96:99], 0
buffer_load_dwordx4 v[120:123], v0, s[4:7], s51 offen offset:1024 sc1
v_mfma_f32_16x16x32_bf16 v[20:23], v[132:135], v[96:99], 0
v_mfma_f32_16x16x32_bf16 v[24:27], v[136:139], v[96:99], 0
v_mfma_f32_16x16x32_bf16 v[28:31], v[140:143], v[96:99], 0
ds_write_b128 v229, v[36:39] offset:0
v_mfma_f32_16x16x32_bf16 v[32:35], v[144:147], v[96:99], 0
s_waitcnt vmcnt(5)
v_mfma_f32_16x16x32_bf16 v[16:19], v[148:151], v[100:103], v[16:19]
buffer_load_dwordx4 v[124:127], v0, s[4:7], s51 offen offset:2048 sc1
v_mfma_f32_16x16x32_bf16 v[20:23], v[152:155], v[100:103], v[20:23]
ds_write_b128 v229, v[40:43] offset:1024
v_mfma_f32_16x16x32_bf16 v[24:27], v[156:159], v[100:103], v[24:27]
ds_write_b128 v229, v[44:47] offset:2048
v_mfma_f32_16x16x32_bf16 v[28:31], v[160:163], v[100:103], v[28:31]
ds_write_b128 v229, v[48:51] offset:3072
v_mfma_f32_16x16x32_bf16 v[32:35], v[164:167], v[100:103], v[32:35]
s_waitcnt vmcnt(5)
v_mfma_f32_16x16x32_bf16 v[16:19], v[168:171], v[104:107], v[16:19]
buffer_load_dwordx4 v[56:59], v0, s[4:7], s51 offen offset:3072 sc1
v_mfma_f32_16x16x32_bf16 v[20:23], v[172:175], v[104:107], v[20:23]
s_add_u32 s51, s25, 2625536
v_mfma_f32_16x16x32_bf16 v[24:27], v[176:179], v[104:107], v[24:27]
ds_write_b128 v229, v[52:55] offset:4096
v_mfma_f32_16x16x32_bf16 v[28:31], v[180:183], v[104:107], v[28:31]
v_lshlrev_b32 v36, 16, v246
v_and_b32 v37, 0xffff0000, v246
v_mfma_f32_16x16x32_bf16 v[32:35], v[184:187], v[104:107], v[32:35]
v_lshlrev_b32 v38, 16, v247
s_waitcnt vmcnt(5)
v_mfma_f32_16x16x32_bf16 v[16:19], v[188:191], v[108:111], v[16:19]
buffer_load_dwordx4 v[60:63], v0, s[4:7], s51 offen offset:0 sc1
v_mfma_f32_16x16x32_bf16 v[20:23], v[192:195], v[108:111], v[20:23]
s_add_u32 m0, s43, 24576
s_add_u32 s49, s19, 24576
v_mfma_f32_16x16x32_bf16 v[24:27], v[196:199], v[108:111], v[24:27]
v_and_b32 v39, 0xffff0000, v247
v_lshlrev_b32 v40, 16, v248
v_mfma_f32_16x16x32_bf16 v[28:31], v[200:203], v[108:111], v[28:31]
v_and_b32 v41, 0xffff0000, v248
v_lshlrev_b32 v42, 16, v249
v_mfma_f32_16x16x32_bf16 v[32:35], v[204:207], v[108:111], v[32:35]
v_and_b32 v43, 0xffff0000, v249
v_lshlrev_b32 v44, 16, v250
v_and_b32 v45, 0xffff0000, v250
s_waitcnt vmcnt(5)
v_mfma_f32_16x16x32_bf16 v[16:19], v[208:211], v[112:115], v[16:19]
buffer_load_dwordx4 v0, s[4:7], s49 offen offset:0 sc1 lds
v_lshlrev_b32 v46, 16, v251
v_mfma_f32_16x16x32_bf16 v[20:23], v[212:215], v[112:115], v[20:23]
v_and_b32 v47, 0xffff0000, v251
v_lshlrev_b32 v48, 16, v252
v_and_b32 v49, 0xffff0000, v252
v_lshlrev_b32 v50, 16, v253
v_mfma_f32_16x16x32_bf16 v[24:27], v[216:219], v[112:115], v[24:27]
buffer_load_dwordx4 v0, s[4:7], s49 offen offset:1024 sc1 lds
v_and_b32 v51, 0xffff0000, v253
v_lshlrev_b32 v52, 16, v254
v_mfma_f32_16x16x32_bf16 v[28:31], v[220:223], v[112:115], v[28:31]
v_and_b32 v53, 0xffff0000, v254
v_lshlrev_b32 v54, 16, v255
v_and_b32 v55, 0xffff0000, v255
v_mfma_f32_16x16x32_bf16 v[32:35], v[224:227], v[112:115], v[32:35]
buffer_load_dwordx4 v0, s[4:7], s49 offen offset:2048 sc1 lds
s_waitcnt vmcnt(7)
v_mfma_f32_16x16x32_bf16 v[36:39], v[128:131], v[116:119], v[36:39]
s_add_u32 m0, s43, 36864
s_add_u32 s49, s19, 36864
v_mfma_f32_16x16x32_bf16 v[40:43], v[132:135], v[116:119], v[40:43]
buffer_load_dwordx4 v0, s[4:7], s49 offen offset:0 sc1 lds
v_mfma_f32_16x16x32_bf16 v[44:47], v[136:139], v[116:119], v[44:47]
v_mfma_f32_16x16x32_bf16 v[48:51], v[140:143], v[116:119], v[48:51]
buffer_load_dwordx4 v0, s[4:7], s49 offen offset:1024 sc1 lds
v_mfma_f32_16x16x32_bf16 v[52:55], v[144:147], v[116:119], v[52:55]
s_waitcnt vmcnt(8)
v_mfma_f32_16x16x32_bf16 v[36:39], v[148:151], v[120:123], v[36:39]
buffer_load_dwordx4 v0, s[4:7], s49 offen offset:2048 sc1 lds
v_mfma_f32_16x16x32_bf16 v[40:43], v[152:155], v[120:123], v[40:43]
s_add_u32 m0, s43, 49152
s_add_u32 s49, s19, 49152
v_mfma_f32_16x16x32_bf16 v[44:47], v[156:159], v[120:123], v[44:47]
buffer_load_dwordx4 v0, s[4:7], s49 offen offset:0 sc1 lds
v_mfma_f32_16x16x32_bf16 v[48:51], v[160:163], v[120:123], v[48:51]
ds_write_b128 v230, v[16:19] offset:0
v_mfma_f32_16x16x32_bf16 v[52:55], v[164:167], v[120:123], v[52:55]
buffer_load_dwordx4 v0, s[4:7], s49 offen offset:1024 sc1 lds
s_waitcnt vmcnt(10)
v_mfma_f32_16x16x32_bf16 v[36:39], v[168:171], v[124:127], v[36:39]
ds_write_b128 v230, v[20:23] offset:1024
v_mfma_f32_16x16x32_bf16 v[40:43], v[172:175], v[124:127], v[40:43]
buffer_load_dwordx4 v0, s[4:7], s49 offen offset:2048 sc1 lds
v_mfma_f32_16x16x32_bf16 v[44:47], v[176:179], v[124:127], v[44:47]
ds_write_b128 v230, v[24:27] offset:2048
ds_write_b128 v230, v[28:31] offset:3072
ds_write_b128 v230, v[32:35] offset:4096
v_mfma_f32_16x16x32_bf16 v[48:51], v[180:183], v[124:127], v[48:51]
s_waitcnt lgkmcnt(0)
s_barrier
v_mfma_f32_16x16x32_bf16 v[52:55], v[184:187], v[124:127], v[52:55]
ds_read_b128 v[64:67], v231 offset:0
s_waitcnt vmcnt(10)
v_mfma_f32_16x16x32_bf16 v[36:39], v[188:191], v[56:59], v[36:39]
ds_read_b128 v[84:87], v231 offset:5120
ds_read_b128 v[16:19], v231 offset:10240
v_mfma_f32_16x16x32_bf16 v[40:43], v[192:195], v[56:59], v[40:43]
ds_read_b128 v[68:71], v231 offset:1024
ds_read_b128 v[88:91], v231 offset:6144
v_mfma_f32_16x16x32_bf16 v[44:47], v[196:199], v[56:59], v[44:47]
ds_read_b128 v[20:23], v231 offset:11264
ds_read_b128 v[72:75], v231 offset:2048
v_mfma_f32_16x16x32_bf16 v[48:51], v[200:203], v[56:59], v[48:51]
ds_read_b128 v[92:95], v231 offset:7168
ds_read_b128 v[24:27], v231 offset:12288
v_mfma_f32_16x16x32_bf16 v[52:55], v[204:207], v[56:59], v[52:55]
ds_read_b128 v[76:79], v231 offset:3072
s_waitcnt vmcnt(9)
v_mfma_f32_16x16x32_bf16 v[36:39], v[208:211], v[60:63], v[36:39]
ds_read_b128 v[96:99], v231 offset:8192
ds_read_b128 v[28:31], v231 offset:13312
v_mfma_f32_16x16x32_bf16 v[40:43], v[212:215], v[60:63], v[40:43]
ds_read_b128 v[80:83], v231 offset:4096
ds_read_b128 v[100:103], v231 offset:9216
v_mfma_f32_16x16x32_bf16 v[44:47], v[216:219], v[60:63], v[44:47]
ds_read_b128 v[32:35], v231 offset:14336
v_mfma_f32_16x16x32_bf16 v[48:51], v[220:223], v[60:63], v[48:51]
v_mfma_f32_16x16x32_bf16 v[52:55], v[224:227], v[60:63], v[52:55]
s_waitcnt lgkmcnt(13)
v_add_f32 v64, v64, v84
v_add_f32 v65, v65, v85
v_add_f32 v66, v66, v86
v_add_f32 v67, v67, v87
s_waitcnt lgkmcnt(10)
v_add_f32 v68, v68, v88
v_add_f32 v69, v69, v89
v_add_f32 v70, v70, v90
v_add_f32 v71, v71, v91
s_waitcnt lgkmcnt(7)
v_add_f32 v72, v72, v92
v_add_f32 v73, v73, v93
s_add_u32 s50, s21, 0
buffer_load_dwordx4 a[0:3], v0, s[4:7], s50 offen offset:0 sc1
v_add_f32 v74, v74, v94
v_add_f32 v75, v75, v95
s_waitcnt lgkmcnt(4)
v_add_f32 v76, v76, v96
v_add_f32 v77, v77, v97
v_add_f32 v78, v78, v98
v_add_f32 v79, v79, v99
s_waitcnt lgkmcnt(1)
v_add_f32 v80, v80, v100
v_add_f32 v81, v81, v101
v_add_f32 v82, v82, v102
v_add_f32 v83, v83, v103
buffer_load_dwordx4 a[4:7], v0, s[4:7], s50 offen offset:1024 sc1
v_add_f32 v64, v64, v16
v_add_f32 v65, v65, v17
v_add_f32 v66, v66, v18
v_add_f32 v67, v67, v19
v_add_f32 v68, v68, v20
v_add_f32 v69, v69, v21
v_add_f32 v70, v70, v22
v_add_f32 v71, v71, v23
v_add_f32 v72, v72, v24
v_add_f32 v73, v73, v25
buffer_load_dwordx4 a[8:11], v0, s[4:7], s50 offen offset:2048 sc1
v_add_f32 v74, v74, v26
v_add_f32 v75, v75, v27
v_add_f32 v76, v76, v28
v_add_f32 v77, v77, v29
v_add_f32 v78, v78, v30
v_add_f32 v79, v79, v31
s_waitcnt lgkmcnt(0)
v_add_f32 v80, v80, v32
v_add_f32 v81, v81, v33
v_add_f32 v82, v82, v34
v_add_f32 v83, v83, v35
v_mov_b32 v24, 0x3f803f80
v_pk_add_f32 v[36:37], v[36:37], v[64:65]
v_pk_add_f32 v[38:39], v[38:39], v[66:67]
v_cvt_pk_bf16_f32 v246, v36, v37
v_cvt_pk_bf16_f32 v247, v38, v39
v_pk_add_f32 v[40:41], v[40:41], v[68:69]
v_pk_add_f32 v[42:43], v[42:43], v[70:71]
v_cvt_pk_bf16_f32 v248, v40, v41
v_cvt_pk_bf16_f32 v249, v42, v43
buffer_store_dwordx4 v[246:249], v0, s[4:7], s30 offen
v_pk_add_f32 v[44:45], v[44:45], v[72:73]
v_pk_add_f32 v[46:47], v[46:47], v[74:75]
v_cvt_pk_bf16_f32 v250, v44, v45
v_cvt_pk_bf16_f32 v251, v46, v47
v_pk_add_f32 v[48:49], v[48:49], v[76:77]
v_pk_add_f32 v[50:51], v[50:51], v[78:79]
v_cvt_pk_bf16_f32 v252, v48, v49
v_cvt_pk_bf16_f32 v253, v50, v51
buffer_store_dwordx4 v[250:253], v0, s[4:7], s30 offen offset:1024
v_pk_add_f32 v[52:53], v[52:53], v[80:81]
v_pk_add_f32 v[54:55], v[54:55], v[82:83]
v_cvt_pk_bf16_f32 v254, v52, v53
v_cvt_pk_bf16_f32 v255, v54, v55
buffer_store_dwordx2 v[254:255], v11, s[4:7], s31 offen
v_dot2_f32_bf16 v16, v246, v24, 0
v_dot2_f32_bf16 v17, v246, v246, 0
v_dot2_f32_bf16 v18, v247, v24, 0
v_dot2_f32_bf16 v19, v247, v247, 0
v_dot2_f32_bf16 v20, v248, v24, 0
v_dot2_f32_bf16 v21, v248, v248, 0
v_dot2_f32_bf16 v22, v249, v24, 0
v_dot2_f32_bf16 v23, v249, v249, 0
v_dot2_f32_bf16 v16, v250, v24, v16
v_dot2_f32_bf16 v17, v250, v250, v17
v_dot2_f32_bf16 v18, v251, v24, v18
v_dot2_f32_bf16 v19, v251, v251, v19
v_dot2_f32_bf16 v20, v252, v24, v20
v_dot2_f32_bf16 v21, v252, v252, v21
v_dot2_f32_bf16 v22, v253, v24, v22
v_dot2_f32_bf16 v23, v253, v253, v23
v_dot2_f32_bf16 v16, v254, v24, v16
v_dot2_f32_bf16 v17, v254, v254, v17
v_dot2_f32_bf16 v18, v255, v24, v18
v_dot2_f32_bf16 v19, v255, v255, v19
v_pk_add_f32 v[20:21], v[20:21], v[22:23]
s_nop 1
v_pk_add_f32 v[16:17], v[16:17], v[18:19]
v_pk_add_f32 v[16:17], v[16:17], v[20:21]
s_nop 1
v_permlane16_swap_b32 v16, v17
v_add_f32 v16, v16, v17
v_mov_b32 v17, v16
s_nop 1
v_permlane32_swap_b32 v16, v17
v_add_f32 v16, v16, v17
v_mov_b32 v17, v16
s_nop 1
v_permlane16_swap_b32 v16, v17
s_mov_b32 exec_lo, 0xffff
s_mov_b32 exec_hi, 0
buffer_store_dwordx2 v[16:17], v13, s[4:7], s53 offen
s_mov_b64 exec, -1
v_lshrrev_b32 v232, 9, v0
v_mul_u32_u24 v229, 49152, v232
v_lshrrev_b32 v232, 8, v0
v_lshlrev_b32 v232, 4, v232
v_add_u32 v232, 160256, v232
v_and_b32 v233, 0x1f0, v0
v_min_u32 v233, 368, v233
v_lshl_add_u32 v229, v233, 3, v229
s_lshl_b32 s54, s14, 2
s_add_u32 s54, s54, s40
s_add_u32 s54, s54, 2048
s_waitcnt vmcnt(0)
s_barrier
s_cmp_lg_u32 s12, 0
s_cbranch_scc1 SY14
s_mov_b64 exec, 1
s_cmp_eq_u32 s15, 0
s_cbranch_scc1 SY16
buffer_store_dword v10, off, s[4:7], s54
s_branch SY17
SY16:
buffer_wbl2 sc1
s_waitcnt vmcnt(0)
buffer_store_dword v10, off, s[4:7], s54 sc1
SY17:
s_mov_b64 exec, -1
s_add_u32 s48, s40, 2048
PL18:
buffer_load_dword v18, v9, s[4:7], s48 offen sc1
s_waitcnt vmcnt(0)
v_cmp_ne_u32 vcc, s89, v18
s_nop 1
s_cmp_eq_u64 vcc, 0
s_cbranch_scc1 PL19
s_sub_u32 s45, s45, 1
s_cbranch_scc0 PL18
s_mov_b32 s45, 0
PL19:
s_cmp_lg_u32 s15, 0
s_cbranch_scc1 SY15
buffer_inv sc1
s_waitcnt vmcnt(0)
s_branch SY15
SY14:
SY15:
s_barrier
s_add_u32 s51, s16, 0
buffer_load_dwordx4 v[112:115], v0, s[4:7], s51 offen offset:0 sc1
buffer_load_dwordx4 v[116:119], v1, s[4:7], s51 offen offset:0 sc1
buffer_load_dwordx4 v[120:123], v0, s[4:7], s51 offen offset:1024 sc1
buffer_load_dwordx4 v[124:127], v1, s[4:7], s51 offen offset:1024 sc1
s_barrier
ds_read_b128 v[160:163], v0 offset:0
ds_read_b128 v[164:167], v0 offset:1024
ds_read_b128 v[168:171], v0 offset:2048
ds_read_b128 v[172:175], v0 offset:3072
ds_read_b128 v[176:179], v0 offset:4096
ds_read_b128 v[180:183], v0 offset:5120
s_waitcnt lgkmcnt(4)
s_waitcnt vmcnt(3)
v_mfma_f32_16x16x32_bf16 v[16:19], v[160:163], v[112:115], 0
s_min_u32 s52, s12, 2
s_add_u32 s52, s52, 2
s_lshl_b32 s52, s52, 8
s_add_u32 s53, s52, s84
v_lshrrev_b32 v230, 8, v0
v_mul_u32_u24 v230, 1280, v230
v_and_b32 v231, 0xf0, v0
v_add_u32 v230, v230, v231
s_add_u32 s52, s52, 159744
v_add_u32 v231, s52, v231
buffer_load_dwordx4 v[128:131], v0, s[4:7], s51 offen offset:2048 sc1
s_waitcnt vmcnt(3)
v_mfma_f32_16x16x32_bf16 v[20:23], v[160:163], v[116:119], 0
ds_read_b128 v[184:187], v0 offset:6144
ds_read_b128 v[188:191], v0 offset:7168
v_mfma_f32_16x16x32_bf16 v[24:27], v[164:167], v[112:115], 0
ds_read_b128 v[160:163], v0 offset:8192
v_mfma_f32_16x16x32_bf16 v[28:31], v[164:167], v[116:119], 0
s_waitcnt lgkmcnt(5)
v_mfma_f32_16x16x32_bf16 v[32:35], v[168:171], v[112:115], 0
buffer_load_dwordx4 v[132:135], v1, s[4:7], s51 offen offset:2048 sc1
v_mfma_f32_16x16x32_bf16 v[36:39], v[168:171], v[116:119], 0
ds_read_b128 v[164:167], v0 offset:9216
v_mfma_f32_16x16x32_bf16 v[40:43], v[172:175], v[112:115], 0
ds_read_b128 v[168:171], v0 offset:10240
v_mfma_f32_16x16x32_bf16 v[44:47], v[172:175], v[116:119], 0
s_waitcnt lgkmcnt(5)
v_mfma_f32_16x16x32_bf16 v[48:51], v[176:179], v[112:115], 0
buffer_load_dwordx4 v[136:139], v0, s[4:7], s51 offen offset:3072 sc1
v_mfma_f32_16x16x32_bf16 v[52:55], v[176:179], v[116:119], 0
ds_read_b128 v[172:175], v0 offset:11264
v_mfma_f32_16x16x32_bf16 v[56:59], v[180:183], v[112:115], 0
ds_read_b128 v[176:179], v0 offset:12288
v_mfma_f32_16x16x32_bf16 v[60:63], v[180:183], v[116:119], 0
s_waitcnt lgkmcnt(5)
v_mfma_f32_16x16x32_bf16 v[64:67], v[184:187], v[112:115], 0
buffer_load_dwordx4 v[140:143], v1, s[4:7], s51 offen offset:3072 sc1
v_mfma_f32_16x16x32_bf16 v[68:71], v[184:187], v[116:119], 0
s_add_u32 m0, s43, 61440
s_add_u32 s49, s19, 61440
v_mfma_f32_16x16x32_bf16 v[72:75], v[188:191], v[112:115], 0
ds_read_b128 v[180:183], v0 offset:13312
ds_read_b128 v[184:187], v0 offset:14336
v_mfma_f32_16x16x32_bf16 v[76:79], v[188:191], v[116:119], 0
s_waitcnt lgkmcnt(5)
v_mfma_f32_16x16x32_bf16 v[80:83], v[160:163], v[112:115], 0
buffer_load_dwordx4 v0, s[4:7], s49 offen offset:0 sc1 lds
v_mfma_f32_16x16x32_bf16 v[84:87], v[160:163], v[116:119], 0
ds_read_b128 v[188:191], v0 offset:15360
v_mfma_f32_16x16x32_bf16 v[88:91], v[164:167], v[112:115], 0
ds_read_b128 v[160:163], v0 offset:16384
v_mfma_f32_16x16x32_bf16 v[92:95], v[164:167], v[116:119], 0
buffer_load_dwordx4 v0, s[4:7], s49 offen offset:1024 sc1 lds
s_waitcnt lgkmcnt(5)
v_mfma_f32_16x16x32_bf16 v[96:99], v[168:171], v[112:115], 0
ds_read_b128 v[164:167], v0 offset:17408
v_mfma_f32_16x16x32_bf16 v[100:103], v[168:171], v[116:119], 0
v_mfma_f32_16x16x32_bf16 v[104:107], v[172:175], v[112:115], 0
buffer_load_dwordx4 v0, s[4:7], s49 offen offset:2048 sc1 lds
v_mfma_f32_16x16x32_bf16 v[108:111], v[172:175], v[116:119], 0
s_add_u32 s51, s16, 4096
s_waitcnt lgkmcnt(4)
s_waitcnt vmcnt(8)
v_mfma_f32_16x16x32_bf16 v[16:19], v[176:179], v[120:123], v[16:19]
ds_read_b128 v[168:171], v0 offset:18432
ds_read_b128 v[172:175], v0 offset:19456
s_waitcnt vmcnt(7)
v_mfma_f32_16x16x32_bf16 v[20:23], v[176:179], v[124:127], v[20:23]
v_mfma_f32_16x16x32_bf16 v[24:27], v[180:183], v[120:123], v[24:27]
buffer_load_dwordx4 v[144:147], v0, s[4:7], s51 offen offset:0 sc1
v_mfma_f32_16x16x32_bf16 v[28:31], v[180:183], v[124:127], v[28:31]
ds_read_b128 v[176:179], v0 offset:20480
s_waitcnt lgkmcnt(5)
v_mfma_f32_16x16x32_bf16 v[32:35], v[184:187], v[120:123], v[32:35]
ds_read_b128 v[180:183], v0 offset:21504
v_mfma_f32_16x16x32_bf16 v[36:39], v[184:187], v[124:127], v[36:39]
buffer_load_dwordx4 v[148:151], v1, s[4:7], s51 offen offset:0 sc1
v_mfma_f32_16x16x32_bf16 v[40:43], v[188:191], v[120:123], v[40:43]
ds_read_b128 v[184:187], v0 offset:22528
v_mfma_f32_16x16x32_bf16 v[44:47], v[188:191], v[124:127], v[44:47]
s_waitcnt lgkmcnt(5)
v_mfma_f32_16x16x32_bf16 v[48:51], v[160:163], v[120:123], v[48:51]
ds_read_b128 v[188:191], v0 offset:23552
v_mfma_f32_16x16x32_bf16 v[52:55], v[160:163], v[124:127], v[52:55]
buffer_load_dwordx4 v[152:155], v0, s[4:7], s51 offen offset:1024 sc1
v_mfma_f32_16x16x32_bf16 v[56:59], v[164:167], v[120:123], v[56:59]
v_mfma_f32_16x16x32_bf16 v[60:63], v[164:167], v[124:127], v[60:63]
s_waitcnt lgkmcnt(4)
v_mfma_f32_16x16x32_bf16 v[64:67], v[168:171], v[120:123], v[64:67]
s_barrier
v_mfma_f32_16x16x32_bf16 v[68:71], v[168:171], v[124:127], v[68:71]
buffer_load_dwordx4 v[156:159], v1, s[4:7], s51 offen offset:1024 sc1
v_mfma_f32_16x16x32_bf16 v[72:75], v[172:175], v[120:123], v[72:75]
s_add_u32 m0, s43, 73728
s_add_u32 s49, s19, 73728
v_mfma_f32_16x16x32_bf16 v[76:79], v[172:175], v[124:127], v[76:79]
ds_read_b128 v[160:163], v0 offset:24576
s_waitcnt lgkmcnt(3)
v_mfma_f32_16x16x32_bf16 v[80:83], v[176:179], v[120:123], v[80:83]
buffer_load_dwordx4 v0, s[4:7], s49 offen offset:0 sc1 lds
v_mfma_f32_16x16x32_bf16 v[84:87], v[176:179], v[124:127], v[84:87]
ds_read_b128 v[164:167], v0 offset:25600
ds_read_b128 v[168:171], v0 offset:26624
v_mfma_f32_16x16x32_bf16 v[88:91], v[180:183], v[120:123], v[88:91]
ds_read_b128 v[172:175], v0 offset:27648
ds_read_b128 v[176:179], v0 offset:28672
v_mfma_f32_16x16x32_bf16 v[92:95], v[180:183], v[124:127], v[92:95]
s_waitcnt lgkmcnt(5)
v_mfma_f32_16x16x32_bf16 v[96:99], v[184:187], v[120:123], v[96:99]
buffer_load_dwordx4 v0, s[4:7], s49 offen offset:1024 sc1 lds
v_mfma_f32_16x16x32_bf16 v[100:103], v[184:187], v[124:127], v[100:103]
ds_read_b128 v[180:183], v0 offset:29696
v_mfma_f32_16x16x32_bf16 v[104:107], v[188:191], v[120:123], v[104:107]
ds_read_b128 v[184:187], v0 offset:30720
v_mfma_f32_16x16x32_bf16 v[108:111], v[188:191], v[124:127], v[108:111]
s_waitcnt lgkmcnt(5)
s_waitcnt vmcnt(12)
v_mfma_f32_16x16x32_bf16 v[16:19], v[160:163], v[128:131], v[16:19]
buffer_load_dwordx4 v0, s[4:7], s49 offen offset:2048 sc1 lds
s_waitcnt vmcnt(12)
v_mfma_f32_16x16x32_bf16 v[20:23], v[160:163], v[132:135], v[20:23]
s_add_u32 m0, s43, 86016
s_add_u32 s49, s19, 86016
v_mfma_f32_16x16x32_bf16 v[24:27], v[164:167], v[128:131], v[24:27]
ds_read_b128 v[188:191], v0 offset:31744
ds_read_b128 v[160:163], v0 offset:32768
v_mfma_f32_16x16x32_bf16 v[28:31], v[164:167], v[132:135], v[28:31]
s_waitcnt lgkmcnt(5)
v_mfma_f32_16x16x32_bf16 v[32:35], v[168:171], v[128:131], v[32:35]
buffer_load_dwordx4 v0, s[4:7], s49 offen offset:0 sc1 lds
v_mfma_f32_16x16x32_bf16 v[36:39], v[168:171], v[132:135], v[36:39]
ds_read_b128 v[164:167], v0 offset:33792
v_mfma_f32_16x16x32_bf16 v[40:43], v[172:175], v[128:131], v[40:43]
ds_read_b128 v[168:171], v0 offset:34816
v_mfma_f32_16x16x32_bf16 v[44:47], v[172:175], v[132:135], v[44:47]
s_waitcnt lgkmcnt(5)
v_mfma_f32_16x16x32_bf16 v[48:51], v[176:179], v[128:131], v[48:51]
buffer_load_dwordx4 v0, s[4:7], s49 offen offset:1024 sc1 lds
v_mfma_f32_16x16x32_bf16 v[52:55], v[176:179], v[132:135], v[52:55]
ds_read_b128 v[172:175], v0 offset:35840
v_mfma_f32_16x16x32_bf16 v[56:59], v[180:183], v[128:131], v[56:59]
ds_read_b128 v[176:179], v0 offset:36864
v_mfma_f32_16x16x32_bf16 v[60:63], v[180:183], v[132:135], v[60:63]
buffer_load_dwordx4 v0, s[4:7], s49 offen offset:2048 sc1 lds
s_waitcnt lgkmcnt(5)
v_mfma_f32_16x16x32_bf16 v[64:67], v[184:187], v[128:131], v[64:67]
ds_read_b128 v[180:183], v0 offset:37888
v_mfma_f32_16x16x32_bf16 v[68:71], v[184:187], v[132:135], v[68:71]
v_mfma_f32_16x16x32_bf16 v[72:75], v[188:191], v[128:131], v[72:75]
buffer_load_dwordx4 v[192:195], v0, s[4:7], s51 offen offset:2048 sc1
v_mfma_f32_16x16x32_bf16 v[76:79], v[188:191], v[132:135], v[76:79]
ds_read_b128 v[184:187], v0 offset:38912
s_waitcnt lgkmcnt(5)
v_mfma_f32_16x16x32_bf16 v[80:83], v[160:163], v[128:131], v[80:83]
ds_read_b128 v[188:191], v0 offset:39936
v_mfma_f32_16x16x32_bf16 v[84:87], v[160:163], v[132:135], v[84:87]
buffer_load_dwordx4 v[196:199], v1, s[4:7], s51 offen offset:2048 sc1
v_mfma_f32_16x16x32_bf16 v[88:91], v[164:167], v[128:131], v[88:91]
ds_read_b128 v[160:163], v0 offset:40960
v_mfma_f32_16x16x32_bf16 v[92:95], v[164:167], v[132:135], v[92:95]
s_waitcnt lgkmcnt(5)
v_mfma_f32_16x16x32_bf16 v[96:99], v[168:171], v[128:131], v[96:99]
ds_read_b128 v[164:167], v0 offset:41984
v_mfma_f32_16x16x32_bf16 v[100:103], v[168:171], v[132:135], v[100:103]
buffer_load_dwordx4 v[200:203], v0, s[4:7], s51 offen offset:3072 sc1
v_mfma_f32_16x16x32_bf16 v[104:107], v[172:175], v[128:131], v[104:107]
ds_read_b128 v[168:171], v0 offset:43008
v_mfma_f32_16x16x32_bf16 v[108:111], v[172:175], v[132:135], v[108:111]
s_waitcnt lgkmcnt(5)
s_waitcnt vmcnt(17)
v_mfma_f32_16x16x32_bf16 v[16:19], v[176:179], v[136:139], v[16:19]
buffer_load_dwordx4 v[204:207], v1, s[4:7], s51 offen offset:3072 sc1
s_waitcnt vmcnt(17)
v_mfma_f32_16x16x32_bf16 v[20:23], v[176:179], v[140:143], v[20:23]
s_add_u32 m0, s43, 98304
s_add_u32 s49, s19, 98304
v_mfma_f32_16x16x32_bf16 v[24:27], v[180:183], v[136:139], v[24:27]
ds_read_b128 v[172:175], v0 offset:44032
ds_read_b128 v[176:179], v0 offset:45056
v_mfma_f32_16x16x32_bf16 v[28:31], v[180:183], v[140:143], v[28:31]
s_waitcnt lgkmcnt(5)
v_mfma_f32_16x16x32_bf16 v[32:35], v[184:187], v[136:139], v[32:35]
buffer_load_dwordx4 v0, s[4:7], s49 offen offset:0 sc1 lds
v_mfma_f32_16x16x32_bf16 v[36:39], v[184:187], v[140:143], v[36:39]
ds_read_b128 v[180:183], v0 offset:46080
v_mfma_f32_16x16x32_bf16 v[40:43], v[188:191], v[136:139], v[40:43]
ds_read_b128 v[184:187], v0 offset:47104
v_mfma_f32_16x16x32_bf16 v[44:47], v[188:191], v[140:143], v[44:47]
s_waitcnt lgkmcnt(5)
v_mfma_f32_16x16x32_bf16 v[48:51], v[160:163], v[136:139], v[48:51]
buffer_load_dwordx4 v0, s[4:7], s49 offen offset:1024 sc1 lds
v_mfma_f32_16x16x32_bf16 v[52:55], v[160:163], v[140:143], v[52:55]
ds_read_b128 v[188:191], v0 offset:48128
v_mfma_f32_16x16x32_bf16 v[56:59], v[164:167], v[136:139], v[56:59]
v_mfma_f32_16x16x32_bf16 v[60:63], v[164:167], v[140:143], v[60:63]
buffer_load_dwordx4 v0, s[4:7], s49 offen offset:2048 sc1 lds
s_waitcnt lgkmcnt(4)
v_mfma_f32_16x16x32_bf16 v[64:67], v[168:171], v[136:139], v[64:67]
s_waitcnt vmcnt(17)
s_barrier
v_mfma_f32_16x16x32_bf16 v[68:71], v[168:171], v[140:143], v[68:71]
s_add_u32 m0, s43, 110592
s_add_u32 s49, s19, 110592
v_mfma_f32_16x16x32_bf16 v[72:75], v[172:175], v[136:139], v[72:75]
ds_read_b128 v[160:163], v0 offset:49152
ds_read_b128 v[164:167], v0 offset:50176
v_mfma_f32_16x16x32_bf16 v[76:79], v[172:175], v[140:143], v[76:79]
ds_read_b128 v[168:171], v0 offset:51200
s_waitcnt lgkmcnt(5)
v_mfma_f32_16x16x32_bf16 v[80:83], v[176:179], v[136:139], v[80:83]
buffer_load_dwordx4 v0, s[4:7], s49 offen offset:0 sc1 lds
v_mfma_f32_16x16x32_bf16 v[84:87], v[176:179], v[140:143], v[84:87]
ds_read_b128 v[172:175], v0 offset:52224
v_mfma_f32_16x16x32_bf16 v[88:91], v[180:183], v[136:139], v[88:91]
ds_read_b128 v[176:179], v0 offset:53248
v_mfma_f32_16x16x32_bf16 v[92:95], v[180:183], v[140:143], v[92:95]
buffer_load_dwordx4 v0, s[4:7], s49 offen offset:1024 sc1 lds
s_waitcnt lgkmcnt(5)
v_mfma_f32_16x16x32_bf16 v[96:99], v[184:187], v[136:139], v[96:99]
ds_read_b128 v[180:183], v0 offset:54272
v_mfma_f32_16x16x32_bf16 v[100:103], v[184:187], v[140:143], v[100:103]
v_mfma_f32_16x16x32_bf16 v[104:107], v[188:191], v[136:139], v[104:107]
buffer_load_dwordx4 v0, s[4:7], s49 offen offset:2048 sc1 lds
v_mfma_f32_16x16x32_bf16 v[108:111], v[188:191], v[140:143], v[108:111]
s_add_u32 s51, s16, 8192
s_waitcnt lgkmcnt(4)
s_waitcnt vmcnt(19)
v_mfma_f32_16x16x32_bf16 v[16:19], v[160:163], v[144:147], v[16:19]
ds_read_b128 v[184:187], v0 offset:55296
ds_read_b128 v[188:191], v0 offset:56320
s_waitcnt vmcnt(18)
v_mfma_f32_16x16x32_bf16 v[20:23], v[160:163], v[148:151], v[20:23]
v_mfma_f32_16x16x32_bf16 v[24:27], v[164:167], v[144:147], v[24:27]
buffer_load_dwordx4 v[112:115], v0, s[4:7], s51 offen offset:0 sc1
v_mfma_f32_16x16x32_bf16 v[28:31], v[164:167], v[148:151], v[28:31]
ds_read_b128 v[160:163], v0 offset:57344
s_waitcnt lgkmcnt(5)
v_mfma_f32_16x16x32_bf16 v[32:35], v[168:171], v[144:147], v[32:35]
ds_read_b128 v[164:167], v0 offset:58368
v_mfma_f32_16x16x32_bf16 v[36:39], v[168:171], v[148:151], v[36:39]
buffer_load_dwordx4 v[116:119], v1, s[4:7], s51 offen offset:0 sc1
v_mfma_f32_16x16x32_bf16 v[40:43], v[172:175], v[144:147], v[40:43]
ds_read_b128 v[168:171], v0 offset:59392
v_mfma_f32_16x16x32_bf16 v[44:47], v[172:175], v[148:151], v[44:47]
s_waitcnt lgkmcnt(5)
v_mfma_f32_16x16x32_bf16 v[48:51], v[176:179], v[144:147], v[48:51]
ds_read_b128 v[172:175], v0 offset:60416
v_mfma_f32_16x16x32_bf16 v[52:55], v[176:179], v[148:151], v[52:55]
buffer_load_dwordx4 v[120:123], v0, s[4:7], s51 offen offset:1024 sc1
v_mfma_f32_16x16x32_bf16 v[56:59], v[180:183], v[144:147], v[56:59]
ds_read_b128 v[176:179], v0 offset:61440
v_mfma_f32_16x16x32_bf16 v[60:63], v[180:183], v[148:151], v[60:63]
s_waitcnt lgkmcnt(5)
v_mfma_f32_16x16x32_bf16 v[64:67], v[184:187], v[144:147], v[64:67]
buffer_load_dwordx4 v[124:127], v1, s[4:7], s51 offen offset:1024 sc1
v_mfma_f32_16x16x32_bf16 v[68:71], v[184:187], v[148:151], v[68:71]
s_add_u32 m0, s43, 122880
s_add_u32 s49, s19, 122880
v_mfma_f32_16x16x32_bf16 v[72:75], v[188:191], v[144:147], v[72:75]
ds_read_b128 v[180:183], v0 offset:62464
ds_read_b128 v[184:187], v0 offset:63488
v_mfma_f32_16x16x32_bf16 v[76:79], v[188:191], v[148:151], v[76:79]
s_waitcnt lgkmcnt(5)
v_mfma_f32_16x16x32_bf16 v[80:83], v[160:163], v[144:147], v[80:83]
buffer_load_dwordx4 v0, s[4:7], s49 offen offset:0 sc1 lds
v_mfma_f32_16x16x32_bf16 v[84:87], v[160:163], v[148:151], v[84:87]
ds_read_b128 v[188:191], v0 offset:64512
v_mfma_f32_16x16x32_bf16 v[88:91], v[164:167], v[144:147], v[88:91]
ds_read_b128 v[160:163], v4 offset:0
v_mfma_f32_16x16x32_bf16 v[92:95], v[164:167], v[148:151], v[92:95]
s_waitcnt lgkmcnt(5)
v_mfma_f32_16x16x32_bf16 v[96:99], v[168:171], v[144:147], v[96:99]
buffer_load_dwordx4 v0, s[4:7], s49 offen offset:1024 sc1 lds
v_mfma_f32_16x16x32_bf16 v[100:103], v[168:171], v[148:151], v[100:103]
ds_read_b128 v[164:167], v4 offset:1024
v_mfma_f32_16x16x32_bf16 v[104:107], v[172:175], v[144:147], v[104:107]
ds_read_b128 v[168:171], v4 offset:2048
v_mfma_f32_16x16x32_bf16 v[108:111], v[172:175], v[148:151], v[108:111]
s_waitcnt lgkmcnt(5)
s_waitcnt vmcnt(23)
v_mfma_f32_16x16x32_bf16 v[16:19], v[176:179], v[152:155], v[16:19]
ds_read_b128 v[172:175], v4 offset:3072
s_waitcnt vmcnt(22)
v_mfma_f32_16x16x32_bf16 v[20:23], v[176:179], v[156:159], v[20:23]
s_lshl_b32 s55, s14, 10
s_add_u32 s55, s55, C_p3e0-M_pc
v_lshlrev_b32 v233, 5, v9
v_and_b32 v233, 0x380, v233
v_add_u32 v233, s55, v233
v_min_u32 v233, M_last-M_pc-4, v233
global_load_dword v233, v233, s[86:87]
v_mfma_f32_16x16x32_bf16 v[24:27], v[180:183], v[152:155], v[24:27]
ds_read_b128 v[176:179], v4 offset:4096
v_mfma_f32_16x16x32_bf16 v[28:31], v[180:183], v[156:159], v[28:31]
s_waitcnt lgkmcnt(5)
v_mfma_f32_16x16x32_bf16 v[32:35], v[184:187], v[152:155], v[32:35]
buffer_load_dwordx4 v0, s[4:7], s49 offen offset:2048 sc1 lds
v_mfma_f32_16x16x32_bf16 v[36:39], v[184:187], v[156:159], v[36:39]
s_add_u32 m0, s43, 135168
s_add_u32 s49, s19, 135168
v_mfma_f32_16x16x32_bf16 v[40:43], v[188:191], v[152:155], v[40:43]
ds_read_b128 v[180:183], v4 offset:5120
ds_read_b128 v[184:187], v4 offset:6144
v_mfma_f32_16x16x32_bf16 v[44:47], v[188:191], v[156:159], v[44:47]
s_waitcnt lgkmcnt(5)
v_mfma_f32_16x16x32_bf16 v[48:51], v[160:163], v[152:155], v[48:51]
buffer_load_dwordx4 v0, s[4:7], s49 offen offset:0 sc1 lds
v_mfma_f32_16x16x32_bf16 v[52:55], v[160:163], v[156:159], v[52:55]
ds_read_b128 v[188:191], v4 offset:7168
v_mfma_f32_16x16x32_bf16 v[56:59], v[164:167], v[152:155], v[56:59]
v_mfma_f32_16x16x32_bf16 v[60:63], v[164:167], v[156:159], v[60:63]
s_waitcnt lgkmcnt(4)
v_mfma_f32_16x16x32_bf16 v[64:67], v[168:171], v[152:155], v[64:67]
s_waitcnt vmcnt(19)
s_barrier
v_mfma_f32_16x16x32_bf16 v[68:71], v[168:171], v[156:159], v[68:71]
buffer_load_dwordx4 v0, s[4:7], s49 offen offset:1024 sc1 lds
v_mfma_f32_16x16x32_bf16 v[72:75], v[172:175], v[152:155], v[72:75]
ds_read_b128 v[160:163], v4 offset:8192
ds_read_b128 v[164:167], v4 offset:9216
v_mfma_f32_16x16x32_bf16 v[76:79], v[172:175], v[156:159], v[76:79]
ds_read_b128 v[168:171], v4 offset:10240
s_waitcnt lgkmcnt(5)
v_mfma_f32_16x16x32_bf16 v[80:83], v[176:179], v[152:155], v[80:83]
buffer_load_dwordx4 v0, s[4:7], s49 offen offset:2048 sc1 lds
v_mfma_f32_16x16x32_bf16 v[84:87], v[176:179], v[156:159], v[84:87]
ds_read_b128 v[172:175], v4 offset:11264
v_mfma_f32_16x16x32_bf16 v[88:91], v[180:183], v[152:155], v[88:91]
ds_read_b128 v[176:179], v4 offset:12288
v_mfma_f32_16x16x32_bf16 v[92:95], v[180:183], v[156:159], v[92:95]
s_waitcnt lgkmcnt(5)
v_mfma_f32_16x16x32_bf16 v[96:99], v[184:187], v[152:155], v[96:99]
buffer_load_dwordx4 v[128:131], v0, s[4:7], s51 offen offset:2048 sc1
v_mfma_f32_16x16x32_bf16 v[100:103], v[184:187], v[156:159], v[100:103]
ds_read_b128 v[180:183], v4 offset:13312
v_mfma_f32_16x16x32_bf16 v[104:107], v[188:191], v[152:155], v[104:107]
ds_read_b128 v[184:187], v4 offset:14336
v_mfma_f32_16x16x32_bf16 v[108:111], v[188:191], v[156:159], v[108:111]
buffer_load_dwordx4 v[132:135], v1, s[4:7], s51 offen offset:2048 sc1
s_waitcnt lgkmcnt(5)
s_waitcnt vmcnt(22)
v_mfma_f32_16x16x32_bf16 v[16:19], v[160:163], v[192:195], v[16:19]
ds_read_b128 v[188:191], v4 offset:15360
s_waitcnt vmcnt(21)
v_mfma_f32_16x16x32_bf16 v[20:23], v[160:163], v[196:199], v[20:23]
v_mfma_f32_16x16x32_bf16 v[24:27], v[164:167], v[192:195], v[24:27]
buffer_load_dwordx4 v[136:139], v0, s[4:7], s51 offen offset:3072 sc1
v_mfma_f32_16x16x32_bf16 v[28:31], v[164:167], v[196:199], v[28:31]
ds_read_b128 v[160:163], v4 offset:16384
s_waitcnt lgkmcnt(5)
v_mfma_f32_16x16x32_bf16 v[32:35], v[168:171], v[192:195], v[32:35]
ds_read_b128 v[164:167], v4 offset:17408
v_mfma_f32_16x16x32_bf16 v[36:39], v[168:171], v[196:199], v[36:39]
v_mfma_f32_16x16x32_bf16 v[40:43], v[172:175], v[192:195], v[40:43]
buffer_load_dwordx4 v[140:143], v1, s[4:7], s51 offen offset:3072 sc1
v_mfma_f32_16x16x32_bf16 v[44:47], v[172:175], v[196:199], v[44:47]
s_add_u32 m0, s43, 147456
s_waitcnt lgkmcnt(4)
v_mfma_f32_16x16x32_bf16 v[48:51], v[176:179], v[192:195], v[48:51]
s_add_u32 s49, s19, 147456
ds_read_b128 v[168:171], v4 offset:18432
v_mfma_f32_16x16x32_bf16 v[52:55], v[176:179], v[196:199], v[52:55]
buffer_load_dwordx4 v0, s[4:7], s49 offen offset:0 sc1 lds
v_mfma_f32_16x16x32_bf16 v[56:59], v[180:183], v[192:195], v[56:59]
ds_read_b128 v[172:175], v4 offset:19456
ds_read_b128 v[176:179], v4 offset:20480
v_mfma_f32_16x16x32_bf16 v[60:63], v[180:183], v[196:199], v[60:63]
s_waitcnt lgkmcnt(5)
v_mfma_f32_16x16x32_bf16 v[64:67], v[184:187], v[192:195], v[64:67]
ds_read_b128 v[180:183], v4 offset:21504
v_mfma_f32_16x16x32_bf16 v[68:71], v[184:187], v[196:199], v[68:71]
buffer_load_dwordx4 v0, s[4:7], s49 offen offset:1024 sc1 lds
v_mfma_f32_16x16x32_bf16 v[72:75], v[188:191], v[192:195], v[72:75]
ds_read_b128 v[184:187], v4 offset:22528
v_mfma_f32_16x16x32_bf16 v[76:79], v[188:191], v[196:199], v[76:79]
s_waitcnt lgkmcnt(5)
v_mfma_f32_16x16x32_bf16 v[80:83], v[160:163], v[192:195], v[80:83]
buffer_load_dwordx4 v0, s[4:7], s49 offen offset:2048 sc1 lds
v_mfma_f32_16x16x32_bf16 v[84:87], v[160:163], v[196:199], v[84:87]
s_add_u32 m0, s43, 0
s_add_u32 s49, s19, 159744
v_mfma_f32_16x16x32_bf16 v[88:91], v[164:167], v[192:195], v[88:91]
ds_read_b128 v[188:191], v4 offset:23552
ds_read_b128 v[160:163], v4 offset:24576
v_mfma_f32_16x16x32_bf16 v[92:95], v[164:167], v[196:199], v[92:95]
s_waitcnt lgkmcnt(5)
v_mfma_f32_16x16x32_bf16 v[96:99], v[168:171], v[192:195], v[96:99]
buffer_load_dwordx4 v0, s[4:7], s49 offen offset:0 sc1 lds
v_mfma_f32_16x16x32_bf16 v[100:103], v[168:171], v[196:199], v[100:103]
ds_read_b128 v[164:167], v4 offset:25600
v_mfma_f32_16x16x32_bf16 v[104:107], v[172:175], v[192:195], v[104:107]
ds_read_b128 v[168:171], v4 offset:26624
v_mfma_f32_16x16x32_bf16 v[108:111], v[172:175], v[196:199], v[108:111]
s_waitcnt lgkmcnt(5)
s_waitcnt vmcnt(26)
v_mfma_f32_16x16x32_bf16 v[16:19], v[176:179], v[200:203], v[16:19]
buffer_load_dwordx4 v0, s[4:7], s49 offen offset:1024 sc1 lds
s_waitcnt vmcnt(26)
v_mfma_f32_16x16x32_bf16 v[20:23], v[176:179], v[204:207], v[20:23]
ds_read_b128 v[172:175], v4 offset:27648
v_mfma_f32_16x16x32_bf16 v[24:27], v[180:183], v[200:203], v[24:27]
ds_read_b128 v[176:179], v4 offset:28672
v_mfma_f32_16x16x32_bf16 v[28:31], v[180:183], v[204:207], v[28:31]
s_waitcnt lgkmcnt(5)
v_mfma_f32_16x16x32_bf16 v[32:35], v[184:187], v[200:203], v[32:35]
buffer_load_dwordx4 v0, s[4:7], s49 offen offset:2048 sc1 lds
v_mfma_f32_16x16x32_bf16 v[36:39], v[184:187], v[204:207], v[36:39]
s_add_u32 s51, s16, 12288
ds_read_b128 v[180:183], v4 offset:29696
v_mfma_f32_16x16x32_bf16 v[40:43], v[188:191], v[200:203], v[40:43]
ds_read_b128 v[184:187], v4 offset:30720
v_mfma_f32_16x16x32_bf16 v[44:47], v[188:191], v[204:207], v[44:47]
s_waitcnt lgkmcnt(5)
v_mfma_f32_16x16x32_bf16 v[48:51], v[160:163], v[200:203], v[48:51]
buffer_load_dwordx4 v[144:147], v0, s[4:7], s51 offen offset:0 sc1
v_mfma_f32_16x16x32_bf16 v[52:55], v[160:163], v[204:207], v[52:55]
ds_read_b128 v[188:191], v4 offset:31744
v_mfma_f32_16x16x32_bf16 v[56:59], v[164:167], v[200:203], v[56:59]
v_mfma_f32_16x16x32_bf16 v[60:63], v[164:167], v[204:207], v[60:63]
buffer_load_dwordx4 v[148:151], v1, s[4:7], s51 offen offset:0 sc1
s_waitcnt lgkmcnt(4)
v_mfma_f32_16x16x32_bf16 v[64:67], v[168:171], v[200:203], v[64:67]
s_waitcnt vmcnt(23)
s_barrier
v_mfma_f32_16x16x32_bf16 v[68:71], v[168:171], v[204:207], v[68:71]
ds_read_b128 v[160:163], v4 offset:32768
ds_read_b128 v[164:167], v4 offset:33792
v_mfma_f32_16x16x32_bf16 v[72:75], v[172:175], v[200:203], v[72:75]
buffer_load_dwordx4 v[152:155], v0, s[4:7], s51 offen offset:1024 sc1
v_mfma_f32_16x16x32_bf16 v[76:79], v[172:175], v[204:207], v[76:79]
ds_read_b128 v[168:171], v4 offset:34816
s_waitcnt lgkmcnt(5)
v_mfma_f32_16x16x32_bf16 v[80:83], v[176:179], v[200:203], v[80:83]
ds_read_b128 v[172:175], v4 offset:35840
v_mfma_f32_16x16x32_bf16 v[84:87], v[176:179], v[204:207], v[84:87]
v_mfma_f32_16x16x32_bf16 v[88:91], v[180:183], v[200:203], v[88:91]
buffer_load_dwordx4 v[156:159], v1, s[4:7], s51 offen offset:1024 sc1
v_mfma_f32_16x16x32_bf16 v[92:95], v[180:183], v[204:207], v[92:95]
s_add_u32 m0, s43, 12288
s_waitcnt lgkmcnt(4)
v_mfma_f32_16x16x32_bf16 v[96:99], v[184:187], v[200:203], v[96:99]
s_add_u32 s49, s19, 172032
ds_read_b128 v[176:179], v4 offset:36864
v_mfma_f32_16x16x32_bf16 v[100:103], v[184:187], v[204:207], v[100:103]
buffer_load_dwordx4 v0, s[4:7], s49 offen offset:0 sc1 lds
v_mfma_f32_16x16x32_bf16 v[104:107], v[188:191], v[200:203], v[104:107]
ds_read_b128 v[180:183], v4 offset:37888
ds_read_b128 v[184:187], v4 offset:38912
v_mfma_f32_16x16x32_bf16 v[108:111], v[188:191], v[204:207], v[108:111]
s_waitcnt lgkmcnt(5)
s_waitcnt vmcnt(25)
v_mfma_f32_16x16x32_bf16 v[16:19], v[160:163], v[112:115], v[16:19]
ds_read_b128 v[188:191], v4 offset:39936
s_waitcnt vmcnt(24)
v_mfma_f32_16x16x32_bf16 v[20:23], v[160:163], v[116:119], v[20:23]
buffer_load_dwordx4 v0, s[4:7], s49 offen offset:1024 sc1 lds
v_mfma_f32_16x16x32_bf16 v[24:27], v[164:167], v[112:115], v[24:27]
ds_read_b128 v[160:163], v4 offset:40960
v_mfma_f32_16x16x32_bf16 v[28:31], v[164:167], v[116:119], v[28:31]
s_waitcnt lgkmcnt(5)
v_mfma_f32_16x16x32_bf16 v[32:35], v[168:171], v[112:115], v[32:35]
buffer_load_dwordx4 v0, s[4:7], s49 offen offset:2048 sc1 lds
v_mfma_f32_16x16x32_bf16 v[36:39], v[168:171], v[116:119], v[36:39]
s_add_u32 m0, s43, 24576
s_add_u32 s49, s19, 184320
v_mfma_f32_16x16x32_bf16 v[40:43], v[172:175], v[112:115], v[40:43]
ds_read_b128 v[164:167], v4 offset:41984
ds_read_b128 v[168:171], v4 offset:43008
v_mfma_f32_16x16x32_bf16 v[44:47], v[172:175], v[116:119], v[44:47]
s_waitcnt lgkmcnt(5)
v_mfma_f32_16x16x32_bf16 v[48:51], v[176:179], v[112:115], v[48:51]
buffer_load_dwordx4 v0, s[4:7], s49 offen offset:0 sc1 lds
v_mfma_f32_16x16x32_bf16 v[52:55], v[176:179], v[116:119], v[52:55]
ds_read_b128 v[172:175], v4 offset:44032
v_mfma_f32_16x16x32_bf16 v[56:59], v[180:183], v[112:115], v[56:59]
ds_read_b128 v[176:179], v4 offset:45056
v_mfma_f32_16x16x32_bf16 v[60:63], v[180:183], v[116:119], v[60:63]
s_waitcnt lgkmcnt(5)
v_mfma_f32_16x16x32_bf16 v[64:67], v[184:187], v[112:115], v[64:67]
buffer_load_dwordx4 v0, s[4:7], s49 offen offset:1024 sc1 lds
v_mfma_f32_16x16x32_bf16 v[68:71], v[184:187], v[116:119], v[68:71]
ds_read_b128 v[180:183], v4 offset:46080
v_mfma_f32_16x16x32_bf16 v[72:75], v[188:191], v[112:115], v[72:75]
ds_read_b128 v[184:187], v4 offset:47104
v_mfma_f32_16x16x32_bf16 v[76:79], v[188:191], v[116:119], v[76:79]
s_waitcnt lgkmcnt(5)
v_mfma_f32_16x16x32_bf16 v[80:83], v[160:163], v[112:115], v[80:83]
buffer_load_dwordx4 v0, s[4:7], s49 offen offset:2048 sc1 lds
v_mfma_f32_16x16x32_bf16 v[84:87], v[160:163], v[116:119], v[84:87]
ds_read_b128 v[188:191], v4 offset:48128
v_mfma_f32_16x16x32_bf16 v[88:91], v[164:167], v[112:115], v[88:91]
ds_read_b128 v[160:163], v4 offset:49152
v_mfma_f32_16x16x32_bf16 v[92:95], v[164:167], v[116:119], v[92:95]
s_waitcnt lgkmcnt(5)
v_mfma_f32_16x16x32_bf16 v[96:99], v[168:171], v[112:115], v[96:99]
buffer_load_dwordx4 v[208:211], v230, s[4:7], s53 offen sc1
s_add_u32 s53, s53, 5120
v_mfma_f32_16x16x32_bf16 v[100:103], v[168:171], v[116:119], v[100:103]
ds_read_b128 v[164:167], v4 offset:50176
v_mfma_f32_16x16x32_bf16 v[104:107], v[172:175], v[112:115], v[104:107]
ds_read_b128 v[168:171], v4 offset:51200
v_mfma_f32_16x16x32_bf16 v[108:111], v[172:175], v[116:119], v[108:111]
buffer_load_dwordx4 v[212:215], v230, s[4:7], s53 offen sc1
s_add_u32 s53, s53, 5120
s_waitcnt lgkmcnt(5)
s_waitcnt vmcnt(30)
v_mfma_f32_16x16x32_bf16 v[16:19], v[176:179], v[120:123], v[16:19]
ds_read_b128 v[172:175], v4 offset:52224
s_waitcnt vmcnt(29)
v_mfma_f32_16x16x32_bf16 v[20:23], v[176:179], v[124:127], v[20:23]
v_mfma_f32_16x16x32_bf16 v[24:27], v[180:183], v[120:123], v[24:27]
buffer_load_dwordx4 v[216:219], v230, s[4:7], s53 offen sc1
s_add_u32 s53, s53, 5120
v_mfma_f32_16x16x32_bf16 v[28:31], v[180:183], v[124:127], v[28:31]
ds_read_b128 v[176:179], v4 offset:53248
s_waitcnt lgkmcnt(5)
v_mfma_f32_16x16x32_bf16 v[32:35], v[184:187], v[120:123], v[32:35]
ds_read_b128 v[180:183], v4 offset:54272
v_mfma_f32_16x16x32_bf16 v[36:39], v[184:187], v[124:127], v[36:39]
v_mfma_f32_16x16x32_bf16 v[40:43], v[188:191], v[120:123], v[40:43]
buffer_load_dwordx4 v[220:223], v230, s[4:7], s53 offen sc1
s_add_u32 s53, s53, 5120
v_mfma_f32_16x16x32_bf16 v[44:47], v[188:191], v[124:127], v[44:47]
ds_read_b128 v[184:187], v4 offset:55296
s_waitcnt lgkmcnt(5)
v_mfma_f32_16x16x32_bf16 v[48:51], v[160:163], v[120:123], v[48:51]
ds_read_b128 v[188:191], v4 offset:56320
v_mfma_f32_16x16x32_bf16 v[52:55], v[160:163], v[124:127], v[52:55]
buffer_load_dwordx4 v[224:227], v230, s[4:7], s53 offen sc1
v_mfma_f32_16x16x32_bf16 v[56:59], v[164:167], v[120:123], v[56:59]
v_mfma_f32_16x16x32_bf16 v[60:63], v[164:167], v[124:127], v[60:63]
s_waitcnt lgkmcnt(4)
v_mfma_f32_16x16x32_bf16 v[64:67], v[168:171], v[120:123], v[64:67]
s_waitcnt vmcnt(25)
s_barrier
v_mfma_f32_16x16x32_bf16 v[68:71], v[168:171], v[124:127], v[68:71]
buffer_load_dwordx4 v[192:195], v0, s[4:7], s51 offen offset:2048 sc1
v_mfma_f32_16x16x32_bf16 v[72:75], v[172:175], v[120:123], v[72:75]
ds_read_b128 v[160:163], v4 offset:57344
ds_read_b128 v[164:167], v4 offset:58368
v_mfma_f32_16x16x32_bf16 v[76:79], v[172:175], v[124:127], v[76:79]
ds_read_b128 v[168:171], v4 offset:59392
s_waitcnt lgkmcnt(5)
v_mfma_f32_16x16x32_bf16 v[80:83], v[176:179], v[120:123], v[80:83]
buffer_load_dwordx4 v[196:199], v1, s[4:7], s51 offen offset:2048 sc1
v_mfma_f32_16x16x32_bf16 v[84:87], v[176:179], v[124:127], v[84:87]
ds_read_b128 v[172:175], v4 offset:60416
v_mfma_f32_16x16x32_bf16 v[88:91], v[180:183], v[120:123], v[88:91]
ds_read_b128 v[176:179], v4 offset:61440
v_mfma_f32_16x16x32_bf16 v[92:95], v[180:183], v[124:127], v[92:95]
s_waitcnt lgkmcnt(5)
v_mfma_f32_16x16x32_bf16 v[96:99], v[184:187], v[120:123], v[96:99]
buffer_load_dwordx2 v[234:235], v13, s[4:7], s33 offen offset:0 sc1
v_mfma_f32_16x16x32_bf16 v[100:103], v[184:187], v[124:127], v[100:103]
ds_read_b128 v[180:183], v4 offset:62464
v_mfma_f32_16x16x32_bf16 v[104:107], v[188:191], v[120:123], v[104:107]
ds_read_b128 v[184:187], v4 offset:63488
v_mfma_f32_16x16x32_bf16 v[108:111], v[188:191], v[124:127], v[108:111]
s_waitcnt lgkmcnt(5)
s_waitcnt vmcnt(27)
v_mfma_f32_16x16x32_bf16 v[16:19], v[160:163], v[128:131], v[16:19]
buffer_load_dwordx2 v[236:237], v13, s[4:7], s33 offen offset:128 sc1
s_waitcnt vmcnt(27)
v_mfma_f32_16x16x32_bf16 v[20:23], v[160:163], v[132:135], v[20:23]
ds_read_b128 v[188:191], v4 offset:64512
v_mfma_f32_16x16x32_bf16 v[24:27], v[164:167], v[128:131], v[24:27]
ds_read_b128 v[160:163], v5 offset:0
v_mfma_f32_16x16x32_bf16 v[28:31], v[164:167], v[132:135], v[28:31]
s_waitcnt lgkmcnt(5)
v_mfma_f32_16x16x32_bf16 v[32:35], v[168:171], v[128:131], v[32:35]
buffer_load_dwordx2 v[238:239], v13, s[4:7], s33 offen offset:1024 sc1
v_mfma_f32_16x16x32_bf16 v[36:39], v[168:171], v[132:135], v[36:39]
ds_read_b128 v[164:167], v5 offset:1024
v_mfma_f32_16x16x32_bf16 v[40:43], v[172:175], v[128:131], v[40:43]
ds_read_b128 v[168:171], v5 offset:2048
v_mfma_f32_16x16x32_bf16 v[44:47], v[172:175], v[132:135], v[44:47]
s_waitcnt lgkmcnt(5)
v_mfma_f32_16x16x32_bf16 v[48:51], v[176:179], v[128:131], v[48:51]
buffer_load_dwordx2 v[240:241], v13, s[4:7], s33 offen offset:1152 sc1
v_mfma_f32_16x16x32_bf16 v[52:55], v[176:179], v[132:135], v[52:55]
ds_read_b128 v[172:175], v5 offset:3072
v_mfma_f32_16x16x32_bf16 v[56:59], v[180:183], v[128:131], v[56:59]
ds_read_b128 v[176:179], v5 offset:4096
v_mfma_f32_16x16x32_bf16 v[60:63], v[180:183], v[132:135], v[60:63]
buffer_load_dwordx4 v[200:203], v0, s[4:7], s51 offen offset:3072 sc1
s_waitcnt lgkmcnt(5)
v_mfma_f32_16x16x32_bf16 v[64:67], v[184:187], v[128:131], v[64:67]
ds_read_b128 v[180:183], v5 offset:5120
v_mfma_f32_16x16x32_bf16 v[68:71], v[184:187], v[132:135], v[68:71]
v_mfma_f32_16x16x32_bf16 v[72:75], v[188:191], v[128:131], v[72:75]
buffer_load_dwordx4 v[204:207], v1, s[4:7], s51 offen offset:3072 sc1
v_mfma_f32_16x16x32_bf16 v[76:79], v[188:191], v[132:135], v[76:79]
s_add_u32 m0, s43, 98304
s_waitcnt lgkmcnt(4)
v_mfma_f32_16x16x32_bf16 v[80:83], v[160:163], v[128:131], v[80:83]
s_add_u32 s49, s19, 196608
ds_read_b128 v[184:187], v5 offset:6144
v_mfma_f32_16x16x32_bf16 v[84:87], v[160:163], v[132:135], v[84:87]
ds_read_b128 v[188:191], v5 offset:7168
v_mfma_f32_16x16x32_bf16 v[88:91], v[164:167], v[128:131], v[88:91]
buffer_load_dwordx4 v0, s[4:7], s49 offen offset:0 sc1 lds
v_mfma_f32_16x16x32_bf16 v[92:95], v[164:167], v[132:135], v[92:95]
ds_read_b128 v[160:163], v5 offset:8192
s_waitcnt lgkmcnt(5)
v_mfma_f32_16x16x32_bf16 v[96:99], v[168:171], v[128:131], v[96:99]
ds_read_b128 v[164:167], v5 offset:9216
v_mfma_f32_16x16x32_bf16 v[100:103], v[168:171], v[132:135], v[100:103]
buffer_load_dwordx4 v0, s[4:7], s49 offen offset:1024 sc1 lds
v_mfma_f32_16x16x32_bf16 v[104:107], v[172:175], v[128:131], v[104:107]
ds_read_b128 v[168:171], v5 offset:10240
v_mfma_f32_16x16x32_bf16 v[108:111], v[172:175], v[132:135], v[108:111]
s_waitcnt lgkmcnt(5)
s_waitcnt vmcnt(32)
v_mfma_f32_16x16x32_bf16 v[16:19], v[176:179], v[136:139], v[16:19]
ds_read_b128 v[172:175], v5 offset:11264
s_waitcnt vmcnt(31)
v_mfma_f32_16x16x32_bf16 v[20:23], v[176:179], v[140:143], v[20:23]
buffer_load_dwordx4 v0, s[4:7], s49 offen offset:2048 sc1 lds
v_mfma_f32_16x16x32_bf16 v[24:27], v[180:183], v[136:139], v[24:27]
s_add_u32 s51, s16, 16384
ds_read_b128 v[176:179], v5 offset:12288
v_mfma_f32_16x16x32_bf16 v[28:31], v[180:183], v[140:143], v[28:31]
s_waitcnt lgkmcnt(5)
v_mfma_f32_16x16x32_bf16 v[32:35], v[184:187], v[136:139], v[32:35]
buffer_load_dwordx4 v[112:115], v0, s[4:7], s51 offen offset:0 sc1
v_mfma_f32_16x16x32_bf16 v[36:39], v[184:187], v[140:143], v[36:39]
ds_read_b128 v[180:183], v5 offset:13312
v_mfma_f32_16x16x32_bf16 v[40:43], v[188:191], v[136:139], v[40:43]
ds_read_b128 v[184:187], v5 offset:14336
v_mfma_f32_16x16x32_bf16 v[44:47], v[188:191], v[140:143], v[44:47]
s_waitcnt lgkmcnt(5)
v_mfma_f32_16x16x32_bf16 v[48:51], v[160:163], v[136:139], v[48:51]
buffer_load_dwordx4 v[116:119], v1, s[4:7], s51 offen offset:0 sc1
v_mfma_f32_16x16x32_bf16 v[52:55], v[160:163], v[140:143], v[52:55]
s_add_u32 m0, s43, 110592
s_add_u32 s49, s19, 208896
v_mfma_f32_16x16x32_bf16 v[56:59], v[164:167], v[136:139], v[56:59]
ds_read_b128 v[188:191], v5 offset:15360
v_mfma_f32_16x16x32_bf16 v[60:63], v[164:167], v[140:143], v[60:63]
s_waitcnt lgkmcnt(4)
v_mfma_f32_16x16x32_bf16 v[64:67], v[168:171], v[136:139], v[64:67]
s_waitcnt vmcnt(28)
s_barrier
v_mfma_f32_16x16x32_bf16 v[68:71], v[168:171], v[140:143], v[68:71]
buffer_load_dwordx4 v0, s[4:7], s49 offen offset:0 sc1 lds
v_mfma_f32_16x16x32_bf16 v[72:75], v[172:175], v[136:139], v[72:75]
ds_read_b128 v[160:163], v5 offset:16384
ds_read_b128 v[164:167], v5 offset:17408
v_mfma_f32_16x16x32_bf16 v[76:79], v[172:175], v[140:143], v[76:79]
ds_read_b128 v[168:171], v5 offset:18432
s_waitcnt lgkmcnt(5)
v_mfma_f32_16x16x32_bf16 v[80:83], v[176:179], v[136:139], v[80:83]
buffer_load_dwordx4 v0, s[4:7], s49 offen offset:1024 sc1 lds
v_mfma_f32_16x16x32_bf16 v[84:87], v[176:179], v[140:143], v[84:87]
ds_read_b128 v[172:175], v5 offset:19456
v_mfma_f32_16x16x32_bf16 v[88:91], v[180:183], v[136:139], v[88:91]
ds_read_b128 v[176:179], v5 offset:20480
v_mfma_f32_16x16x32_bf16 v[92:95], v[180:183], v[140:143], v[92:95]
s_waitcnt lgkmcnt(5)
v_mfma_f32_16x16x32_bf16 v[96:99], v[184:187], v[136:139], v[96:99]
buffer_load_dwordx4 v0, s[4:7], s49 offen offset:2048 sc1 lds
v_mfma_f32_16x16x32_bf16 v[100:103], v[184:187], v[140:143], v[100:103]
ds_read_b128 v[180:183], v5 offset:21504
v_mfma_f32_16x16x32_bf16 v[104:107], v[188:191], v[136:139], v[104:107]
ds_read_b128 v[184:187], v5 offset:22528
v_mfma_f32_16x16x32_bf16 v[108:111], v[188:191], v[140:143], v[108:111]
buffer_load_dwordx4 v[120:123], v0, s[4:7], s51 offen offset:1024 sc1
s_waitcnt lgkmcnt(5)
s_waitcnt vmcnt(31)
v_mfma_f32_16x16x32_bf16 v[16:19], v[160:163], v[144:147], v[16:19]
ds_read_b128 v[188:191], v5 offset:23552
s_waitcnt vmcnt(30)
v_mfma_f32_16x16x32_bf16 v[20:23], v[160:163], v[148:151], v[20:23]
v_mfma_f32_16x16x32_bf16 v[24:27], v[164:167], v[144:147], v[24:27]
buffer_load_dwordx4 v[124:127], v1, s[4:7], s51 offen offset:1024 sc1
v_mfma_f32_16x16x32_bf16 v[28:31], v[164:167], v[148:151], v[28:31]
s_add_u32 m0, s43, 122880
s_waitcnt lgkmcnt(4)
v_mfma_f32_16x16x32_bf16 v[32:35], v[168:171], v[144:147], v[32:35]
s_add_u32 s49, s19, 221184
ds_read_b128 v[160:163], v5 offset:24576
v_mfma_f32_16x16x32_bf16 v[36:39], v[168:171], v[148:151], v[36:39]
ds_read_b128 v[164:167], v5 offset:25600
v_mfma_f32_16x16x32_bf16 v[40:43], v[172:175], v[144:147], v[40:43]
buffer_load_dwordx4 v0, s[4:7], s49 offen offset:0 sc1 lds
v_mfma_f32_16x16x32_bf16 v[44:47], v[172:175], v[148:151], v[44:47]
ds_read_b128 v[168:171], v5 offset:26624
s_waitcnt lgkmcnt(5)
v_mfma_f32_16x16x32_bf16 v[48:51], v[176:179], v[144:147], v[48:51]
ds_read_b128 v[172:175], v5 offset:27648
v_mfma_f32_16x16x32_bf16 v[52:55], v[176:179], v[148:151], v[52:55]
buffer_load_dwordx4 v0, s[4:7], s49 offen offset:1024 sc1 lds
v_mfma_f32_16x16x32_bf16 v[56:59], v[180:183], v[144:147], v[56:59]
ds_read_b128 v[176:179], v0 offset:0
v_mfma_f32_16x16x32_bf16 v[60:63], v[180:183], v[148:151], v[60:63]
s_waitcnt lgkmcnt(5)
v_mfma_f32_16x16x32_bf16 v[64:67], v[184:187], v[144:147], v[64:67]
ds_read_b128 v[180:183], v0 offset:1024
v_mfma_f32_16x16x32_bf16 v[68:71], v[184:187], v[148:151], v[68:71]
buffer_load_dwordx4 v0, s[4:7], s49 offen offset:2048 sc1 lds
v_mfma_f32_16x16x32_bf16 v[72:75], v[188:191], v[144:147], v[72:75]
ds_read_b128 v[184:187], v0 offset:2048
v_mfma_f32_16x16x32_bf16 v[76:79], v[188:191], v[148:151], v[76:79]
s_waitcnt lgkmcnt(5)
v_mfma_f32_16x16x32_bf16 v[80:83], v[160:163], v[144:147], v[80:83]
buffer_load_dwordx4 v[128:131], v0, s[4:7], s51 offen offset:2048 sc1
v_mfma_f32_16x16x32_bf16 v[84:87], v[160:163], v[148:151], v[84:87]
ds_read_b128 v[188:191], v0 offset:3072
v_mfma_f32_16x16x32_bf16 v[88:91], v[164:167], v[144:147], v[88:91]
ds_read_b128 v[160:163], v0 offset:4096
v_mfma_f32_16x16x32_bf16 v[92:95], v[164:167], v[148:151], v[92:95]
s_waitcnt lgkmcnt(5)
v_mfma_f32_16x16x32_bf16 v[96:99], v[168:171], v[144:147], v[96:99]
buffer_load_dwordx4 v[132:135], v1, s[4:7], s51 offen offset:2048 sc1
v_mfma_f32_16x16x32_bf16 v[100:103], v[168:171], v[148:151], v[100:103]
ds_read_b128 v[164:167], v0 offset:5120
v_mfma_f32_16x16x32_bf16 v[104:107], v[172:175], v[144:147], v[104:107]
ds_read_b128 v[168:171], v0 offset:6144
v_mfma_f32_16x16x32_bf16 v[108:111], v[172:175], v[148:151], v[108:111]
s_waitcnt lgkmcnt(5)
s_waitcnt vmcnt(35)
v_mfma_f32_16x16x32_bf16 v[16:19], v[176:179], v[152:155], v[16:19]
buffer_load_dwordx4 v[136:139], v0, s[4:7], s51 offen offset:3072 sc1
s_waitcnt vmcnt(35)
v_mfma_f32_16x16x32_bf16 v[20:23], v[176:179], v[156:159], v[20:23]
ds_read_b128 v[172:175], v0 offset:7168
v_mfma_f32_16x16x32_bf16 v[24:27], v[180:183], v[152:155], v[24:27]
ds_read_b128 v[176:179], v0 offset:8192
v_mfma_f32_16x16x32_bf16 v[28:31], v[180:183], v[156:159], v[28:31]
s_waitcnt lgkmcnt(5)
v_mfma_f32_16x16x32_bf16 v[32:35], v[184:187], v[152:155], v[32:35]
buffer_load_dwordx4 v[140:143], v1, s[4:7], s51 offen offset:3072 sc1
v_mfma_f32_16x16x32_bf16 v[36:39], v[184:187], v[156:159], v[36:39]
ds_read_b128 v[180:183], v0 offset:9216
v_mfma_f32_16x16x32_bf16 v[40:43], v[188:191], v[152:155], v[40:43]
ds_read_b128 v[184:187], v0 offset:10240
v_mfma_f32_16x16x32_bf16 v[44:47], v[188:191], v[156:159], v[44:47]
s_waitcnt lgkmcnt(5)
v_mfma_f32_16x16x32_bf16 v[48:51], v[160:163], v[152:155], v[48:51]
s_add_u32 s48, s40, 4096
v_lshlrev_b32 v228, 9, v9
v_and_b32 v228, 2048, v228
buffer_load_dword v228, v228, s[4:7], s48 offen
v_mfma_f32_16x16x32_bf16 v[52:55], v[160:163], v[156:159], v[52:55]
s_add_u32 s50, s21, 3072
ds_read_b128 v[188:191], v0 offset:11264
v_mfma_f32_16x16x32_bf16 v[56:59], v[164:167], v[152:155], v[56:59]
v_mfma_f32_16x16x32_bf16 v[60:63], v[164:167], v[156:159], v[60:63]
buffer_load_dwordx4 a[12:15], v0, s[4:7], s50 offen offset:0 sc1
s_waitcnt lgkmcnt(4)
v_mfma_f32_16x16x32_bf16 v[64:67], v[168:171], v[152:155], v[64:67]
s_waitcnt vmcnt(32)
s_barrier
v_mfma_f32_16x16x32_bf16 v[68:71], v[168:171], v[156:159], v[68:71]
s_add_u32 m0, s43, 135168
s_add_u32 s49, s19, 233472
v_mfma_f32_16x16x32_bf16 v[72:75], v[172:175], v[152:155], v[72:75]
buffer_load_dwordx4 v0, s[4:7], s49 offen offset:0 sc1 lds
v_mfma_f32_16x16x32_bf16 v[76:79], v[172:175], v[156:159], v[76:79]
ds_read_b128 v[160:163], v0 offset:12288
s_waitcnt lgkmcnt(3)
v_mfma_f32_16x16x32_bf16 v[80:83], v[176:179], v[152:155], v[80:83]
ds_read_b128 v[164:167], v0 offset:13312
ds_read_b128 v[168:171], v0 offset:14336
v_mfma_f32_16x16x32_bf16 v[84:87], v[176:179], v[156:159], v[84:87]
ds_read_b128 v[172:175], v0 offset:15360
v_mfma_f32_16x16x32_bf16 v[88:91], v[180:183], v[152:155], v[88:91]
buffer_load_dwordx4 v0, s[4:7], s49 offen offset:1024 sc1 lds
v_mfma_f32_16x16x32_bf16 v[92:95], v[180:183], v[156:159], v[92:95]
ds_read_b128 v[176:179], v0 offset:16384
s_waitcnt lgkmcnt(5)
v_mfma_f32_16x16x32_bf16 v[96:99], v[184:187], v[152:155], v[96:99]
ds_read_b128 v[180:183], v0 offset:17408
v_mfma_f32_16x16x32_bf16 v[100:103], v[184:187], v[156:159], v[100:103]
buffer_load_dwordx4 v0, s[4:7], s49 offen offset:2048 sc1 lds
v_mfma_f32_16x16x32_bf16 v[104:107], v[188:191], v[152:155], v[104:107]
ds_read_b128 v[184:187], v0 offset:18432
v_mfma_f32_16x16x32_bf16 v[108:111], v[188:191], v[156:159], v[108:111]
s_waitcnt lgkmcnt(5)
s_waitcnt vmcnt(29)
v_mfma_f32_16x16x32_bf16 v[16:19], v[160:163], v[192:195], v[16:19]
ds_read_b128 v[188:191], v0 offset:19456
v_add_f32 v208, v208, v212
s_waitcnt vmcnt(28)
v_mfma_f32_16x16x32_bf16 v[20:23], v[160:163], v[196:199], v[20:23]
buffer_load_dwordx4 a[16:19], v0, s[4:7], s50 offen offset:1024 sc1
v_mfma_f32_16x16x32_bf16 v[24:27], v[164:167], v[192:195], v[24:27]
ds_read_b128 v[160:163], v0 offset:20480
v_add_f32 v209, v209, v213
v_mfma_f32_16x16x32_bf16 v[28:31], v[164:167], v[196:199], v[28:31]
v_add_f32 v210, v210, v214
s_waitcnt lgkmcnt(5)
v_mfma_f32_16x16x32_bf16 v[32:35], v[168:171], v[192:195], v[32:35]
buffer_load_dwordx4 a[20:23], v0, s[4:7], s50 offen offset:2048 sc1
v_mfma_f32_16x16x32_bf16 v[36:39], v[168:171], v[196:199], v[36:39]
ds_read_b128 v[164:167], v0 offset:21504
v_add_f32 v211, v211, v215
v_mfma_f32_16x16x32_bf16 v[40:43], v[172:175], v[192:195], v[40:43]
ds_read_b128 v[168:171], v0 offset:22528
v_add_f32 v208, v208, v216
v_mfma_f32_16x16x32_bf16 v[44:47], v[172:175], v[196:199], v[44:47]
v_add_f32 v209, v209, v217
s_waitcnt lgkmcnt(5)
v_mfma_f32_16x16x32_bf16 v[48:51], v[176:179], v[192:195], v[48:51]
buffer_load_dwordx4 a[24:27], v0, s[4:7], s50 offen offset:3072 sc1
v_mfma_f32_16x16x32_bf16 v[52:55], v[176:179], v[196:199], v[52:55]
s_add_u32 s50, s21, 7168
ds_read_b128 v[172:175], v0 offset:23552
v_mfma_f32_16x16x32_bf16 v[56:59], v[180:183], v[192:195], v[56:59]
ds_read_b128 v[176:179], v0 offset:24576
v_add_f32 v210, v210, v218
v_mfma_f32_16x16x32_bf16 v[60:63], v[180:183], v[196:199], v[60:63]
v_add_f32 v211, v211, v219
s_waitcnt lgkmcnt(5)
v_mfma_f32_16x16x32_bf16 v[64:67], v[184:187], v[192:195], v[64:67]
buffer_load_dwordx4 a[28:31], v0, s[4:7], s50 offen offset:0 sc1
v_mfma_f32_16x16x32_bf16 v[68:71], v[184:187], v[196:199], v[68:71]
ds_read_b128 v[180:183], v0 offset:25600
v_add_f32 v208, v208, v220
v_mfma_f32_16x16x32_bf16 v[72:75], v[188:191], v[192:195], v[72:75]
ds_read_b128 v[184:187], v0 offset:26624
v_add_f32 v209, v209, v221
v_mfma_f32_16x16x32_bf16 v[76:79], v[188:191], v[196:199], v[76:79]
v_add_f32 v210, v210, v222
s_waitcnt lgkmcnt(5)
v_mfma_f32_16x16x32_bf16 v[80:83], v[160:163], v[192:195], v[80:83]
buffer_load_dwordx4 a[32:35], v0, s[4:7], s50 offen offset:1024 sc1
v_mfma_f32_16x16x32_bf16 v[84:87], v[160:163], v[196:199], v[84:87]
ds_read_b128 v[188:191], v0 offset:27648
v_add_f32 v211, v211, v223
v_mfma_f32_16x16x32_bf16 v[88:91], v[164:167], v[192:195], v[88:91]
ds_read_b128 v[160:163], v0 offset:28672
v_add_f32 v208, v208, v224
v_mfma_f32_16x16x32_bf16 v[92:95], v[164:167], v[196:199], v[92:95]
v_add_f32 v209, v209, v225
s_waitcnt lgkmcnt(5)
v_mfma_f32_16x16x32_bf16 v[96:99], v[168:171], v[192:195], v[96:99]
buffer_load_dwordx4 a[36:39], v0, s[4:7], s50 offen offset:2048 sc1
v_mfma_f32_16x16x32_bf16 v[100:103], v[168:171], v[196:199], v[100:103]
ds_read_b128 v[164:167], v0 offset:29696
v_add_f32 v210, v210, v226
v_mfma_f32_16x16x32_bf16 v[104:107], v[172:175], v[192:195], v[104:107]
ds_read_b128 v[168:171], v0 offset:30720
v_add_f32 v211, v211, v227
v_mfma_f32_16x16x32_bf16 v[108:111], v[172:175], v[196:199], v[108:111]
v_mov_b32 v212, v208
s_waitcnt lgkmcnt(5)
s_waitcnt vmcnt(29)
v_mfma_f32_16x16x32_bf16 v[16:19], v[176:179], v[200:203], v[16:19]
buffer_load_dwordx4 a[40:43], v0, s[4:7], s50 offen offset:3072 sc1
s_waitcnt vmcnt(29)
v_mfma_f32_16x16x32_bf16 v[20:23], v[176:179], v[204:207], v[20:23]
s_add_u32 s50, s21, 11264
ds_read_b128 v[172:175], v0 offset:31744
v_mfma_f32_16x16x32_bf16 v[24:27], v[180:183], v[200:203], v[24:27]
ds_read_b128 v[176:179], v0 offset:32768
v_mov_b32 v213, v209
v_mfma_f32_16x16x32_bf16 v[28:31], v[180:183], v[204:207], v[28:31]
buffer_load_dwordx4 a[44:47], v0, s[4:7], s50 offen offset:0 sc1
s_waitcnt lgkmcnt(5)
v_mfma_f32_16x16x32_bf16 v[32:35], v[184:187], v[200:203], v[32:35]
ds_read_b128 v[180:183], v0 offset:33792
v_mov_b32 v214, v210
v_mfma_f32_16x16x32_bf16 v[36:39], v[184:187], v[204:207], v[36:39]
v_mov_b32 v215, v211
v_permlane16_swap_b32 v208, v212
v_mfma_f32_16x16x32_bf16 v[40:43], v[188:191], v[200:203], v[40:43]
buffer_load_dwordx4 a[48:51], v0, s[4:7], s50 offen offset:1024 sc1
v_mfma_f32_16x16x32_bf16 v[44:47], v[188:191], v[204:207], v[44:47]
ds_read_b128 v[184:187], v0 offset:34816
s_waitcnt lgkmcnt(5)
v_mfma_f32_16x16x32_bf16 v[48:51], v[160:163], v[200:203], v[48:51]
ds_read_b128 v[188:191], v0 offset:35840
v_permlane16_swap_b32 v209, v213
v_mfma_f32_16x16x32_bf16 v[52:55], v[160:163], v[204:207], v[52:55]
buffer_load_dwordx4 a[52:55], v0, s[4:7], s50 offen offset:2048 sc1
v_mfma_f32_16x16x32_bf16 v[56:59], v[164:167], v[200:203], v[56:59]
v_permlane16_swap_b32 v210, v214
v_permlane16_swap_b32 v211, v215
v_mfma_f32_16x16x32_bf16 v[60:63], v[164:167], v[204:207], v[60:63]
v_add_f32 v208, v208, v212
s_waitcnt lgkmcnt(4)
v_mfma_f32_16x16x32_bf16 v[64:67], v[168:171], v[200:203], v[64:67]
s_waitcnt vmcnt(24)
s_barrier
v_mfma_f32_16x16x32_bf16 v[68:71], v[168:171], v[204:207], v[68:71]
buffer_load_dwordx4 a[56:59], v0, s[4:7], s50 offen offset:3072 sc1
v_mfma_f32_16x16x32_bf16 v[72:75], v[172:175], v[200:203], v[72:75]
s_add_u32 s50, s21, 15360
ds_read_b128 v[160:163], v4 offset:32768
v_mfma_f32_16x16x32_bf16 v[76:79], v[172:175], v[204:207], v[76:79]
ds_read_b128 v[164:167], v4 offset:33792
s_waitcnt lgkmcnt(4)
v_mfma_f32_16x16x32_bf16 v[80:83], v[176:179], v[200:203], v[80:83]
buffer_load_dwordx4 a[60:63], v0, s[4:7], s50 offen offset:0 sc1
v_mfma_f32_16x16x32_bf16 v[84:87], v[176:179], v[204:207], v[84:87]
ds_read_b128 v[168:171], v4 offset:34816
ds_read_b128 v[172:175], v4 offset:35840
v_mfma_f32_16x16x32_bf16 v[88:91], v[180:183], v[200:203], v[88:91]
ds_read_b128 v[176:179], v4 offset:36864
v_add_f32 v209, v209, v213
v_mfma_f32_16x16x32_bf16 v[92:95], v[180:183], v[204:207], v[92:95]
v_add_f32 v210, v210, v214
s_waitcnt lgkmcnt(5)
v_mfma_f32_16x16x32_bf16 v[96:99], v[184:187], v[200:203], v[96:99]
buffer_load_dwordx4 a[64:67], v0, s[4:7], s50 offen offset:1024 sc1
v_mfma_f32_16x16x32_bf16 v[100:103], v[184:187], v[204:207], v[100:103]
ds_read_b128 v[180:183], v4 offset:37888
v_add_f32 v211, v211, v215
v_mfma_f32_16x16x32_bf16 v[104:107], v[188:191], v[200:203], v[104:107]
ds_read_b128 v[184:187], v4 offset:38912
v_mov_b32 v212, v208
v_mfma_f32_16x16x32_bf16 v[108:111], v[188:191], v[204:207], v[108:111]
v_mov_b32 v213, v209
s_waitcnt lgkmcnt(5)
v_mfma_f32_16x16x32_bf16 v[16:19], v[160:163], v[112:115], v[16:19]
buffer_load_dwordx4 a[68:71], v0, s[4:7], s50 offen offset:2048 sc1
v_mfma_f32_16x16x32_bf16 v[20:23], v[160:163], v[116:119], v[20:23]
ds_read_b128 v[188:191], v4 offset:39936
v_mov_b32 v214, v210
v_mfma_f32_16x16x32_bf16 v[24:27], v[164:167], v[112:115], v[24:27]
ds_read_b128 v[160:163], v4 offset:40960
v_mov_b32 v215, v211
v_mfma_f32_16x16x32_bf16 v[28:31], v[164:167], v[116:119], v[28:31]
v_permlane32_swap_b32 v208, v212
s_waitcnt lgkmcnt(5)
v_mfma_f32_16x16x32_bf16 v[32:35], v[168:171], v[112:115], v[32:35]
buffer_load_dwordx4 a[72:75], v0, s[4:7], s50 offen offset:3072 sc1
v_mfma_f32_16x16x32_bf16 v[36:39], v[168:171], v[116:119], v[36:39]
s_add_u32 s50, s21, 19456
ds_read_b128 v[164:167], v4 offset:41984
v_mfma_f32_16x16x32_bf16 v[40:43], v[172:175], v[112:115], v[40:43]
ds_read_b128 v[168:171], v4 offset:43008
v_permlane32_swap_b32 v209, v213
v_mfma_f32_16x16x32_bf16 v[44:47], v[172:175], v[116:119], v[44:47]
v_permlane32_swap_b32 v210, v214
s_waitcnt lgkmcnt(5)
v_mfma_f32_16x16x32_bf16 v[48:51], v[176:179], v[112:115], v[48:51]
buffer_load_dwordx4 a[76:79], v0, s[4:7], s50 offen offset:0 sc1
v_mfma_f32_16x16x32_bf16 v[52:55], v[176:179], v[116:119], v[52:55]
ds_read_b128 v[172:175], v4 offset:44032
v_permlane32_swap_b32 v211, v215
v_mfma_f32_16x16x32_bf16 v[56:59], v[180:183], v[112:115], v[56:59]
ds_read_b128 v[176:179], v4 offset:45056
v_add_f32 v208, v208, v212
v_mfma_f32_16x16x32_bf16 v[60:63], v[180:183], v[116:119], v[60:63]
v_add_f32 v209, v209, v213
s_waitcnt lgkmcnt(5)
v_mfma_f32_16x16x32_bf16 v[64:67], v[184:187], v[112:115], v[64:67]
buffer_load_dwordx4 a[80:83], v0, s[4:7], s50 offen offset:1024 sc1
v_mfma_f32_16x16x32_bf16 v[68:71], v[184:187], v[116:119], v[68:71]
ds_read_b128 v[180:183], v4 offset:46080
v_add_f32 v210, v210, v214
v_mfma_f32_16x16x32_bf16 v[72:75], v[188:191], v[112:115], v[72:75]
ds_read_b128 v[184:187], v4 offset:47104
v_add_f32 v211, v211, v215
v_mfma_f32_16x16x32_bf16 v[76:79], v[188:191], v[116:119], v[76:79]
buffer_load_dwordx4 a[84:87], v0, s[4:7], s50 offen offset:2048 sc1
s_waitcnt lgkmcnt(5)
v_mfma_f32_16x16x32_bf16 v[80:83], v[160:163], v[112:115], v[80:83]
ds_read_b128 v[188:191], v4 offset:48128
ds_write_b128 v231, v[208:211]
v_mfma_f32_16x16x32_bf16 v[84:87], v[160:163], v[116:119], v[84:87]
v_add_f32 v234, v234, v236
v_add_f32 v238, v238, v240
v_mfma_f32_16x16x32_bf16 v[88:91], v[164:167], v[112:115], v[88:91]
buffer_load_dwordx4 a[88:91], v0, s[4:7], s50 offen offset:3072 sc1
v_mfma_f32_16x16x32_bf16 v[92:95], v[164:167], v[116:119], v[92:95]
s_add_u32 s50, s21, 23552
s_waitcnt lgkmcnt(5)
v_mfma_f32_16x16x32_bf16 v[96:99], v[168:171], v[112:115], v[96:99]
ds_read_b128 v[160:163], v4 offset:49152
ds_read_b128 v[164:167], v4 offset:50176
v_mfma_f32_16x16x32_bf16 v[100:103], v[168:171], v[116:119], v[100:103]
buffer_load_dwordx4 a[92:95], v0, s[4:7], s50 offen offset:0 sc1
v_mfma_f32_16x16x32_bf16 v[104:107], v[172:175], v[112:115], v[104:107]
ds_read_b128 v[168:171], v4 offset:51200
v_add_f32 v235, v235, v237
v_mfma_f32_16x16x32_bf16 v[108:111], v[172:175], v[116:119], v[108:111]
v_add_f32 v239, v239, v241
s_waitcnt lgkmcnt(6)
s_waitcnt vmcnt(33)
v_mfma_f32_16x16x32_bf16 v[16:19], v[176:179], v[120:123], v[16:19]
ds_read_b128 v[172:175], v4 offset:52224
v_permlane16_swap_b32 v234, v235
s_waitcnt vmcnt(32)
v_mfma_f32_16x16x32_bf16 v[20:23], v[176:179], v[124:127], v[20:23]
buffer_load_dwordx4 a[96:99], v0, s[4:7], s50 offen offset:1024 sc1
v_mfma_f32_16x16x32_bf16 v[24:27], v[180:183], v[120:123], v[24:27]
ds_read_b128 v[176:179], v4 offset:53248
v_permlane16_swap_b32 v238, v239
v_mfma_f32_16x16x32_bf16 v[28:31], v[180:183], v[124:127], v[28:31]
v_add_f32 v234, v234, v235
s_waitcnt lgkmcnt(6)
v_mfma_f32_16x16x32_bf16 v[32:35], v[184:187], v[120:123], v[32:35]
buffer_load_dwordx4 a[100:103], v0, s[4:7], s50 offen offset:2048 sc1
v_mfma_f32_16x16x32_bf16 v[36:39], v[184:187], v[124:127], v[36:39]
ds_read_b128 v[180:183], v4 offset:54272
v_add_f32 v238, v238, v239
v_mfma_f32_16x16x32_bf16 v[40:43], v[188:191], v[120:123], v[40:43]
ds_read_b128 v[184:187], v4 offset:55296
v_mov_b32 v235, v234
v_mfma_f32_16x16x32_bf16 v[44:47], v[188:191], v[124:127], v[44:47]
v_mov_b32 v239, v238
s_waitcnt lgkmcnt(5)
v_mfma_f32_16x16x32_bf16 v[48:51], v[160:163], v[120:123], v[48:51]
buffer_load_dwordx4 a[104:107], v0, s[4:7], s50 offen offset:3072 sc1
v_mfma_f32_16x16x32_bf16 v[52:55], v[160:163], v[124:127], v[52:55]
s_add_u32 s50, s21, 27648
ds_read_b128 v[188:191], v4 offset:56320
v_mfma_f32_16x16x32_bf16 v[56:59], v[164:167], v[120:123], v[56:59]
v_permlane32_swap_b32 v234, v235
v_permlane32_swap_b32 v238, v239
v_mfma_f32_16x16x32_bf16 v[60:63], v[164:167], v[124:127], v[60:63]
v_add_f32 v234, v234, v235
s_waitcnt lgkmcnt(4)
v_mfma_f32_16x16x32_bf16 v[64:67], v[168:171], v[120:123], v[64:67]
s_waitcnt vmcnt(23)
s_barrier
v_mfma_f32_16x16x32_bf16 v[68:71], v[168:171], v[124:127], v[68:71]
buffer_load_dwordx4 a[108:111], v0, s[4:7], s50 offen offset:0 sc1
v_mfma_f32_16x16x32_bf16 v[72:75], v[172:175], v[120:123], v[72:75]
ds_read_b128 v[160:163], v4 offset:57344
ds_read_b128 v[164:167], v4 offset:58368
v_mfma_f32_16x16x32_bf16 v[76:79], v[172:175], v[124:127], v[76:79]
ds_read_b128 v[168:171], v4 offset:59392
s_waitcnt lgkmcnt(5)
v_mfma_f32_16x16x32_bf16 v[80:83], v[176:179], v[120:123], v[80:83]
buffer_load_dwordx4 a[112:115], v0, s[4:7], s50 offen offset:1024 sc1
v_mfma_f32_16x16x32_bf16 v[84:87], v[176:179], v[124:127], v[84:87]
ds_read_b128 v[172:175], v4 offset:60416
v_add_f32 v238, v238, v239
v_mfma_f32_16x16x32_bf16 v[88:91], v[180:183], v[120:123], v[88:91]
ds_read_b128 v[176:179], v4 offset:61440
v_mov_b32 v235, v234
v_mfma_f32_16x16x32_bf16 v[92:95], v[180:183], v[124:127], v[92:95]
v_mov_b32 v239, v238
s_waitcnt lgkmcnt(5)
v_mfma_f32_16x16x32_bf16 v[96:99], v[184:187], v[120:123], v[96:99]
buffer_load_dwordx4 a[116:119], v0, s[4:7], s50 offen offset:2048 sc1
v_mfma_f32_16x16x32_bf16 v[100:103], v[184:187], v[124:127], v[100:103]
ds_read_b128 v[180:183], v4 offset:62464
v_permlane16_swap_b32 v234, v235
v_mfma_f32_16x16x32_bf16 v[104:107], v[188:191], v[120:123], v[104:107]
ds_read_b128 v[184:187], v4 offset:63488
v_permlane16_swap_b32 v238, v239
v_mfma_f32_16x16x32_bf16 v[108:111], v[188:191], v[124:127], v[108:111]
v_mul_f32 v242, 0x3acccccd, v234
s_waitcnt lgkmcnt(5)
v_mfma_f32_16x16x32_bf16 v[16:19], v[160:163], v[128:131], v[16:19]
buffer_load_dwordx4 a[120:123], v0, s[4:7], s50 offen offset:3072 sc1
v_mfma_f32_16x16x32_bf16 v[20:23], v[160:163], v[132:135], v[20:23]
s_add_u32 s50, s21, 31744
ds_read_b128 v[188:191], v4 offset:64512
v_mfma_f32_16x16x32_bf16 v[24:27], v[164:167], v[128:131], v[24:27]
ds_read_b128 v[160:163], v5 offset:0
v_mul_f32 v244, 0x3acccccd, v238
v_mfma_f32_16x16x32_bf16 v[28:31], v[164:167], v[132:135], v[28:31]
buffer_load_dwordx4 a[124:127], v0, s[4:7], s50 offen offset:0 sc1
s_waitcnt lgkmcnt(5)
v_mfma_f32_16x16x32_bf16 v[32:35], v[168:171], v[128:131], v[32:35]
ds_read_b128 v[164:167], v5 offset:1024
v_mul_f32 v235, 0x3acccccd, v235
v_mfma_f32_16x16x32_bf16 v[36:39], v[168:171], v[132:135], v[36:39]
v_mul_f32 v239, 0x3acccccd, v239
v_fma_f32 v235, -v242, v242, v235
v_mfma_f32_16x16x32_bf16 v[40:43], v[172:175], v[128:131], v[40:43]
buffer_load_dwordx4 a[128:131], v0, s[4:7], s50 offen offset:1024 sc1
v_mfma_f32_16x16x32_bf16 v[44:47], v[172:175], v[132:135], v[44:47]
ds_read_b128 v[168:171], v5 offset:2048
s_waitcnt lgkmcnt(5)
v_mfma_f32_16x16x32_bf16 v[48:51], v[176:179], v[128:131], v[48:51]
ds_read_b128 v[172:175], v5 offset:3072
v_fma_f32 v239, -v244, v244, v239
v_mfma_f32_16x16x32_bf16 v[52:55], v[176:179], v[132:135], v[52:55]
buffer_load_dwordx4 a[132:135], v0, s[4:7], s50 offen offset:2048 sc1
v_mfma_f32_16x16x32_bf16 v[56:59], v[180:183], v[128:131], v[56:59]
ds_read_b128 v[176:179], v5 offset:4096
v_max_f32 v235, 0, v235
v_mfma_f32_16x16x32_bf16 v[60:63], v[180:183], v[132:135], v[60:63]
v_max_f32 v239, 0, v239
s_waitcnt lgkmcnt(5)
v_mfma_f32_16x16x32_bf16 v[64:67], v[184:187], v[128:131], v[64:67]
ds_read_b128 v[180:183], v5 offset:5120
v_add_f32 v235, 0x3727c5ac, v235
v_mfma_f32_16x16x32_bf16 v[68:71], v[184:187], v[132:135], v[68:71]
buffer_load_dwordx4 a[136:139], v0, s[4:7], s50 offen offset:3072 sc1
v_mfma_f32_16x16x32_bf16 v[72:75], v[188:191], v[128:131], v[72:75]
s_add_u32 s50, s21, 35840
ds_read_b128 v[184:187], v5 offset:6144
v_mfma_f32_16x16x32_bf16 v[76:79], v[188:191], v[132:135], v[76:79]
v_add_f32 v239, 0x3727c5ac, v239
s_waitcnt lgkmcnt(5)
v_mfma_f32_16x16x32_bf16 v[80:83], v[160:163], v[128:131], v[80:83]
buffer_load_dwordx4 a[140:143], v0, s[4:7], s50 offen offset:0 sc1
v_mfma_f32_16x16x32_bf16 v[84:87], v[160:163], v[132:135], v[84:87]
ds_read_b128 v[188:191], v5 offset:7168
v_mfma_f32_16x16x32_bf16 v[88:91], v[164:167], v[128:131], v[88:91]
ds_read_b128 v[160:163], v5 offset:8192
ds_read_b128 v[144:147], v232 offset:0
v_mfma_f32_16x16x32_bf16 v[92:95], v[164:167], v[132:135], v[92:95]
ds_read_b128 v[148:151], v232 offset:64
s_waitcnt lgkmcnt(7)
v_mfma_f32_16x16x32_bf16 v[96:99], v[168:171], v[128:131], v[96:99]
buffer_load_dwordx4 a[144:147], v0, s[4:7], s50 offen offset:1024 sc1
v_mfma_f32_16x16x32_bf16 v[100:103], v[168:171], v[132:135], v[100:103]
ds_read_b128 v[164:167], v5 offset:9216
ds_read_b128 v[152:155], v232 offset:128
v_mfma_f32_16x16x32_bf16 v[104:107], v[172:175], v[128:131], v[104:107]
ds_read_b128 v[168:171], v5 offset:10240
ds_read_b128 v[156:159], v232 offset:192
v_mfma_f32_16x16x32_bf16 v[108:111], v[172:175], v[132:135], v[108:111]
ds_read_b128 v[192:195], v232 offset:256
s_waitcnt lgkmcnt(10)
v_mfma_f32_16x16x32_bf16 v[16:19], v[176:179], v[136:139], v[16:19]
buffer_load_dwordx4 a[148:151], v0, s[4:7], s50 offen offset:2048 sc1
v_mfma_f32_16x16x32_bf16 v[20:23], v[176:179], v[140:143], v[20:23]
ds_read_b128 v[172:175], v5 offset:11264
ds_read_b128 v[196:199], v232 offset:320
v_mfma_f32_16x16x32_bf16 v[24:27], v[180:183], v[136:139], v[24:27]
ds_read_b128 v[176:179], v5 offset:12288
ds_read_b128 v[200:203], v232 offset:384
v_mfma_f32_16x16x32_bf16 v[28:31], v[180:183], v[140:143], v[28:31]
ds_read_b128 v[204:207], v232 offset:448
s_waitcnt lgkmcnt(13)
v_mfma_f32_16x16x32_bf16 v[32:35], v[184:187], v[136:139], v[32:35]
buffer_load_dwordx4 a[152:155], v0, s[4:7], s50 offen offset:3072 sc1
v_mfma_f32_16x16x32_bf16 v[36:39], v[184:187], v[140:143], v[36:39]
s_add_u32 s50, s21, 39936
ds_read_b128 v[180:183], v5 offset:13312
v_mfma_f32_16x16x32_bf16 v[40:43], v[188:191], v[136:139], v[40:43]
ds_read_b128 v[184:187], v5 offset:14336
ds_read_b128 v[208:211], v232 offset:512
v_mfma_f32_16x16x32_bf16 v[44:47], v[188:191], v[140:143], v[44:47]
ds_read_b128 v[212:215], v232 offset:576
s_waitcnt lgkmcnt(13)
v_mfma_f32_16x16x32_bf16 v[48:51], v[160:163], v[136:139], v[48:51]
buffer_load_dwordx4 a[156:159], v0, s[4:7], s50 offen offset:0 sc1
v_mfma_f32_16x16x32_bf16 v[52:55], v[160:163], v[140:143], v[52:55]
ds_read_b128 v[188:191], v5 offset:15360
ds_read_b128 v[216:219], v232 offset:640
v_mfma_f32_16x16x32_bf16 v[56:59], v[164:167], v[136:139], v[56:59]
v_rsq_f32 v243, v235
v_mfma_f32_16x16x32_bf16 v[60:63], v[164:167], v[140:143], v[60:63]
ds_read_b128 v[220:223], v232 offset:704
s_waitcnt lgkmcnt(11)
v_mfma_f32_16x16x32_bf16 v[64:67], v[168:171], v[136:139], v[64:67]
buffer_load_dwordx4 a[160:163], v0, s[4:7], s50 offen offset:1024 sc1
v_mfma_f32_16x16x32_bf16 v[68:71], v[168:171], v[140:143], v[68:71]
v_rsq_f32 v245, v239
v_mfma_f32_16x16x32_bf16 v[72:75], v[172:175], v[136:139], v[72:75]
v_mul_f32 v236, 0xbfb8aa3b, v243
v_mul_f32 v237, v235, v243
v_mfma_f32_16x16x32_bf16 v[76:79], v[172:175], v[140:143], v[76:79]
buffer_load_dwordx4 a[164:167], v0, s[4:7], s50 offen offset:2048 sc1
s_waitcnt lgkmcnt(6)
v_mfma_f32_16x16x32_bf16 v[80:83], v[176:179], v[136:139], v[80:83]
v_mul_f32 v240, 0xbfb8aa3b, v245
v_mul_f32 v241, v239, v245
v_mfma_f32_16x16x32_bf16 v[84:87], v[176:179], v[140:143], v[84:87]
v_mfma_f32_16x16x32_bf16 v[88:91], v[180:183], v[136:139], v[88:91]
buffer_load_dwordx4 a[168:171], v0, s[4:7], s50 offen offset:3072 sc1
v_mfma_f32_16x16x32_bf16 v[92:95], v[180:183], v[140:143], v[92:95]
s_add_u32 s50, s21, 44032
s_waitcnt lgkmcnt(2)
v_mfma_f32_16x16x32_bf16 v[96:99], v[184:187], v[136:139], v[96:99]
v_mfma_f32_16x16x32_bf16 v[100:103], v[184:187], v[140:143], v[100:103]
buffer_load_dwordx4 a[172:175], v0, s[4:7], s50 offen offset:0 sc1
v_mfma_f32_16x16x32_bf16 v[104:107], v[188:191], v[136:139], v[104:107]
v_mfma_f32_16x16x32_bf16 v[108:111], v[188:191], v[140:143], v[108:111]
C_p3e0:
v_pk_fma_f32 v[16:17], v[144:145], v[242:243], v[16:17] op_sel_hi:[1,0,1] neg_lo:[0,1,0] neg_hi:[0,1,0]
v_pk_fma_f32 v[18:19], v[146:147], v[242:243], v[18:19] op_sel_hi:[1,0,1] neg_lo:[0,1,0] neg_hi:[0,1,0]
v_pk_fma_f32 v[32:33], v[152:153], v[242:243], v[32:33] op_sel_hi:[1,0,1] neg_lo:[0,1,0] neg_hi:[0,1,0]
v_pk_fma_f32 v[34:35], v[154:155], v[242:243], v[34:35] op_sel_hi:[1,0,1] neg_lo:[0,1,0] neg_hi:[0,1,0]
v_pk_mul_f32 v[16:17], v[16:17], v[236:237] op_sel_hi:[1,0]
v_pk_mul_f32 v[18:19], v[18:19], v[236:237] op_sel_hi:[1,0]
v_pk_mul_f32 v[32:33], v[32:33], v[236:237] op_sel_hi:[1,0]
v_pk_mul_f32 v[34:35], v[34:35], v[236:237] op_sel_hi:[1,0]
v_exp_f32 v16, v16
v_exp_f32 v17, v17
buffer_load_dwordx4 a[176:179], v0, s[4:7], s50 offen offset:1024 sc1
v_pk_fma_f32 v[24:25], v[148:149], v[242:243], v[24:25] op_sel_hi:[1,0,1] neg_lo:[0,1,0] neg_hi:[0,1,0]
v_exp_f32 v18, v18
v_exp_f32 v19, v19
v_pk_fma_f32 v[26:27], v[150:151], v[242:243], v[26:27] op_sel_hi:[1,0,1] neg_lo:[0,1,0] neg_hi:[0,1,0]
v_exp_f32 v32, v32
v_exp_f32 v33, v33
v_pk_fma_f32 v[40:41], v[156:157], v[242:243], v[40:41] op_sel_hi:[1,0,1] neg_lo:[0,1,0] neg_hi:[0,1,0]
v_exp_f32 v34, v34
v_exp_f32 v35, v35
v_pk_fma_f32 v[42:43], v[158:159], v[242:243], v[42:43] op_sel_hi:[1,0,1] neg_lo:[0,1,0] neg_hi:[0,1,0]
buffer_load_dwordx4 a[180:183], v0, s[4:7], s50 offen offset:2048 sc1
v_pk_fma_f32 v[16:17], v[16:17], v[236:237], v[236:237] op_sel:[0,1,1] op_sel_hi:[1,1,1]
v_pk_fma_f32 v[18:19], v[18:19], v[236:237], v[236:237] op_sel:[0,1,1] op_sel_hi:[1,1,1]
v_pk_fma_f32 v[32:33], v[32:33], v[236:237], v[236:237] op_sel:[0,1,1] op_sel_hi:[1,1,1]
v_pk_fma_f32 v[34:35], v[34:35], v[236:237], v[236:237] op_sel:[0,1,1] op_sel_hi:[1,1,1]
v_rcp_f32 v16, v16
v_rcp_f32 v17, v17
v_rcp_f32 v18, v18
v_rcp_f32 v19, v19
v_rcp_f32 v32, v32
v_rcp_f32 v33, v33
buffer_load_dwordx4 a[184:187], v0, s[4:7], s50 offen offset:3072 sc1
v_rcp_f32 v34, v34
v_rcp_f32 v35, v35
v_pk_mul_f32 v[24:25], v[24:25], v[16:17]
v_pk_mul_f32 v[26:27], v[26:27], v[18:19]
v_pk_mul_f32 v[40:41], v[40:41], v[32:33]
v_pk_mul_f32 v[42:43], v[42:43], v[34:35]
v_cvt_pk_bf16_f32 v112, v24, v25
v_cvt_pk_bf16_f32 v113, v26, v27
v_cvt_pk_bf16_f32 v114, v40, v41
v_cvt_pk_bf16_f32 v115, v42, v43
s_add_u32 s50, s21, 48128
buffer_load_dwordx4 a[188:191], v0, s[4:7], s50 offen offset:0 sc1
buffer_store_dwordx4 v[112:115], v0, s[4:7], s39 offen offset:0 sc1
v_pk_fma_f32 v[20:21], v[144:145], v[244:245], v[20:21] op_sel_hi:[1,0,1] neg_lo:[0,1,0] neg_hi:[0,1,0]
v_pk_fma_f32 v[22:23], v[146:147], v[244:245], v[22:23] op_sel_hi:[1,0,1] neg_lo:[0,1,0] neg_hi:[0,1,0]
v_pk_fma_f32 v[36:37], v[152:153], v[244:245], v[36:37] op_sel_hi:[1,0,1] neg_lo:[0,1,0] neg_hi:[0,1,0]
v_pk_fma_f32 v[38:39], v[154:155], v[244:245], v[38:39] op_sel_hi:[1,0,1] neg_lo:[0,1,0] neg_hi:[0,1,0]
v_pk_mul_f32 v[20:21], v[20:21], v[240:241] op_sel_hi:[1,0]
v_pk_mul_f32 v[22:23], v[22:23], v[240:241] op_sel_hi:[1,0]
v_pk_mul_f32 v[36:37], v[36:37], v[240:241] op_sel_hi:[1,0]
v_pk_mul_f32 v[38:39], v[38:39], v[240:241] op_sel_hi:[1,0]
v_exp_f32 v20, v20
v_exp_f32 v21, v21
buffer_load_dwordx4 a[192:195], v0, s[4:7], s50 offen offset:1024 sc1
v_pk_fma_f32 v[28:29], v[148:149], v[244:245], v[28:29] op_sel_hi:[1,0,1] neg_lo:[0,1,0] neg_hi:[0,1,0]
v_exp_f32 v22, v22
v_exp_f32 v23, v23
v_pk_fma_f32 v[30:31], v[150:151], v[244:245], v[30:31] op_sel_hi:[1,0,1] neg_lo:[0,1,0] neg_hi:[0,1,0]
v_exp_f32 v36, v36
v_exp_f32 v37, v37
v_pk_fma_f32 v[44:45], v[156:157], v[244:245], v[44:45] op_sel_hi:[1,0,1] neg_lo:[0,1,0] neg_hi:[0,1,0]
v_exp_f32 v38, v38
v_exp_f32 v39, v39
v_pk_fma_f32 v[46:47], v[158:159], v[244:245], v[46:47] op_sel_hi:[1,0,1] neg_lo:[0,1,0] neg_hi:[0,1,0]
buffer_load_dwordx4 a[196:199], v0, s[4:7], s50 offen offset:2048 sc1
v_pk_fma_f32 v[20:21], v[20:21], v[240:241], v[240:241] op_sel:[0,1,1] op_sel_hi:[1,1,1]
v_pk_fma_f32 v[22:23], v[22:23], v[240:241], v[240:241] op_sel:[0,1,1] op_sel_hi:[1,1,1]
v_pk_fma_f32 v[36:37], v[36:37], v[240:241], v[240:241] op_sel:[0,1,1] op_sel_hi:[1,1,1]
v_pk_fma_f32 v[38:39], v[38:39], v[240:241], v[240:241] op_sel:[0,1,1] op_sel_hi:[1,1,1]
v_rcp_f32 v20, v20
v_rcp_f32 v21, v21
v_rcp_f32 v22, v22
v_rcp_f32 v23, v23
v_rcp_f32 v36, v36
v_rcp_f32 v37, v37
buffer_load_dwordx4 a[200:203], v0, s[4:7], s50 offen offset:3072 sc1
v_rcp_f32 v38, v38
v_rcp_f32 v39, v39
v_pk_mul_f32 v[28:29], v[28:29], v[20:21]
v_pk_mul_f32 v[30:31], v[30:31], v[22:23]
v_pk_mul_f32 v[44:45], v[44:45], v[36:37]
v_pk_mul_f32 v[46:47], v[46:47], v[38:39]
v_cvt_pk_bf16_f32 v116, v28, v29
v_cvt_pk_bf16_f32 v117, v30, v31
v_cvt_pk_bf16_f32 v118, v44, v45
v_cvt_pk_bf16_f32 v119, v46, v47
s_add_u32 s50, s21, 52224
buffer_load_dwordx4 a[204:207], v0, s[4:7], s50 offen offset:0 sc1
buffer_store_dwordx4 v[116:119], v12, s[4:7], s39 offen offset:0 sc1
v_pk_fma_f32 v[48:49], v[192:193], v[242:243], v[48:49] op_sel_hi:[1,0,1] neg_lo:[0,1,0] neg_hi:[0,1,0]
v_pk_fma_f32 v[50:51], v[194:195], v[242:243], v[50:51] op_sel_hi:[1,0,1] neg_lo:[0,1,0] neg_hi:[0,1,0]
v_pk_fma_f32 v[64:65], v[200:201], v[242:243], v[64:65] op_sel_hi:[1,0,1] neg_lo:[0,1,0] neg_hi:[0,1,0]
v_pk_fma_f32 v[66:67], v[202:203], v[242:243], v[66:67] op_sel_hi:[1,0,1] neg_lo:[0,1,0] neg_hi:[0,1,0]
v_pk_mul_f32 v[48:49], v[48:49], v[236:237] op_sel_hi:[1,0]
v_pk_mul_f32 v[50:51], v[50:51], v[236:237] op_sel_hi:[1,0]
v_pk_mul_f32 v[64:65], v[64:65], v[236:237] op_sel_hi:[1,0]
v_pk_mul_f32 v[66:67], v[66:67], v[236:237] op_sel_hi:[1,0]
v_exp_f32 v48, v48
v_exp_f32 v49, v49
buffer_load_dwordx4 a[208:211], v0, s[4:7], s50 offen offset:1024 sc1
v_pk_fma_f32 v[56:57], v[196:197], v[242:243], v[56:57] op_sel_hi:[1,0,1] neg_lo:[0,1,0] neg_hi:[0,1,0]
v_exp_f32 v50, v50
v_exp_f32 v51, v51
v_pk_fma_f32 v[58:59], v[198:199], v[242:243], v[58:59] op_sel_hi:[1,0,1] neg_lo:[0,1,0] neg_hi:[0,1,0]
v_exp_f32 v64, v64
v_exp_f32 v65, v65
v_pk_fma_f32 v[72:73], v[204:205], v[242:243], v[72:73] op_sel_hi:[1,0,1] neg_lo:[0,1,0] neg_hi:[0,1,0]
v_exp_f32 v66, v66
v_exp_f32 v67, v67
v_pk_fma_f32 v[74:75], v[206:207], v[242:243], v[74:75] op_sel_hi:[1,0,1] neg_lo:[0,1,0] neg_hi:[0,1,0]
buffer_load_dwordx4 a[212:215], v0, s[4:7], s50 offen offset:2048 sc1
v_pk_fma_f32 v[48:49], v[48:49], v[236:237], v[236:237] op_sel:[0,1,1] op_sel_hi:[1,1,1]
v_pk_fma_f32 v[50:51], v[50:51], v[236:237], v[236:237] op_sel:[0,1,1] op_sel_hi:[1,1,1]
v_pk_fma_f32 v[64:65], v[64:65], v[236:237], v[236:237] op_sel:[0,1,1] op_sel_hi:[1,1,1]
v_pk_fma_f32 v[66:67], v[66:67], v[236:237], v[236:237] op_sel:[0,1,1] op_sel_hi:[1,1,1]
v_rcp_f32 v48, v48
v_rcp_f32 v49, v49
v_rcp_f32 v50, v50
v_rcp_f32 v51, v51
v_rcp_f32 v64, v64
v_rcp_f32 v65, v65
buffer_load_dwordx4 a[216:219], v0, s[4:7], s50 offen offset:3072 sc1
v_rcp_f32 v66, v66
v_rcp_f32 v67, v67
v_pk_mul_f32 v[56:57], v[56:57], v[48:49]
v_pk_mul_f32 v[58:59], v[58:59], v[50:51]
v_pk_mul_f32 v[72:73], v[72:73], v[64:65]
v_pk_mul_f32 v[74:75], v[74:75], v[66:67]
v_cvt_pk_bf16_f32 v120, v56, v57
v_cvt_pk_bf16_f32 v121, v58, v59
v_cvt_pk_bf16_f32 v122, v72, v73
v_cvt_pk_bf16_f32 v123, v74, v75
s_add_u32 s50, s21, 56320
buffer_load_dwordx4 a[220:223], v0, s[4:7], s50 offen offset:0 sc1
buffer_store_dwordx4 v[120:123], v0, s[4:7], s39 offen offset:1024 sc1
v_pk_fma_f32 v[52:53], v[192:193], v[244:245], v[52:53] op_sel_hi:[1,0,1] neg_lo:[0,1,0] neg_hi:[0,1,0]
v_pk_fma_f32 v[54:55], v[194:195], v[244:245], v[54:55] op_sel_hi:[1,0,1] neg_lo:[0,1,0] neg_hi:[0,1,0]
v_pk_fma_f32 v[68:69], v[200:201], v[244:245], v[68:69] op_sel_hi:[1,0,1] neg_lo:[0,1,0] neg_hi:[0,1,0]
v_pk_fma_f32 v[70:71], v[202:203], v[244:245], v[70:71] op_sel_hi:[1,0,1] neg_lo:[0,1,0] neg_hi:[0,1,0]
v_pk_mul_f32 v[52:53], v[52:53], v[240:241] op_sel_hi:[1,0]
v_pk_mul_f32 v[54:55], v[54:55], v[240:241] op_sel_hi:[1,0]
v_pk_mul_f32 v[68:69], v[68:69], v[240:241] op_sel_hi:[1,0]
v_pk_mul_f32 v[70:71], v[70:71], v[240:241] op_sel_hi:[1,0]
v_exp_f32 v52, v52
v_exp_f32 v53, v53
buffer_load_dwordx4 a[224:227], v0, s[4:7], s50 offen offset:1024 sc1
v_pk_fma_f32 v[60:61], v[196:197], v[244:245], v[60:61] op_sel_hi:[1,0,1] neg_lo:[0,1,0] neg_hi:[0,1,0]
v_exp_f32 v54, v54
v_exp_f32 v55, v55
v_pk_fma_f32 v[62:63], v[198:199], v[244:245], v[62:63] op_sel_hi:[1,0,1] neg_lo:[0,1,0] neg_hi:[0,1,0]
v_exp_f32 v68, v68
v_exp_f32 v69, v69
v_pk_fma_f32 v[76:77], v[204:205], v[244:245], v[76:77] op_sel_hi:[1,0,1] neg_lo:[0,1,0] neg_hi:[0,1,0]
v_exp_f32 v70, v70
v_exp_f32 v71, v71
v_pk_fma_f32 v[78:79], v[206:207], v[244:245], v[78:79] op_sel_hi:[1,0,1] neg_lo:[0,1,0] neg_hi:[0,1,0]
buffer_load_dwordx4 a[228:231], v0, s[4:7], s50 offen offset:2048 sc1
v_pk_fma_f32 v[52:53], v[52:53], v[240:241], v[240:241] op_sel:[0,1,1] op_sel_hi:[1,1,1]
v_pk_fma_f32 v[54:55], v[54:55], v[240:241], v[240:241] op_sel:[0,1,1] op_sel_hi:[1,1,1]
v_pk_fma_f32 v[68:69], v[68:69], v[240:241], v[240:241] op_sel:[0,1,1] op_sel_hi:[1,1,1]
v_pk_fma_f32 v[70:71], v[70:71], v[240:241], v[240:241] op_sel:[0,1,1] op_sel_hi:[1,1,1]
v_rcp_f32 v52, v52
v_rcp_f32 v53, v53
v_rcp_f32 v54, v54
v_rcp_f32 v55, v55
v_rcp_f32 v68, v68
v_rcp_f32 v69, v69
buffer_load_dwordx4 a[232:235], v0, s[4:7], s50 offen offset:3072 sc1
v_rcp_f32 v70, v70
v_rcp_f32 v71, v71
v_pk_mul_f32 v[60:61], v[60:61], v[52:53]
v_pk_mul_f32 v[62:63], v[62:63], v[54:55]
v_pk_mul_f32 v[76:77], v[76:77], v[68:69]
v_pk_mul_f32 v[78:79], v[78:79], v[70:71]
v_cvt_pk_bf16_f32 v124, v60, v61
v_cvt_pk_bf16_f32 v125, v62, v63
v_cvt_pk_bf16_f32 v126, v76, v77
v_cvt_pk_bf16_f32 v127, v78, v79
s_add_u32 s50, s21, 60416
buffer_load_dwordx4 a[236:239], v0, s[4:7], s50 offen offset:0 sc1
buffer_store_dwordx4 v[124:127], v12, s[4:7], s39 offen offset:1024 sc1
v_pk_fma_f32 v[80:81], v[208:209], v[242:243], v[80:81] op_sel_hi:[1,0,1] neg_lo:[0,1,0] neg_hi:[0,1,0]
v_pk_fma_f32 v[82:83], v[210:211], v[242:243], v[82:83] op_sel_hi:[1,0,1] neg_lo:[0,1,0] neg_hi:[0,1,0]
s_waitcnt lgkmcnt(1)
v_pk_fma_f32 v[96:97], v[216:217], v[242:243], v[96:97] op_sel_hi:[1,0,1] neg_lo:[0,1,0] neg_hi:[0,1,0]
v_pk_fma_f32 v[98:99], v[218:219], v[242:243], v[98:99] op_sel_hi:[1,0,1] neg_lo:[0,1,0] neg_hi:[0,1,0]
v_pk_mul_f32 v[80:81], v[80:81], v[236:237] op_sel_hi:[1,0]
v_pk_mul_f32 v[82:83], v[82:83], v[236:237] op_sel_hi:[1,0]
v_pk_mul_f32 v[96:97], v[96:97], v[236:237] op_sel_hi:[1,0]
v_pk_mul_f32 v[98:99], v[98:99], v[236:237] op_sel_hi:[1,0]
v_exp_f32 v80, v80
v_exp_f32 v81, v81
v_pk_fma_f32 v[88:89], v[212:213], v[242:243], v[88:89] op_sel_hi:[1,0,1] neg_lo:[0,1,0] neg_hi:[0,1,0]
v_exp_f32 v82, v82
v_exp_f32 v83, v83
v_pk_fma_f32 v[90:91], v[214:215], v[242:243], v[90:91] op_sel_hi:[1,0,1] neg_lo:[0,1,0] neg_hi:[0,1,0]
v_exp_f32 v96, v96
v_exp_f32 v97, v97
s_waitcnt lgkmcnt(0)
v_pk_fma_f32 v[104:105], v[220:221], v[242:243], v[104:105] op_sel_hi:[1,0,1] neg_lo:[0,1,0] neg_hi:[0,1,0]
v_exp_f32 v98, v98
v_exp_f32 v99, v99
v_pk_fma_f32 v[106:107], v[222:223], v[242:243], v[106:107] op_sel_hi:[1,0,1] neg_lo:[0,1,0] neg_hi:[0,1,0]
v_pk_fma_f32 v[80:81], v[80:81], v[236:237], v[236:237] op_sel:[0,1,1] op_sel_hi:[1,1,1]
v_pk_fma_f32 v[82:83], v[82:83], v[236:237], v[236:237] op_sel:[0,1,1] op_sel_hi:[1,1,1]
v_pk_fma_f32 v[96:97], v[96:97], v[236:237], v[236:237] op_sel:[0,1,1] op_sel_hi:[1,1,1]
v_pk_fma_f32 v[98:99], v[98:99], v[236:237], v[236:237] op_sel:[0,1,1] op_sel_hi:[1,1,1]
v_rcp_f32 v80, v80
v_rcp_f32 v81, v81
v_rcp_f32 v82, v82
v_rcp_f32 v83, v83
v_rcp_f32 v96, v96
v_rcp_f32 v97, v97
v_rcp_f32 v98, v98
v_rcp_f32 v99, v99
v_pk_mul_f32 v[88:89], v[88:89], v[80:81]
v_pk_mul_f32 v[90:91], v[90:91], v[82:83]
v_pk_mul_f32 v[104:105], v[104:105], v[96:97]
v_pk_mul_f32 v[106:107], v[106:107], v[98:99]
v_cvt_pk_bf16_f32 v128, v88, v89
v_cvt_pk_bf16_f32 v129, v90, v91
v_cvt_pk_bf16_f32 v130, v104, v105
v_cvt_pk_bf16_f32 v131, v106, v107
buffer_store_dwordx4 v[128:131], v0, s[4:7], s39 offen offset:2048 sc1
v_pk_fma_f32 v[84:85], v[208:209], v[244:245], v[84:85] op_sel_hi:[1,0,1] neg_lo:[0,1,0] neg_hi:[0,1,0]
v_pk_fma_f32 v[86:87], v[210:211], v[244:245], v[86:87] op_sel_hi:[1,0,1] neg_lo:[0,1,0] neg_hi:[0,1,0]
v_pk_fma_f32 v[100:101], v[216:217], v[244:245], v[100:101] op_sel_hi:[1,0,1] neg_lo:[0,1,0] neg_hi:[0,1,0]
v_pk_fma_f32 v[102:103], v[218:219], v[244:245], v[102:103] op_sel_hi:[1,0,1] neg_lo:[0,1,0] neg_hi:[0,1,0]
v_pk_mul_f32 v[84:85], v[84:85], v[240:241] op_sel_hi:[1,0]
v_pk_mul_f32 v[86:87], v[86:87], v[240:241] op_sel_hi:[1,0]
v_pk_mul_f32 v[100:101], v[100:101], v[240:241] op_sel_hi:[1,0]
v_pk_mul_f32 v[102:103], v[102:103], v[240:241] op_sel_hi:[1,0]
v_exp_f32 v84, v84
v_exp_f32 v85, v85
v_pk_fma_f32 v[92:93], v[212:213], v[244:245], v[92:93] op_sel_hi:[1,0,1] neg_lo:[0,1,0] neg_hi:[0,1,0]
v_exp_f32 v86, v86
v_exp_f32 v87, v87
v_pk_fma_f32 v[94:95], v[214:215], v[244:245], v[94:95] op_sel_hi:[1,0,1] neg_lo:[0,1,0] neg_hi:[0,1,0]
v_exp_f32 v100, v100
v_exp_f32 v101, v101
v_pk_fma_f32 v[108:109], v[220:221], v[244:245], v[108:109] op_sel_hi:[1,0,1] neg_lo:[0,1,0] neg_hi:[0,1,0]
v_exp_f32 v102, v102
v_exp_f32 v103, v103
v_pk_fma_f32 v[110:111], v[222:223], v[244:245], v[110:111] op_sel_hi:[1,0,1] neg_lo:[0,1,0] neg_hi:[0,1,0]
v_pk_fma_f32 v[84:85], v[84:85], v[240:241], v[240:241] op_sel:[0,1,1] op_sel_hi:[1,1,1]
v_pk_fma_f32 v[86:87], v[86:87], v[240:241], v[240:241] op_sel:[0,1,1] op_sel_hi:[1,1,1]
v_pk_fma_f32 v[100:101], v[100:101], v[240:241], v[240:241] op_sel:[0,1,1] op_sel_hi:[1,1,1]
v_pk_fma_f32 v[102:103], v[102:103], v[240:241], v[240:241] op_sel:[0,1,1] op_sel_hi:[1,1,1]
v_rcp_f32 v84, v84
v_rcp_f32 v85, v85
v_rcp_f32 v86, v86
v_rcp_f32 v87, v87
v_rcp_f32 v100, v100
v_rcp_f32 v101, v101
v_rcp_f32 v102, v102
v_rcp_f32 v103, v103
v_pk_mul_f32 v[92:93], v[92:93], v[84:85]
v_pk_mul_f32 v[94:95], v[94:95], v[86:87]
v_pk_mul_f32 v[108:109], v[108:109], v[100:101]
v_pk_mul_f32 v[110:111], v[110:111], v[102:103]
v_cvt_pk_bf16_f32 v132, v92, v93
v_cvt_pk_bf16_f32 v133, v94, v95
v_cvt_pk_bf16_f32 v134, v108, v109
v_cvt_pk_bf16_f32 v135, v110, v111
buffer_store_dwordx4 v[132:135], v12, s[4:7], s39 offen offset:2048 sc1
s_add_u32 s48, s12, 1
s_and_b32 s48, s48, 3
s_mul_i32 s48, s48, 15360
s_add_u32 s48, s48, 98304
v_add_u32 v228, s48, v0
s_add_u32 s48, s12, 2
s_and_b32 s48, s48, 3
s_mul_i32 s48, s48, 15360
s_add_u32 s48, s48, 103424
v_add_u32 v229, s48, v0
s_add_u32 s48, s12, 3
s_and_b32 s48, s48, 3
s_mul_i32 s48, s48, 15360
s_add_u32 s48, s48, 108544
v_add_u32 v230, s48, v0
s_mul_i32 s48, s12, 15360
s_add_u32 s48, s48, 98304
v_add_u32 v231, s48, v0
v_lshlrev_b32 v232, 5, v9
v_and_b32 v233, 0x180, v232
s_lshl_b32 s54, s14, 2
s_add_u32 s54, s54, s40
s_add_u32 s54, s54, 4096
s_waitcnt vmcnt(0)
s_barrier
s_cmp_lg_u32 s12, 0
s_cbranch_scc1 SY20
s_mov_b64 exec, 1
s_cmp_eq_u32 s15, 0
s_cbranch_scc1 SY22
buffer_store_dword v10, off, s[4:7], s54
s_branch SY23
SY22:
buffer_wbl2 sc1
s_waitcnt vmcnt(0)
buffer_store_dword v10, off, s[4:7], s54 sc1
SY23:
s_mov_b64 exec, -1
s_add_u32 s48, s40, 4096
PL24:
buffer_load_dword v18, v9, s[4:7], s48 offen sc1
s_waitcnt vmcnt(0)
v_cmp_ne_u32 vcc, s89, v18
s_nop 1
s_cmp_eq_u64 vcc, 0
s_cbranch_scc1 PL25
s_sub_u32 s45, s45, 1
s_cbranch_scc0 PL24
s_mov_b32 s45, 0
PL25:
s_cmp_lg_u32 s15, 0
s_cbranch_scc1 SY21
buffer_inv sc1
s_waitcnt vmcnt(0)
s_branch SY21
SY20:
SY21:
s_barrier
s_add_u32 s51, s26, 5242880
buffer_load_dwordx4 v[56:59], v0, s[4:7], s51 offen offset:0 sc1
buffer_load_dwordx4 v[60:63], v0, s[4:7], s51 offen offset:1024 sc1
buffer_load_dwordx4 v[64:67], v0, s[4:7], s51 offen offset:2048 sc1
buffer_load_dwordx4 v[68:71], v0, s[4:7], s51 offen offset:3072 sc1
s_add_u32 s51, s26, 5246976
buffer_load_dwordx4 v[72:75], v0, s[4:7], s51 offen offset:0 sc1
buffer_load_dwordx4 v[76:79], v0, s[4:7], s51 offen offset:1024 sc1
s_waitcnt vmcnt(5)
v_mfma_f32_16x16x32_bf16 v[16:19], a[0:3], v[56:59], 0
buffer_load_dwordx4 v[80:83], v0, s[4:7], s51 offen offset:2048 sc1
v_mfma_f32_16x16x32_bf16 v[20:23], a[4:7], v[56:59], 0
v_mfma_f32_16x16x32_bf16 v[24:27], a[8:11], v[56:59], 0
v_mfma_f32_16x16x32_bf16 v[28:31], a[12:15], v[56:59], 0
v_mfma_f32_16x16x32_bf16 v[32:35], a[16:19], v[56:59], 0
s_waitcnt vmcnt(5)
v_mfma_f32_16x16x32_bf16 v[16:19], a[20:23], v[60:63], v[16:19]
buffer_load_dwordx4 v[84:87], v0, s[4:7], s51 offen offset:3072 sc1
v_mfma_f32_16x16x32_bf16 v[20:23], a[24:27], v[60:63], v[20:23]
s_add_u32 s51, s26, 5251072
v_mfma_f32_16x16x32_bf16 v[24:27], a[28:31], v[60:63], v[24:27]
v_mfma_f32_16x16x32_bf16 v[28:31], a[32:35], v[60:63], v[28:31]
buffer_load_dwordx4 v[88:91], v0, s[4:7], s51 offen offset:0 sc1
v_mfma_f32_16x16x32_bf16 v[32:35], a[36:39], v[60:63], v[32:35]
s_waitcnt vmcnt(6)
v_mfma_f32_16x16x32_bf16 v[16:19], a[40:43], v[64:67], v[16:19]
v_mfma_f32_16x16x32_bf16 v[20:23], a[44:47], v[64:67], v[20:23]
v_mfma_f32_16x16x32_bf16 v[24:27], a[48:51], v[64:67], v[24:27]
buffer_load_dwordx4 v[92:95], v0, s[4:7], s51 offen offset:1024 sc1
v_mfma_f32_16x16x32_bf16 v[28:31], a[52:55], v[64:67], v[28:31]
v_mfma_f32_16x16x32_bf16 v[32:35], a[56:59], v[64:67], v[32:35]
s_waitcnt vmcnt(6)
v_mfma_f32_16x16x32_bf16 v[16:19], a[60:63], v[68:71], v[16:19]
v_mfma_f32_16x16x32_bf16 v[20:23], a[64:67], v[68:71], v[20:23]
buffer_load_dwordx4 v[96:99], v0, s[4:7], s51 offen offset:2048 sc1
v_mfma_f32_16x16x32_bf16 v[24:27], a[68:71], v[68:71], v[24:27]
v_mfma_f32_16x16x32_bf16 v[28:31], a[72:75], v[68:71], v[28:31]
v_mfma_f32_16x16x32_bf16 v[32:35], a[76:79], v[68:71], v[32:35]
s_waitcnt vmcnt(6)
v_mfma_f32_16x16x32_bf16 v[16:19], a[80:83], v[72:75], v[16:19]
buffer_load_dwordx4 v[100:103], v0, s[4:7], s51 offen offset:3072 sc1
v_mfma_f32_16x16x32_bf16 v[20:23], a[84:87], v[72:75], v[20:23]
s_add_u32 s51, s27, 5242880
v_mfma_f32_16x16x32_bf16 v[24:27], a[88:91], v[72:75], v[24:27]
v_mfma_f32_16x16x32_bf16 v[28:31], a[92:95], v[72:75], v[28:31]
v_mfma_f32_16x16x32_bf16 v[32:35], a[96:99], v[72:75], v[32:35]
s_waitcnt vmcnt(6)
v_mfma_f32_16x16x32_bf16 v[16:19], a[100:103], v[76:79], v[16:19]
buffer_load_dwordx4 v[104:107], v0, s[4:7], s51 offen offset:0 sc1
v_mfma_f32_16x16x32_bf16 v[20:23], a[104:107], v[76:79], v[20:23]
v_mfma_f32_16x16x32_bf16 v[24:27], a[108:111], v[76:79], v[24:27]
v_mfma_f32_16x16x32_bf16 v[28:31], a[112:115], v[76:79], v[28:31]
buffer_load_dwordx4 v[108:111], v0, s[4:7], s51 offen offset:1024 sc1
v_mfma_f32_16x16x32_bf16 v[32:35], a[116:119], v[76:79], v[32:35]
s_waitcnt vmcnt(7)
v_mfma_f32_16x16x32_bf16 v[16:19], a[120:123], v[80:83], v[16:19]
v_mfma_f32_16x16x32_bf16 v[20:23], a[124:127], v[80:83], v[20:23]
v_mfma_f32_16x16x32_bf16 v[24:27], a[128:131], v[80:83], v[24:27]
buffer_load_dwordx4 v[112:115], v0, s[4:7], s51 offen offset:2048 sc1
v_mfma_f32_16x16x32_bf16 v[28:31], a[132:135], v[80:83], v[28:31]
v_mfma_f32_16x16x32_bf16 v[32:35], a[136:139], v[80:83], v[32:35]
s_waitcnt vmcnt(7)
v_mfma_f32_16x16x32_bf16 v[16:19], a[140:143], v[84:87], v[16:19]
v_mfma_f32_16x16x32_bf16 v[20:23], a[144:147], v[84:87], v[20:23]
buffer_load_dwordx4 v[116:119], v0, s[4:7], s51 offen offset:3072 sc1
v_mfma_f32_16x16x32_bf16 v[24:27], a[148:151], v[84:87], v[24:27]
s_add_u32 s51, s27, 5246976
v_mfma_f32_16x16x32_bf16 v[28:31], a[152:155], v[84:87], v[28:31]
v_mfma_f32_16x16x32_bf16 v[32:35], a[156:159], v[84:87], v[32:35]
s_waitcnt vmcnt(7)
v_mfma_f32_16x16x32_bf16 v[16:19], a[160:163], v[88:91], v[16:19]
buffer_load_dwordx4 v[120:123], v0, s[4:7], s51 offen offset:0 sc1
v_mfma_f32_16x16x32_bf16 v[20:23], a[164:167], v[88:91], v[20:23]
v_mfma_f32_16x16x32_bf16 v[24:27], a[168:171], v[88:91], v[24:27]
v_mfma_f32_16x16x32_bf16 v[28:31], a[172:175], v[88:91], v[28:31]
v_mfma_f32_16x16x32_bf16 v[32:35], a[176:179], v[88:91], v[32:35]
s_waitcnt vmcnt(7)
v_mfma_f32_16x16x32_bf16 v[16:19], a[180:183], v[92:95], v[16:19]
buffer_load_dwordx4 v[124:127], v0, s[4:7], s51 offen offset:1024 sc1
v_mfma_f32_16x16x32_bf16 v[20:23], a[184:187], v[92:95], v[20:23]
v_mfma_f32_16x16x32_bf16 v[24:27], a[188:191], v[92:95], v[24:27]
v_mfma_f32_16x16x32_bf16 v[28:31], a[192:195], v[92:95], v[28:31]
buffer_load_dwordx4 v[128:131], v0, s[4:7], s51 offen offset:2048 sc1
v_mfma_f32_16x16x32_bf16 v[32:35], a[196:199], v[92:95], v[32:35]
s_waitcnt vmcnt(8)
v_mfma_f32_16x16x32_bf16 v[16:19], a[200:203], v[96:99], v[16:19]
v_mfma_f32_16x16x32_bf16 v[20:23], a[204:207], v[96:99], v[20:23]
v_mfma_f32_16x16x32_bf16 v[24:27], a[208:211], v[96:99], v[24:27]
buffer_load_dwordx4 v[132:135], v0, s[4:7], s51 offen offset:3072 sc1
v_mfma_f32_16x16x32_bf16 v[28:31], a[212:215], v[96:99], v[28:31]
s_add_u32 s51, s27, 5251072
v_mfma_f32_16x16x32_bf16 v[32:35], a[216:219], v[96:99], v[32:35]
s_waitcnt vmcnt(8)
v_mfma_f32_16x16x32_bf16 v[16:19], a[220:223], v[100:103], v[16:19]
v_mfma_f32_16x16x32_bf16 v[20:23], a[224:227], v[100:103], v[20:23]
buffer_load_dwordx4 v[136:139], v0, s[4:7], s51 offen offset:0 sc1
v_mfma_f32_16x16x32_bf16 v[24:27], a[228:231], v[100:103], v[24:27]
v_mfma_f32_16x16x32_bf16 v[28:31], a[232:235], v[100:103], v[28:31]
v_mfma_f32_16x16x32_bf16 v[32:35], a[236:239], v[100:103], v[32:35]
s_waitcnt vmcnt(8)
v_mfma_f32_16x16x32_bf16 v[36:39], a[0:3], v[104:107], 0
buffer_load_dwordx4 v[140:143], v0, s[4:7], s51 offen offset:1024 sc1
v_mfma_f32_16x16x32_bf16 v[40:43], a[4:7], v[104:107], 0
v_mfma_f32_16x16x32_bf16 v[44:47], a[8:11], v[104:107], 0
v_mfma_f32_16x16x32_bf16 v[48:51], a[12:15], v[104:107], 0
ds_write_b128 v228, v[16:19] offset:0
v_mfma_f32_16x16x32_bf16 v[52:55], a[16:19], v[104:107], 0
s_waitcnt vmcnt(8)
v_mfma_f32_16x16x32_bf16 v[36:39], a[20:23], v[108:111], v[36:39]
buffer_load_dwordx4 v[144:147], v0, s[4:7], s51 offen offset:2048 sc1
v_mfma_f32_16x16x32_bf16 v[40:43], a[24:27], v[108:111], v[40:43]
ds_write_b128 v228, v[20:23] offset:1024
v_mfma_f32_16x16x32_bf16 v[44:47], a[28:31], v[108:111], v[44:47]
ds_write_b128 v228, v[24:27] offset:2048
v_mfma_f32_16x16x32_bf16 v[48:51], a[32:35], v[108:111], v[48:51]
buffer_load_dwordx4 v[148:151], v0, s[4:7], s51 offen offset:3072 sc1
v_mfma_f32_16x16x32_bf16 v[52:55], a[36:39], v[108:111], v[52:55]
s_add_u32 s51, s28, 5242880
s_waitcnt vmcnt(9)
v_mfma_f32_16x16x32_bf16 v[36:39], a[40:43], v[112:115], v[36:39]
ds_write_b128 v228, v[28:31] offset:3072
v_mfma_f32_16x16x32_bf16 v[40:43], a[44:47], v[112:115], v[40:43]
ds_write_b128 v228, v[32:35] offset:4096
v_mfma_f32_16x16x32_bf16 v[44:47], a[48:51], v[112:115], v[44:47]
buffer_load_dwordx4 v[56:59], v0, s[4:7], s51 offen offset:0 sc1
v_mfma_f32_16x16x32_bf16 v[48:51], a[52:55], v[112:115], v[48:51]
v_mfma_f32_16x16x32_bf16 v[52:55], a[56:59], v[112:115], v[52:55]
s_waitcnt vmcnt(9)
v_mfma_f32_16x16x32_bf16 v[36:39], a[60:63], v[116:119], v[36:39]
v_mfma_f32_16x16x32_bf16 v[40:43], a[64:67], v[116:119], v[40:43]
buffer_load_dwordx4 v[60:63], v0, s[4:7], s51 offen offset:1024 sc1
v_mfma_f32_16x16x32_bf16 v[44:47], a[68:71], v[116:119], v[44:47]
v_mfma_f32_16x16x32_bf16 v[48:51], a[72:75], v[116:119], v[48:51]
v_mfma_f32_16x16x32_bf16 v[52:55], a[76:79], v[116:119], v[52:55]
s_waitcnt vmcnt(9)
v_mfma_f32_16x16x32_bf16 v[36:39], a[80:83], v[120:123], v[36:39]
buffer_load_dwordx4 v[64:67], v0, s[4:7], s51 offen offset:2048 sc1
v_mfma_f32_16x16x32_bf16 v[40:43], a[84:87], v[120:123], v[40:43]
s_add_u32 m0, s42, 0
s_add_u32 s49, s18, 0
v_mfma_f32_16x16x32_bf16 v[44:47], a[88:91], v[120:123], v[44:47]
buffer_load_dwordx4 v0, s[4:7], s49 offen offset:0 sc1 lds
v_mfma_f32_16x16x32_bf16 v[48:51], a[92:95], v[120:123], v[48:51]
v_mfma_f32_16x16x32_bf16 v[52:55], a[96:99], v[120:123], v[52:55]
s_waitcnt vmcnt(10)
v_mfma_f32_16x16x32_bf16 v[36:39], a[100:103], v[124:127], v[36:39]
buffer_load_dwordx4 v[68:71], v0, s[4:7], s51 offen offset:3072 sc1
v_mfma_f32_16x16x32_bf16 v[40:43], a[104:107], v[124:127], v[40:43]
s_add_u32 s51, s28, 5246976
v_mfma_f32_16x16x32_bf16 v[44:47], a[108:111], v[124:127], v[44:47]
v_mfma_f32_16x16x32_bf16 v[48:51], a[112:115], v[124:127], v[48:51]
buffer_load_dwordx4 v[72:75], v0, s[4:7], s51 offen offset:0 sc1
v_mfma_f32_16x16x32_bf16 v[52:55], a[116:119], v[124:127], v[52:55]
s_waitcnt vmcnt(11)
v_mfma_f32_16x16x32_bf16 v[36:39], a[120:123], v[128:131], v[36:39]
buffer_load_dwordx4 v0, s[4:7], s49 offen offset:1024 sc1 lds
v_mfma_f32_16x16x32_bf16 v[40:43], a[124:127], v[128:131], v[40:43]
v_mfma_f32_16x16x32_bf16 v[44:47], a[128:131], v[128:131], v[44:47]
buffer_load_dwordx4 v[76:79], v0, s[4:7], s51 offen offset:1024 sc1
v_mfma_f32_16x16x32_bf16 v[48:51], a[132:135], v[128:131], v[48:51]
v_mfma_f32_16x16x32_bf16 v[52:55], a[136:139], v[128:131], v[52:55]
s_waitcnt vmcnt(12)
v_mfma_f32_16x16x32_bf16 v[36:39], a[140:143], v[132:135], v[36:39]
v_mfma_f32_16x16x32_bf16 v[40:43], a[144:147], v[132:135], v[40:43]
buffer_load_dwordx4 v[80:83], v0, s[4:7], s51 offen offset:2048 sc1
v_mfma_f32_16x16x32_bf16 v[44:47], a[148:151], v[132:135], v[44:47]
v_mfma_f32_16x16x32_bf16 v[48:51], a[152:155], v[132:135], v[48:51]
v_mfma_f32_16x16x32_bf16 v[52:55], a[156:159], v[132:135], v[52:55]
s_waitcnt vmcnt(12)
v_mfma_f32_16x16x32_bf16 v[36:39], a[160:163], v[136:139], v[36:39]
buffer_load_dwordx4 v[84:87], v0, s[4:7], s51 offen offset:3072 sc1
v_mfma_f32_16x16x32_bf16 v[40:43], a[164:167], v[136:139], v[40:43]
s_add_u32 m0, s42, 8192
s_add_u32 s49, s18, 8192
v_mfma_f32_16x16x32_bf16 v[44:47], a[168:171], v[136:139], v[44:47]
buffer_load_dwordx4 v0, s[4:7], s49 offen offset:0 sc1 lds
v_mfma_f32_16x16x32_bf16 v[48:51], a[172:175], v[136:139], v[48:51]
s_add_u32 s51, s28, 5251072
v_mfma_f32_16x16x32_bf16 v[52:55], a[176:179], v[136:139], v[52:55]
s_waitcnt vmcnt(13)
v_mfma_f32_16x16x32_bf16 v[36:39], a[180:183], v[140:143], v[36:39]
buffer_load_dwordx4 v[88:91], v0, s[4:7], s51 offen offset:0 sc1
v_mfma_f32_16x16x32_bf16 v[40:43], a[184:187], v[140:143], v[40:43]
v_mfma_f32_16x16x32_bf16 v[44:47], a[188:191], v[140:143], v[44:47]
v_mfma_f32_16x16x32_bf16 v[48:51], a[192:195], v[140:143], v[48:51]
buffer_load_dwordx4 v[92:95], v0, s[4:7], s51 offen offset:1024 sc1
v_mfma_f32_16x16x32_bf16 v[52:55], a[196:199], v[140:143], v[52:55]
s_waitcnt vmcnt(14)
v_mfma_f32_16x16x32_bf16 v[36:39], a[200:203], v[144:147], v[36:39]
buffer_load_dwordx4 v0, s[4:7], s49 offen offset:1024 sc1 lds
v_mfma_f32_16x16x32_bf16 v[40:43], a[204:207], v[144:147], v[40:43]
v_mfma_f32_16x16x32_bf16 v[44:47], a[208:211], v[144:147], v[44:47]
buffer_load_dwordx4 v[96:99], v0, s[4:7], s51 offen offset:2048 sc1
v_mfma_f32_16x16x32_bf16 v[48:51], a[212:215], v[144:147], v[48:51]
v_mfma_f32_16x16x32_bf16 v[52:55], a[216:219], v[144:147], v[52:55]
s_waitcnt vmcnt(15)
v_mfma_f32_16x16x32_bf16 v[36:39], a[220:223], v[148:151], v[36:39]
v_mfma_f32_16x16x32_bf16 v[40:43], a[224:227], v[148:151], v[40:43]
buffer_load_dwordx4 v[100:103], v0, s[4:7], s51 offen offset:3072 sc1
v_mfma_f32_16x16x32_bf16 v[44:47], a[228:231], v[148:151], v[44:47]
s_add_u32 s51, s29, 5242880
v_mfma_f32_16x16x32_bf16 v[48:51], a[232:235], v[148:151], v[48:51]
v_mfma_f32_16x16x32_bf16 v[52:55], a[236:239], v[148:151], v[52:55]
s_waitcnt vmcnt(15)
v_mfma_f32_16x16x32_bf16 v[16:19], a[0:3], v[56:59], 0
buffer_load_dwordx4 v[104:107], v0, s[4:7], s51 offen offset:0 sc1
v_mfma_f32_16x16x32_bf16 v[20:23], a[4:7], v[56:59], 0
s_add_u32 m0, s42, 16384
s_add_u32 s49, s18, 16384
v_mfma_f32_16x16x32_bf16 v[24:27], a[8:11], v[56:59], 0
buffer_load_dwordx4 v0, s[4:7], s49 offen offset:0 sc1 lds
v_mfma_f32_16x16x32_bf16 v[28:31], a[12:15], v[56:59], 0
ds_write_b128 v229, v[36:39] offset:0
v_mfma_f32_16x16x32_bf16 v[32:35], a[16:19], v[56:59], 0
s_waitcnt vmcnt(16)
v_mfma_f32_16x16x32_bf16 v[16:19], a[20:23], v[60:63], v[16:19]
buffer_load_dwordx4 v[108:111], v0, s[4:7], s51 offen offset:1024 sc1
v_mfma_f32_16x16x32_bf16 v[20:23], a[24:27], v[60:63], v[20:23]
ds_write_b128 v229, v[40:43] offset:1024
v_mfma_f32_16x16x32_bf16 v[24:27], a[28:31], v[60:63], v[24:27]
ds_write_b128 v229, v[44:47] offset:2048
v_mfma_f32_16x16x32_bf16 v[28:31], a[32:35], v[60:63], v[28:31]
buffer_load_dwordx4 v[112:115], v0, s[4:7], s51 offen offset:2048 sc1
v_mfma_f32_16x16x32_bf16 v[32:35], a[36:39], v[60:63], v[32:35]
s_waitcnt vmcnt(17)
v_mfma_f32_16x16x32_bf16 v[16:19], a[40:43], v[64:67], v[16:19]
buffer_load_dwordx4 v0, s[4:7], s49 offen offset:1024 sc1 lds
v_mfma_f32_16x16x32_bf16 v[20:23], a[44:47], v[64:67], v[20:23]
ds_write_b128 v229, v[48:51] offset:3072
ds_write_b128 v229, v[52:55] offset:4096
v_mfma_f32_16x16x32_bf16 v[24:27], a[48:51], v[64:67], v[24:27]
buffer_load_dwordx4 v[116:119], v0, s[4:7], s51 offen offset:3072 sc1
v_mfma_f32_16x16x32_bf16 v[28:31], a[52:55], v[64:67], v[28:31]
s_add_u32 s51, s29, 5246976
v_lshlrev_b32 v36, 16, v246
v_mfma_f32_16x16x32_bf16 v[32:35], a[56:59], v[64:67], v[32:35]
v_and_b32 v37, 0xffff0000, v246
s_waitcnt vmcnt(17)
v_mfma_f32_16x16x32_bf16 v[16:19], a[60:63], v[68:71], v[16:19]
v_lshlrev_b32 v38, 16, v247
v_and_b32 v39, 0xffff0000, v247
v_mfma_f32_16x16x32_bf16 v[20:23], a[64:67], v[68:71], v[20:23]
buffer_load_dwordx4 v[120:123], v0, s[4:7], s51 offen offset:0 sc1
v_mfma_f32_16x16x32_bf16 v[24:27], a[68:71], v[68:71], v[24:27]
v_lshlrev_b32 v40, 16, v248
v_and_b32 v41, 0xffff0000, v248
v_mfma_f32_16x16x32_bf16 v[28:31], a[72:75], v[68:71], v[28:31]
v_lshlrev_b32 v42, 16, v249
v_and_b32 v43, 0xffff0000, v249
v_mfma_f32_16x16x32_bf16 v[32:35], a[76:79], v[68:71], v[32:35]
v_lshlrev_b32 v44, 16, v250
s_waitcnt vmcnt(17)
v_mfma_f32_16x16x32_bf16 v[16:19], a[80:83], v[72:75], v[16:19]
buffer_load_dwordx4 v[124:127], v0, s[4:7], s51 offen offset:1024 sc1
v_mfma_f32_16x16x32_bf16 v[20:23], a[84:87], v[72:75], v[20:23]
s_add_u32 m0, s42, 24576
s_add_u32 s49, s18, 24576
v_mfma_f32_16x16x32_bf16 v[24:27], a[88:91], v[72:75], v[24:27]
buffer_load_dwordx4 v0, s[4:7], s49 offen offset:0 sc1 lds
v_mfma_f32_16x16x32_bf16 v[28:31], a[92:95], v[72:75], v[28:31]
v_and_b32 v45, 0xffff0000, v250
v_lshlrev_b32 v46, 16, v251
v_mfma_f32_16x16x32_bf16 v[32:35], a[96:99], v[72:75], v[32:35]
v_and_b32 v47, 0xffff0000, v251
s_waitcnt vmcnt(17)
v_mfma_f32_16x16x32_bf16 v[16:19], a[100:103], v[76:79], v[16:19]
buffer_load_dwordx4 v[128:131], v0, s[4:7], s51 offen offset:2048 sc1
v_mfma_f32_16x16x32_bf16 v[20:23], a[104:107], v[76:79], v[20:23]
v_lshlrev_b32 v48, 16, v252
v_and_b32 v49, 0xffff0000, v252
v_mfma_f32_16x16x32_bf16 v[24:27], a[108:111], v[76:79], v[24:27]
v_lshlrev_b32 v50, 16, v253
v_and_b32 v51, 0xffff0000, v253
v_mfma_f32_16x16x32_bf16 v[28:31], a[112:115], v[76:79], v[28:31]
buffer_load_dwordx4 v[132:135], v0, s[4:7], s51 offen offset:3072 sc1
v_mfma_f32_16x16x32_bf16 v[32:35], a[116:119], v[76:79], v[32:35]
v_lshlrev_b32 v52, 16, v254
s_waitcnt vmcnt(18)
v_mfma_f32_16x16x32_bf16 v[16:19], a[120:123], v[80:83], v[16:19]
buffer_load_dwordx4 v0, s[4:7], s49 offen offset:1024 sc1 lds
v_mfma_f32_16x16x32_bf16 v[20:23], a[124:127], v[80:83], v[20:23]
s_add_u32 s51, s29, 5251072
v_and_b32 v53, 0xffff0000, v254
v_mfma_f32_16x16x32_bf16 v[24:27], a[128:131], v[80:83], v[24:27]
buffer_load_dwordx4 v[136:139], v0, s[4:7], s51 offen offset:0 sc1
v_mfma_f32_16x16x32_bf16 v[28:31], a[132:135], v[80:83], v[28:31]
v_lshlrev_b32 v54, 16, v255
v_and_b32 v55, 0xffff0000, v255
v_mfma_f32_16x16x32_bf16 v[32:35], a[136:139], v[80:83], v[32:35]
s_waitcnt vmcnt(19)
v_mfma_f32_16x16x32_bf16 v[16:19], a[140:143], v[84:87], v[16:19]
v_mfma_f32_16x16x32_bf16 v[20:23], a[144:147], v[84:87], v[20:23]
buffer_load_dwordx4 v[140:143], v0, s[4:7], s51 offen offset:1024 sc1
v_mfma_f32_16x16x32_bf16 v[24:27], a[148:151], v[84:87], v[24:27]
v_mfma_f32_16x16x32_bf16 v[28:31], a[152:155], v[84:87], v[28:31]
v_mfma_f32_16x16x32_bf16 v[32:35], a[156:159], v[84:87], v[32:35]
s_waitcnt vmcnt(18)
v_mfma_f32_16x16x32_bf16 v[16:19], a[160:163], v[88:91], v[16:19]
buffer_load_dwordx4 v[144:147], v0, s[4:7], s51 offen offset:2048 sc1
v_mfma_f32_16x16x32_bf16 v[20:23], a[164:167], v[88:91], v[20:23]
s_add_u32 m0, s42, 32768
s_add_u32 s49, s18, 32768
v_mfma_f32_16x16x32_bf16 v[24:27], a[168:171], v[88:91], v[24:27]
buffer_load_dwordx4 v0, s[4:7], s49 offen offset:0 sc1 lds
v_mfma_f32_16x16x32_bf16 v[28:31], a[172:175], v[88:91], v[28:31]
v_mfma_f32_16x16x32_bf16 v[32:35], a[176:179], v[88:91], v[32:35]
s_waitcnt vmcnt(19)
v_mfma_f32_16x16x32_bf16 v[16:19], a[180:183], v[92:95], v[16:19]
buffer_load_dwordx4 v[148:151], v0, s[4:7], s51 offen offset:3072 sc1
v_mfma_f32_16x16x32_bf16 v[20:23], a[184:187], v[92:95], v[20:23]
v_mfma_f32_16x16x32_bf16 v[24:27], a[188:191], v[92:95], v[24:27]
v_mfma_f32_16x16x32_bf16 v[28:31], a[192:195], v[92:95], v[28:31]
buffer_load_dword v3, v232, s[4:7], s30 offen
v_mfma_f32_16x16x32_bf16 v[32:35], a[196:199], v[92:95], v[32:35]
s_waitcnt vmcnt(19)
v_mfma_f32_16x16x32_bf16 v[16:19], a[200:203], v[96:99], v[16:19]
buffer_load_dword v14, v233, s[4:7], s31 offen
v_mfma_f32_16x16x32_bf16 v[20:23], a[204:207], v[96:99], v[20:23]
v_mfma_f32_16x16x32_bf16 v[24:27], a[208:211], v[96:99], v[24:27]
s_add_u32 s53, s32, 21102592
buffer_load_dword v234, off, s[4:7], s53
v_mfma_f32_16x16x32_bf16 v[28:31], a[212:215], v[96:99], v[28:31]
v_mfma_f32_16x16x32_bf16 v[32:35], a[216:219], v[96:99], v[32:35]
buffer_load_dwordx4 v0, s[4:7], s49 offen offset:1024 sc1 lds
s_waitcnt vmcnt(21)
v_mfma_f32_16x16x32_bf16 v[16:19], a[220:223], v[100:103], v[16:19]
s_add_u32 m0, s42, 49152
s_add_u32 s49, s18, 49152
v_mfma_f32_16x16x32_bf16 v[20:23], a[224:227], v[100:103], v[20:23]
buffer_load_dwordx4 v0, s[4:7], s49 offen offset:0 sc1 lds
v_mfma_f32_16x16x32_bf16 v[24:27], a[228:231], v[100:103], v[24:27]
v_mfma_f32_16x16x32_bf16 v[28:31], a[232:235], v[100:103], v[28:31]
buffer_load_dwordx4 v0, s[4:7], s49 offen offset:1024 sc1 lds
v_mfma_f32_16x16x32_bf16 v[32:35], a[236:239], v[100:103], v[32:35]
s_add_u32 m0, s42, 40960
s_add_u32 s49, s18, 40960
s_waitcnt vmcnt(22)
v_mfma_f32_16x16x32_bf16 v[36:39], a[0:3], v[104:107], v[36:39]
buffer_load_dwordx4 v0, s[4:7], s49 offen offset:0 sc1 lds
v_mfma_f32_16x16x32_bf16 v[40:43], a[4:7], v[104:107], v[40:43]
s_add_u32 m0, s42, 57344
s_add_u32 s49, s18, 57344
v_mfma_f32_16x16x32_bf16 v[44:47], a[8:11], v[104:107], v[44:47]
buffer_load_dwordx4 v0, s[4:7], s49 offen offset:0 sc1 lds
v_mfma_f32_16x16x32_bf16 v[48:51], a[12:15], v[104:107], v[48:51]
ds_write_b128 v230, v[16:19] offset:0
v_mfma_f32_16x16x32_bf16 v[52:55], a[16:19], v[104:107], v[52:55]
buffer_load_dwordx4 v0, s[4:7], s49 offen offset:1024 sc1 lds
s_waitcnt vmcnt(23)
v_mfma_f32_16x16x32_bf16 v[36:39], a[20:23], v[108:111], v[36:39]
s_add_u32 m0, s42, 65536
s_add_u32 s49, s18, 65536
v_mfma_f32_16x16x32_bf16 v[40:43], a[24:27], v[108:111], v[40:43]
buffer_load_dwordx4 v0, s[4:7], s49 offen offset:0 sc1 lds
v_mfma_f32_16x16x32_bf16 v[44:47], a[28:31], v[108:111], v[44:47]
ds_write_b128 v230, v[20:23] offset:1024
v_mfma_f32_16x16x32_bf16 v[48:51], a[32:35], v[108:111], v[48:51]
buffer_load_dwordx4 v0, s[4:7], s49 offen offset:1024 sc1 lds
v_mfma_f32_16x16x32_bf16 v[52:55], a[36:39], v[108:111], v[52:55]
s_add_u32 m0, s42, 40960
s_add_u32 s49, s18, 40960
s_waitcnt vmcnt(24)
v_mfma_f32_16x16x32_bf16 v[36:39], a[40:43], v[112:115], v[36:39]
buffer_load_dwordx4 v0, s[4:7], s49 offen offset:1024 sc1 lds
v_mfma_f32_16x16x32_bf16 v[40:43], a[44:47], v[112:115], v[40:43]
ds_write_b128 v230, v[24:27] offset:2048
v_mfma_f32_16x16x32_bf16 v[44:47], a[48:51], v[112:115], v[44:47]
ds_write_b128 v230, v[28:31] offset:3072
ds_write_b128 v230, v[32:35] offset:4096
v_mfma_f32_16x16x32_bf16 v[48:51], a[52:55], v[112:115], v[48:51]
s_waitcnt lgkmcnt(0)
s_barrier
v_mfma_f32_16x16x32_bf16 v[52:55], a[56:59], v[112:115], v[52:55]
ds_read_b128 v[152:155], v231 offset:0
s_waitcnt vmcnt(23)
v_mfma_f32_16x16x32_bf16 v[36:39], a[60:63], v[116:119], v[36:39]
ds_read_b128 v[172:175], v231 offset:5120
ds_read_b128 v[192:195], v231 offset:10240
v_mfma_f32_16x16x32_bf16 v[40:43], a[64:67], v[116:119], v[40:43]
ds_read_b128 v[156:159], v231 offset:1024
ds_read_b128 v[176:179], v231 offset:6144
v_mfma_f32_16x16x32_bf16 v[44:47], a[68:71], v[116:119], v[44:47]
ds_read_b128 v[196:199], v231 offset:11264
ds_read_b128 v[160:163], v231 offset:2048
v_mfma_f32_16x16x32_bf16 v[48:51], a[72:75], v[116:119], v[48:51]
ds_read_b128 v[180:183], v231 offset:7168
ds_read_b128 v[200:203], v231 offset:12288
v_mfma_f32_16x16x32_bf16 v[52:55], a[76:79], v[116:119], v[52:55]
ds_read_b128 v[164:167], v231 offset:3072
s_waitcnt vmcnt(22)
v_mfma_f32_16x16x32_bf16 v[36:39], a[80:83], v[120:123], v[36:39]
ds_read_b128 v[184:187], v231 offset:8192
ds_read_b128 v[204:207], v231 offset:13312
v_mfma_f32_16x16x32_bf16 v[40:43], a[84:87], v[120:123], v[40:43]
ds_read_b128 v[168:171], v231 offset:4096
ds_read_b128 v[188:191], v231 offset:9216
v_mfma_f32_16x16x32_bf16 v[44:47], a[88:91], v[120:123], v[44:47]
ds_read_b128 v[208:211], v231 offset:14336
v_mfma_f32_16x16x32_bf16 v[48:51], a[92:95], v[120:123], v[48:51]
v_mfma_f32_16x16x32_bf16 v[52:55], a[96:99], v[120:123], v[52:55]
s_waitcnt vmcnt(21)
v_mfma_f32_16x16x32_bf16 v[36:39], a[100:103], v[124:127], v[36:39]
v_mfma_f32_16x16x32_bf16 v[40:43], a[104:107], v[124:127], v[40:43]
v_mfma_f32_16x16x32_bf16 v[44:47], a[108:111], v[124:127], v[44:47]
v_mfma_f32_16x16x32_bf16 v[48:51], a[112:115], v[124:127], v[48:51]
v_mfma_f32_16x16x32_bf16 v[52:55], a[116:119], v[124:127], v[52:55]
s_waitcnt vmcnt(19)
v_mfma_f32_16x16x32_bf16 v[36:39], a[120:123], v[128:131], v[36:39]
s_waitcnt lgkmcnt(13)
v_add_f32 v152, v152, v172
v_add_f32 v153, v153, v173
v_mfma_f32_16x16x32_bf16 v[40:43], a[124:127], v[128:131], v[40:43]
v_add_f32 v154, v154, v174
v_add_f32 v155, v155, v175
v_mfma_f32_16x16x32_bf16 v[44:47], a[128:131], v[128:131], v[44:47]
s_waitcnt lgkmcnt(10)
v_add_f32 v156, v156, v176
v_add_f32 v157, v157, v177
v_mfma_f32_16x16x32_bf16 v[48:51], a[132:135], v[128:131], v[48:51]
v_add_f32 v158, v158, v178
v_add_f32 v159, v159, v179
v_mfma_f32_16x16x32_bf16 v[52:55], a[136:139], v[128:131], v[52:55]
s_waitcnt lgkmcnt(7)
v_add_f32 v160, v160, v180
s_waitcnt vmcnt(18)
v_mfma_f32_16x16x32_bf16 v[36:39], a[140:143], v[132:135], v[36:39]
v_add_f32 v161, v161, v181
v_add_f32 v162, v162, v182
v_mfma_f32_16x16x32_bf16 v[40:43], a[144:147], v[132:135], v[40:43]
v_add_f32 v163, v163, v183
s_waitcnt lgkmcnt(4)
v_add_f32 v164, v164, v184
v_mfma_f32_16x16x32_bf16 v[44:47], a[148:151], v[132:135], v[44:47]
v_add_f32 v165, v165, v185
v_add_f32 v166, v166, v186
v_mfma_f32_16x16x32_bf16 v[48:51], a[152:155], v[132:135], v[48:51]
v_add_f32 v167, v167, v187
s_waitcnt lgkmcnt(1)
v_add_f32 v168, v168, v188
v_mfma_f32_16x16x32_bf16 v[52:55], a[156:159], v[132:135], v[52:55]
v_add_f32 v169, v169, v189
s_waitcnt vmcnt(16)
v_mfma_f32_16x16x32_bf16 v[36:39], a[160:163], v[136:139], v[36:39]
v_add_f32 v170, v170, v190
v_add_f32 v171, v171, v191
v_mfma_f32_16x16x32_bf16 v[40:43], a[164:167], v[136:139], v[40:43]
v_add_f32 v152, v152, v192
v_add_f32 v153, v153, v193
v_mfma_f32_16x16x32_bf16 v[44:47], a[168:171], v[136:139], v[44:47]
v_add_f32 v154, v154, v194
v_add_f32 v155, v155, v195
v_mfma_f32_16x16x32_bf16 v[48:51], a[172:175], v[136:139], v[48:51]
v_add_f32 v156, v156, v196
v_add_f32 v157, v157, v197
v_mfma_f32_16x16x32_bf16 v[52:55], a[176:179], v[136:139], v[52:55]
v_add_f32 v158, v158, v198
s_waitcnt vmcnt(15)
v_mfma_f32_16x16x32_bf16 v[36:39], a[180:183], v[140:143], v[36:39]
v_add_f32 v159, v159, v199
v_add_f32 v160, v160, v200
v_mfma_f32_16x16x32_bf16 v[40:43], a[184:187], v[140:143], v[40:43]
v_add_f32 v161, v161, v201
v_add_f32 v162, v162, v202
v_mfma_f32_16x16x32_bf16 v[44:47], a[188:191], v[140:143], v[44:47]
v_add_f32 v163, v163, v203
v_add_f32 v164, v164, v204
v_mfma_f32_16x16x32_bf16 v[48:51], a[192:195], v[140:143], v[48:51]
v_add_f32 v165, v165, v205
v_add_f32 v166, v166, v206
v_mfma_f32_16x16x32_bf16 v[52:55], a[196:199], v[140:143], v[52:55]
v_add_f32 v167, v167, v207
s_waitcnt vmcnt(14)
v_mfma_f32_16x16x32_bf16 v[36:39], a[200:203], v[144:147], v[36:39]
s_waitcnt lgkmcnt(0)
v_add_f32 v168, v168, v208
v_add_f32 v169, v169, v209
v_mfma_f32_16x16x32_bf16 v[40:43], a[204:207], v[144:147], v[40:43]
v_add_f32 v170, v170, v210
v_add_f32 v171, v171, v211
v_mfma_f32_16x16x32_bf16 v[44:47], a[208:211], v[144:147], v[44:47]
v_mfma_f32_16x16x32_bf16 v[48:51], a[212:215], v[144:147], v[48:51]
v_mfma_f32_16x16x32_bf16 v[52:55], a[216:219], v[144:147], v[52:55]
s_waitcnt vmcnt(12)
v_mfma_f32_16x16x32_bf16 v[36:39], a[220:223], v[148:151], v[36:39]
v_mfma_f32_16x16x32_bf16 v[40:43], a[224:227], v[148:151], v[40:43]
v_mfma_f32_16x16x32_bf16 v[44:47], a[228:231], v[148:151], v[44:47]
v_mfma_f32_16x16x32_bf16 v[48:51], a[232:235], v[148:151], v[48:51]
v_mfma_f32_16x16x32_bf16 v[52:55], a[236:239], v[148:151], v[52:55]
v_mov_b32 v24, 0x3f803f80
s_nop 2
v_pk_add_f32 v[36:37], v[36:37], v[152:153]
v_pk_add_f32 v[38:39], v[38:39], v[154:155]
v_cvt_pk_bf16_f32 v246, v36, v37
v_cvt_pk_bf16_f32 v247, v38, v39
v_pk_add_f32 v[40:41], v[40:41], v[156:157]
v_pk_add_f32 v[42:43], v[42:43], v[158:159]
v_cvt_pk_bf16_f32 v248, v40, v41
v_cvt_pk_bf16_f32 v249, v42, v43
buffer_store_dwordx4 v[246:249], v0, s[4:7], s30 offen
v_pk_add_f32 v[44:45], v[44:45], v[160:161]
v_pk_add_f32 v[46:47], v[46:47], v[162:163]
v_cvt_pk_bf16_f32 v250, v44, v45
v_cvt_pk_bf16_f32 v251, v46, v47
v_pk_add_f32 v[48:49], v[48:49], v[164:165]
v_pk_add_f32 v[50:51], v[50:51], v[166:167]
v_cvt_pk_bf16_f32 v252, v48, v49
v_cvt_pk_bf16_f32 v253, v50, v51
buffer_store_dwordx4 v[250:253], v0, s[4:7], s30 offen offset:1024
v_pk_add_f32 v[52:53], v[52:53], v[168:169]
v_pk_add_f32 v[54:55], v[54:55], v[170:171]
v_cvt_pk_bf16_f32 v254, v52, v53
v_cvt_pk_bf16_f32 v255, v54, v55
buffer_store_dwordx2 v[254:255], v11, s[4:7], s31 offen
v_dot2_f32_bf16 v16, v246, v24, 0
v_dot2_f32_bf16 v17, v246, v246, 0
v_dot2_f32_bf16 v18, v247, v24, 0
v_dot2_f32_bf16 v19, v247, v247, 0
v_dot2_f32_bf16 v20, v248, v24, 0
v_dot2_f32_bf16 v21, v248, v248, 0
v_dot2_f32_bf16 v22, v249, v24, 0
v_dot2_f32_bf16 v23, v249, v249, 0
v_dot2_f32_bf16 v16, v250, v24, v16
v_dot2_f32_bf16 v17, v250, v250, v17
v_dot2_f32_bf16 v18, v251, v24, v18
v_dot2_f32_bf16 v19, v251, v251, v19
v_dot2_f32_bf16 v20, v252, v24, v20
v_dot2_f32_bf16 v21, v252, v252, v21
v_dot2_f32_bf16 v22, v253, v24, v22
v_dot2_f32_bf16 v23, v253, v253, v23
v_dot2_f32_bf16 v16, v254, v24, v16
v_dot2_f32_bf16 v17, v254, v254, v17
v_dot2_f32_bf16 v18, v255, v24, v18
v_dot2_f32_bf16 v19, v255, v255, v19
v_pk_add_f32 v[20:21], v[20:21], v[22:23]
s_nop 1
v_pk_add_f32 v[16:17], v[16:17], v[18:19]
v_pk_add_f32 v[16:17], v[16:17], v[20:21]
s_nop 1
v_permlane16_swap_b32 v16, v17
v_add_f32 v16, v16, v17
v_mov_b32 v17, v16
s_nop 1
v_permlane32_swap_b32 v16, v17
v_add_f32 v16, v16, v17
v_mov_b32 v17, v16
s_nop 1
v_permlane16_swap_b32 v16, v17
s_mov_b32 exec_lo, 0xffff
s_mov_b32 exec_hi, 0
buffer_store_dwordx2 v[16:17], v13, s[4:7], s53 offen
s_mov_b64 exec, -1
s_waitcnt vmcnt(13)
s_cmp_eq_u32 s12, 0
s_cbranch_scc1 SY26
s_add_u32 m0, s79, 73728
s_add_u32 s49, s35, 73728
buffer_load_dwordx4 v0, s[4:7], s49 offen offset:0 sc1 lds
buffer_load_dwordx4 v0, s[4:7], s49 offen offset:1024 sc1 lds
buffer_load_dwordx4 v0, s[4:7], s49 offen offset:2048 sc1 lds
buffer_load_dwordx4 v0, s[4:7], s49 offen offset:3072 sc1 lds
s_add_u32 m0, s79, 77824
s_add_u32 s49, s35, 77824
buffer_load_dwordx4 v0, s[4:7], s49 offen offset:0 sc1 lds
buffer_load_dwordx4 v0, s[4:7], s49 offen offset:1024 sc1 lds
buffer_load_dwordx4 v0, s[4:7], s49 offen offset:2048 sc1 lds
buffer_load_dwordx4 v0, s[4:7], s49 offen offset:3072 sc1 lds
SY26:
v_lshrrev_b32 v100, 8, v0
v_lshrrev_b32 v101, 2, v9
v_lshlrev_b32 v100, 2, v100
v_sub_u32 v100, v101, v100
v_mov_b32 v101, 0xf149f2ca
v_subrev_u32 v103, 0, v100
v_cmp_gt_u32 vcc, 8, v103
v_cmp_gt_i32 s[52:53], -8, v103
v_mov_b32 v102, 0x3f803f80
v_cndmask_b32_e64 v88, v101, 0, vcc
v_cndmask_b32_e64 v92, v101, 0, s[52:53]
v_subrev_u32 v103, 1, v100
v_cmp_gt_u32 vcc, 8, v103
v_cmp_gt_i32 s[52:53], -8, v103
v_lshlrev_b32 v110, 3, v0
v_cndmask_b32_e64 v89, v101, 0, vcc
v_cndmask_b32_e64 v93, v101, 0, s[52:53]
v_subrev_u32 v103, 2, v100
v_cmp_gt_u32 vcc, 8, v103
v_cmp_gt_i32 s[52:53], -8, v103
v_and_b32 v111, 0x380, v110
v_cndmask_b32_e64 v90, v101, 0, vcc
v_cndmask_b32_e64 v94, v101, 0, s[52:53]
v_subrev_u32 v103, 3, v100
v_cmp_gt_u32 vcc, 8, v103
v_cmp_gt_i32 s[52:53], -8, v103
v_and_b32 v110, 0x400, v110
v_cndmask_b32_e64 v91, v101, 0, vcc
v_cndmask_b32_e64 v95, v101, 0, s[52:53]
s_cmp_eq_u32 s88, 1
s_cselect_b64 vcc, -1, 0
v_cndmask_b32 v96, v92, v101, vcc
v_cndmask_b32 v97, v93, v101, vcc
v_cndmask_b32 v98, v94, v101, vcc
v_cndmask_b32 v99, v95, v101, vcc
v_mov_b32 v103, 0xffff
v_cmp_le_i32 vcc, 0, v100
v_cmp_le_i32 s[52:53], 1, v100
v_mov_b32 v104, 0
v_cndmask_b32 v104, v104, v103, vcc
v_cndmask_b32_e64 v104, v104, -1, s[52:53]
v_cmp_le_i32 vcc, 2, v100
v_cmp_le_i32 s[52:53], 3, v100
v_mov_b32 v105, 0
v_cndmask_b32 v105, v105, v103, vcc
v_cndmask_b32_e64 v105, v105, -1, s[52:53]
v_mul_u32_u24 v110, 20, v110
v_and_b32 v100, 0x80, v111
v_add_u32 v111, v110, v111
v_add_u32 v110, v110, v100
v_lshrrev_b32 v106, 8, v0
v_lshlrev_b32 v106, 4, v106
s_lshl_b32 s48, s12, 8
s_add_u32 s48, s48, 161024
v_add_u32 v109, s48, v106
v_and_b32 v108, 0x100, v0
v_lshrrev_b32 v108, 2, v108
v_add3_u32 v108, v108, v9, s48
v_add_u32 v106, 159744, v106
v_add_u32 v107, 159744, v9
v_lshrrev_b32 v100, 1, v0
s_add_u32 s48, s43, 126976
v_add_u32 v101, s48, v100
s_add_u32 s48, s12, 1
s_and_b32 s48, s48, 3
s_mul_i32 s48, s48, 3072
s_add_u32 s48, s48, 126976
v_add_u32 v100, s48, v100
s_lshl_b32 s54, s14, 2
s_add_u32 s54, s54, s40
s_add_u32 s54, s54, 6144
s_cmp_lg_u32 s12, 0
s_cbranch_scc1 SY27
s_waitcnt vmcnt(0)
SY27:
s_waitcnt vmcnt(8)
s_barrier
s_cmp_lg_u32 s12, 0
s_cbranch_scc1 SY28
s_mov_b64 exec, 1
s_cmp_eq_u32 s15, 0
s_cbranch_scc1 SY30
buffer_store_dword v10, off, s[4:7], s54
s_branch SY31
SY30:
buffer_wbl2 sc1
s_waitcnt vmcnt(0)
buffer_store_dword v10, off, s[4:7], s54 sc1
SY31:
s_mov_b64 exec, -1
s_add_u32 s48, s40, 6144
PL32:
buffer_load_dword v18, v9, s[4:7], s48 offen sc1
s_waitcnt vmcnt(0)
v_cmp_ne_u32 vcc, s89, v18
s_nop 1
s_cmp_eq_u64 vcc, 0
s_cbranch_scc1 PL33
s_sub_u32 s45, s45, 1
s_cbranch_scc0 PL32
s_mov_b32 s45, 0
PL33:
s_cmp_lg_u32 s15, 0
s_cbranch_scc1 SY29
buffer_inv sc1
s_waitcnt vmcnt(0)
s_branch SY29
SY28:
SY29:
s_barrier
s_add_u32 s51, s16, 0
buffer_load_dwordx4 v[180:183], v0, s[4:7], s51 offen offset:0 sc1
buffer_load_dwordx4 v[184:187], v1, s[4:7], s51 offen offset:0 sc1
buffer_load_dwordx4 v[188:191], v0, s[4:7], s51 offen offset:1024 sc1
buffer_load_dwordx4 v[192:195], v1, s[4:7], s51 offen offset:1024 sc1
s_barrier
ds_read_b128 v[136:139], v0 offset:0
ds_read_b128 v[140:143], v0 offset:1024
ds_read_b128 v[144:147], v0 offset:2048
ds_read_b128 v[148:151], v0 offset:3072
ds_read_b128 v[152:155], v0 offset:4096
ds_read_b128 v[156:159], v0 offset:5120
ds_read_b128 v[160:163], v0 offset:6144
ds_read_b128 v[164:167], v0 offset:7168
s_waitcnt lgkmcnt(5)
s_waitcnt vmcnt(3)
v_mfma_f32_16x16x32_bf16 v[16:19], v[136:139], v[180:183], 0
buffer_load_dwordx4 v[196:199], v0, s[4:7], s51 offen offset:2048 sc1
s_waitcnt vmcnt(3)
v_mfma_f32_16x16x32_bf16 v[20:23], v[136:139], v[184:187], 0
ds_read_b128 v[168:171], v0 offset:8192
ds_read_b128 v[172:175], v0 offset:9216
v_mfma_f32_16x16x32_bf16 v[24:27], v[140:143], v[180:183], 0
ds_read_b128 v[176:179], v0 offset:10240
v_mfma_f32_16x16x32_bf16 v[28:31], v[140:143], v[184:187], 0
v_mfma_f32_16x16x32_bf16 v[32:35], v[144:147], v[180:183], 0
buffer_load_dwordx4 v[200:203], v1, s[4:7], s51 offen offset:2048 sc1
v_mfma_f32_16x16x32_bf16 v[36:39], v[144:147], v[184:187], 0
ds_read_b128 v[136:139], v0 offset:11264
s_waitcnt lgkmcnt(6)
v_mfma_f32_16x16x32_bf16 v[40:43], v[148:151], v[180:183], 0
ds_read_b128 v[140:143], v0 offset:12288
v_mfma_f32_16x16x32_bf16 v[44:47], v[148:151], v[184:187], 0
buffer_load_dwordx4 v[204:207], v0, s[4:7], s51 offen offset:3072 sc1
v_mfma_f32_16x16x32_bf16 v[48:51], v[152:155], v[180:183], 0
ds_read_b128 v[144:147], v0 offset:13312
v_mfma_f32_16x16x32_bf16 v[52:55], v[152:155], v[184:187], 0
v_mfma_f32_16x16x32_bf16 v[56:59], v[180:183], v[156:159], 0
ds_read_b128 v[148:151], v0 offset:14336
v_mfma_f32_16x16x32_bf16 v[60:63], v[184:187], v[156:159], 0
s_waitcnt lgkmcnt(6)
v_mfma_f32_16x16x32_bf16 v[64:67], v[180:183], v[160:163], 0
buffer_load_dwordx4 v[208:211], v1, s[4:7], s51 offen offset:3072 sc1
v_mfma_f32_16x16x32_bf16 v[68:71], v[184:187], v[160:163], 0
ds_read_b128 v[152:155], v0 offset:15360
v_mfma_f32_16x16x32_bf16 v[72:75], v[180:183], v[164:167], 0
v_mfma_f32_16x16x32_bf16 v[76:79], v[184:187], v[164:167], 0
s_waitcnt vmcnt(5)
v_mfma_f32_16x16x32_bf16 v[16:19], v[168:171], v[188:191], v[16:19]
s_barrier
s_waitcnt vmcnt(4)
v_mfma_f32_16x16x32_bf16 v[20:23], v[168:171], v[192:195], v[20:23]
s_lshl_b32 s55, s14, 10
s_add_u32 s55, s55, C_p1e1-M_pc
v_lshlrev_b32 v85, 5, v9
v_and_b32 v85, 0x380, v85
v_add_u32 v85, s55, v85
v_min_u32 v85, M_last-M_pc-4, v85
global_load_dword v85, v85, s[86:87]
s_waitcnt lgkmcnt(4)
v_mfma_f32_16x16x32_bf16 v[24:27], v[172:175], v[188:191], v[24:27]
s_add_u32 s51, s16, 4096
ds_read_b128 v[156:159], v0 offset:16384
v_mfma_f32_16x16x32_bf16 v[28:31], v[172:175], v[192:195], v[28:31]
ds_read_b128 v[160:163], v0 offset:17408
ds_read_b128 v[164:167], v0 offset:18432
v_mfma_f32_16x16x32_bf16 v[32:35], v[176:179], v[188:191], v[32:35]
buffer_load_dwordx4 v[212:215], v0, s[4:7], s51 offen offset:0 sc1
v_mfma_f32_16x16x32_bf16 v[36:39], v[176:179], v[192:195], v[36:39]
ds_read_b128 v[168:171], v0 offset:19456
v_mfma_f32_16x16x32_bf16 v[40:43], v[136:139], v[188:191], v[40:43]
ds_read_b128 v[172:175], v0 offset:20480
v_mfma_f32_16x16x32_bf16 v[44:47], v[136:139], v[192:195], v[44:47]
s_waitcnt lgkmcnt(6)
v_mfma_f32_16x16x32_bf16 v[48:51], v[140:143], v[188:191], v[48:51]
buffer_load_dwordx4 v[216:219], v1, s[4:7], s51 offen offset:0 sc1
v_mfma_f32_16x16x32_bf16 v[52:55], v[140:143], v[192:195], v[52:55]
ds_read_b128 v[176:179], v0 offset:21504
v_mfma_f32_16x16x32_bf16 v[56:59], v[188:191], v[144:147], v[56:59]
ds_read_b128 v[136:139], v0 offset:22528
v_mfma_f32_16x16x32_bf16 v[60:63], v[192:195], v[144:147], v[60:63]
buffer_load_dwordx4 v[220:223], v0, s[4:7], s51 offen offset:1024 sc1
v_mfma_f32_16x16x32_bf16 v[64:67], v[188:191], v[148:151], v[64:67]
ds_read_b128 v[140:143], v0 offset:23552
v_mfma_f32_16x16x32_bf16 v[68:71], v[192:195], v[148:151], v[68:71]
s_waitcnt lgkmcnt(6)
v_mfma_f32_16x16x32_bf16 v[72:75], v[188:191], v[152:155], v[72:75]
ds_read_b128 v[144:147], v0 offset:24576
v_mfma_f32_16x16x32_bf16 v[76:79], v[192:195], v[152:155], v[76:79]
buffer_load_dwordx4 v[224:227], v1, s[4:7], s51 offen offset:1024 sc1
s_waitcnt vmcnt(8)
v_mfma_f32_16x16x32_bf16 v[16:19], v[156:159], v[196:199], v[16:19]
ds_read_b128 v[148:151], v0 offset:25600
s_waitcnt vmcnt(7)
v_mfma_f32_16x16x32_bf16 v[20:23], v[156:159], v[200:203], v[20:23]
v_mfma_f32_16x16x32_bf16 v[24:27], v[160:163], v[196:199], v[24:27]
buffer_load_dwordx4 v[228:231], v0, s[4:7], s51 offen offset:2048 sc1
v_mfma_f32_16x16x32_bf16 v[28:31], v[160:163], v[200:203], v[28:31]
ds_read_b128 v[152:155], v0 offset:26624
s_waitcnt lgkmcnt(6)
v_mfma_f32_16x16x32_bf16 v[32:35], v[164:167], v[196:199], v[32:35]
ds_read_b128 v[156:159], v0 offset:27648
v_mfma_f32_16x16x32_bf16 v[36:39], v[164:167], v[200:203], v[36:39]
v_mfma_f32_16x16x32_bf16 v[40:43], v[168:171], v[196:199], v[40:43]
buffer_load_dwordx4 v[232:235], v1, s[4:7], s51 offen offset:2048 sc1
v_mfma_f32_16x16x32_bf16 v[44:47], v[168:171], v[200:203], v[44:47]
ds_read_b128 v[160:163], v0 offset:28672
v_mfma_f32_16x16x32_bf16 v[48:51], v[172:175], v[196:199], v[48:51]
ds_read_b128 v[164:167], v0 offset:29696
v_mfma_f32_16x16x32_bf16 v[52:55], v[172:175], v[200:203], v[52:55]
s_waitcnt lgkmcnt(6)
v_mfma_f32_16x16x32_bf16 v[56:59], v[196:199], v[176:179], v[56:59]
buffer_load_dwordx4 v[180:183], v0, s[4:7], s51 offen offset:3072 sc1
v_mfma_f32_16x16x32_bf16 v[60:63], v[200:203], v[176:179], v[60:63]
ds_read_b128 v[168:171], v0 offset:30720
v_mfma_f32_16x16x32_bf16 v[64:67], v[196:199], v[136:139], v[64:67]
ds_read_b128 v[172:175], v0 offset:31744
v_mfma_f32_16x16x32_bf16 v[68:71], v[200:203], v[136:139], v[68:71]
buffer_load_dwordx4 v[184:187], v1, s[4:7], s51 offen offset:3072 sc1
v_mfma_f32_16x16x32_bf16 v[72:75], v[196:199], v[140:143], v[72:75]
s_add_u32 s51, s16, 8192
v_mfma_f32_16x16x32_bf16 v[76:79], v[200:203], v[140:143], v[76:79]
s_waitcnt lgkmcnt(5)
s_waitcnt vmcnt(10)
v_mfma_f32_16x16x32_bf16 v[16:19], v[144:147], v[204:207], v[16:19]
s_barrier
s_waitcnt vmcnt(9)
v_mfma_f32_16x16x32_bf16 v[20:23], v[144:147], v[208:211], v[20:23]
buffer_load_dwordx4 v[188:191], v0, s[4:7], s51 offen offset:0 sc1
v_mfma_f32_16x16x32_bf16 v[24:27], v[148:151], v[204:207], v[24:27]
ds_read_b128 v[176:179], v0 offset:32768
ds_read_b128 v[136:139], v0 offset:33792
v_mfma_f32_16x16x32_bf16 v[28:31], v[148:151], v[208:211], v[28:31]
ds_read_b128 v[140:143], v0 offset:34816
v_mfma_f32_16x16x32_bf16 v[32:35], v[152:155], v[204:207], v[32:35]
buffer_load_dwordx4 v[192:195], v1, s[4:7], s51 offen offset:0 sc1
v_mfma_f32_16x16x32_bf16 v[36:39], v[152:155], v[208:211], v[36:39]
ds_read_b128 v[144:147], v0 offset:35840
s_waitcnt lgkmcnt(6)
v_mfma_f32_16x16x32_bf16 v[40:43], v[156:159], v[204:207], v[40:43]
ds_read_b128 v[148:151], v0 offset:36864
v_mfma_f32_16x16x32_bf16 v[44:47], v[156:159], v[208:211], v[44:47]
buffer_load_dwordx2 v[112:113], v13, s[4:7], s33 offen offset:0 sc1
v_mfma_f32_16x16x32_bf16 v[48:51], v[160:163], v[204:207], v[48:51]
ds_read_b128 v[152:155], v0 offset:37888
v_mfma_f32_16x16x32_bf16 v[52:55], v[160:163], v[208:211], v[52:55]
v_mfma_f32_16x16x32_bf16 v[56:59], v[204:207], v[164:167], v[56:59]
ds_read_b128 v[156:159], v0 offset:38912
v_mfma_f32_16x16x32_bf16 v[60:63], v[208:211], v[164:167], v[60:63]
s_waitcnt lgkmcnt(6)
v_mfma_f32_16x16x32_bf16 v[64:67], v[204:207], v[168:171], v[64:67]
buffer_load_dwordx2 v[114:115], v13, s[4:7], s33 offen offset:128 sc1
v_mfma_f32_16x16x32_bf16 v[68:71], v[208:211], v[168:171], v[68:71]
ds_read_b128 v[160:163], v0 offset:39936
v_mfma_f32_16x16x32_bf16 v[72:75], v[204:207], v[172:175], v[72:75]
ds_read_b128 v[164:167], v0 offset:40960
v_mfma_f32_16x16x32_bf16 v[76:79], v[208:211], v[172:175], v[76:79]
buffer_load_dwordx2 v[116:117], v13, s[4:7], s33 offen offset:1024 sc1
s_waitcnt vmcnt(12)
v_mfma_f32_16x16x32_bf16 v[16:19], v[176:179], v[212:215], v[16:19]
ds_read_b128 v[168:171], v0 offset:41984
s_waitcnt vmcnt(11)
v_mfma_f32_16x16x32_bf16 v[20:23], v[176:179], v[216:219], v[20:23]
s_waitcnt lgkmcnt(6)
v_mfma_f32_16x16x32_bf16 v[24:27], v[136:139], v[212:215], v[24:27]
buffer_load_dwordx2 v[118:119], v13, s[4:7], s33 offen offset:1152 sc1
v_mfma_f32_16x16x32_bf16 v[28:31], v[136:139], v[216:219], v[28:31]
ds_read_b128 v[172:175], v0 offset:43008
v_mfma_f32_16x16x32_bf16 v[32:35], v[140:143], v[212:215], v[32:35]
ds_read_b128 v[176:179], v0 offset:44032
v_mfma_f32_16x16x32_bf16 v[36:39], v[140:143], v[216:219], v[36:39]
buffer_load_dwordx4 v[196:199], v0, s[4:7], s51 offen offset:1024 sc1
v_mfma_f32_16x16x32_bf16 v[40:43], v[144:147], v[212:215], v[40:43]
ds_read_b128 v[136:139], v0 offset:45056
v_mfma_f32_16x16x32_bf16 v[44:47], v[144:147], v[216:219], v[44:47]
s_waitcnt lgkmcnt(6)
v_mfma_f32_16x16x32_bf16 v[48:51], v[148:151], v[212:215], v[48:51]
ds_read_b128 v[140:143], v0 offset:46080
v_mfma_f32_16x16x32_bf16 v[52:55], v[148:151], v[216:219], v[52:55]
buffer_load_dwordx4 v[200:203], v1, s[4:7], s51 offen offset:1024 sc1
v_mfma_f32_16x16x32_bf16 v[56:59], v[212:215], v[152:155], v[56:59]
ds_read_b128 v[144:147], v0 offset:47104
v_mfma_f32_16x16x32_bf16 v[60:63], v[216:219], v[152:155], v[60:63]
v_mfma_f32_16x16x32_bf16 v[64:67], v[212:215], v[156:159], v[64:67]
buffer_load_dwordx4 v[204:207], v0, s[4:7], s51 offen offset:2048 sc1
v_mfma_f32_16x16x32_bf16 v[68:71], v[216:219], v[156:159], v[68:71]
ds_read_b128 v[148:151], v0 offset:48128
s_waitcnt lgkmcnt(6)
v_mfma_f32_16x16x32_bf16 v[72:75], v[212:215], v[160:163], v[72:75]
v_mfma_f32_16x16x32_bf16 v[76:79], v[216:219], v[160:163], v[76:79]
s_waitcnt vmcnt(14)
v_mfma_f32_16x16x32_bf16 v[16:19], v[164:167], v[220:223], v[16:19]
s_barrier
s_waitcnt vmcnt(13)
v_mfma_f32_16x16x32_bf16 v[20:23], v[164:167], v[224:227], v[20:23]
buffer_load_dwordx4 v[208:211], v1, s[4:7], s51 offen offset:2048 sc1
v_mfma_f32_16x16x32_bf16 v[24:27], v[168:171], v[220:223], v[24:27]
s_add_u32 m0, s42, 98304
s_add_u32 s49, s18, 98304
v_mfma_f32_16x16x32_bf16 v[28:31], v[168:171], v[224:227], v[28:31]
ds_read_b128 v[152:155], v0 offset:49152
s_waitcnt lgkmcnt(4)
v_mfma_f32_16x16x32_bf16 v[32:35], v[172:175], v[220:223], v[32:35]
buffer_load_dwordx4 v0, s[4:7], s49 offen offset:0 sc1 lds
v_mfma_f32_16x16x32_bf16 v[36:39], v[172:175], v[224:227], v[36:39]
ds_read_b128 v[156:159], v0 offset:50176
ds_read_b128 v[160:163], v0 offset:51200
v_mfma_f32_16x16x32_bf16 v[40:43], v[176:179], v[220:223], v[40:43]
ds_read_b128 v[164:167], v0 offset:52224
ds_read_b128 v[168:171], v0 offset:53248
v_mfma_f32_16x16x32_bf16 v[44:47], v[176:179], v[224:227], v[44:47]
buffer_load_dwordx4 v0, s[4:7], s49 offen offset:1024 sc1 lds
v_mfma_f32_16x16x32_bf16 v[48:51], v[136:139], v[220:223], v[48:51]
s_add_u32 m0, s42, 106496
s_add_u32 s49, s18, 106496
v_mfma_f32_16x16x32_bf16 v[52:55], v[136:139], v[224:227], v[52:55]
ds_read_b128 v[172:175], v0 offset:54272
s_waitcnt lgkmcnt(6)
v_mfma_f32_16x16x32_bf16 v[56:59], v[220:223], v[140:143], v[56:59]
buffer_load_dwordx4 v0, s[4:7], s49 offen offset:0 sc1 lds
v_mfma_f32_16x16x32_bf16 v[60:63], v[224:227], v[140:143], v[60:63]
ds_read_b128 v[176:179], v0 offset:55296
v_mfma_f32_16x16x32_bf16 v[64:67], v[220:223], v[144:147], v[64:67]
ds_read_b128 v[136:139], v0 offset:56320
v_mfma_f32_16x16x32_bf16 v[68:71], v[224:227], v[144:147], v[68:71]
v_mfma_f32_16x16x32_bf16 v[72:75], v[220:223], v[148:151], v[72:75]
buffer_load_dwordx4 v0, s[4:7], s49 offen offset:1024 sc1 lds
v_mfma_f32_16x16x32_bf16 v[76:79], v[224:227], v[148:151], v[76:79]
ds_read_b128 v[140:143], v0 offset:57344
s_waitcnt lgkmcnt(6)
s_waitcnt vmcnt(17)
v_mfma_f32_16x16x32_bf16 v[16:19], v[152:155], v[228:231], v[16:19]
ds_read_b128 v[144:147], v0 offset:58368
s_waitcnt vmcnt(16)
v_mfma_f32_16x16x32_bf16 v[20:23], v[152:155], v[232:235], v[20:23]
buffer_load_dwordx4 v[212:215], v0, s[4:7], s51 offen offset:3072 sc1
v_mfma_f32_16x16x32_bf16 v[24:27], v[156:159], v[228:231], v[24:27]
ds_read_b128 v[148:151], v0 offset:59392
v_mfma_f32_16x16x32_bf16 v[28:31], v[156:159], v[232:235], v[28:31]
v_mfma_f32_16x16x32_bf16 v[32:35], v[160:163], v[228:231], v[32:35]
ds_read_b128 v[152:155], v0 offset:60416
v_mfma_f32_16x16x32_bf16 v[36:39], v[160:163], v[232:235], v[36:39]
s_waitcnt lgkmcnt(6)
v_mfma_f32_16x16x32_bf16 v[40:43], v[164:167], v[228:231], v[40:43]
buffer_load_dwordx4 v[216:219], v1, s[4:7], s51 offen offset:3072 sc1
v_mfma_f32_16x16x32_bf16 v[44:47], v[164:167], v[232:235], v[44:47]
s_add_u32 s51, s16, 12288
ds_read_b128 v[156:159], v0 offset:61440
v_mfma_f32_16x16x32_bf16 v[48:51], v[168:171], v[228:231], v[48:51]
ds_read_b128 v[160:163], v0 offset:62464
v_mfma_f32_16x16x32_bf16 v[52:55], v[168:171], v[232:235], v[52:55]
buffer_load_dwordx4 v[220:223], v0, s[4:7], s51 offen offset:0 sc1
v_mfma_f32_16x16x32_bf16 v[56:59], v[228:231], v[172:175], v[56:59]
ds_read_b128 v[164:167], v0 offset:63488
v_mfma_f32_16x16x32_bf16 v[60:63], v[232:235], v[172:175], v[60:63]
s_waitcnt lgkmcnt(6)
v_mfma_f32_16x16x32_bf16 v[64:67], v[228:231], v[176:179], v[64:67]
buffer_load_dwordx4 v[224:227], v1, s[4:7], s51 offen offset:0 sc1
v_mfma_f32_16x16x32_bf16 v[68:71], v[232:235], v[176:179], v[68:71]
s_add_u32 m0, s42, 114688
s_add_u32 s49, s18, 114688
v_mfma_f32_16x16x32_bf16 v[72:75], v[228:231], v[136:139], v[72:75]
ds_read_b128 v[168:171], v0 offset:64512
v_mfma_f32_16x16x32_bf16 v[76:79], v[232:235], v[136:139], v[76:79]
buffer_load_dwordx4 v0, s[4:7], s49 offen offset:0 sc1 lds
s_waitcnt vmcnt(20)
v_mfma_f32_16x16x32_bf16 v[16:19], v[140:143], v[180:183], v[16:19]
s_barrier
s_waitcnt vmcnt(19)
v_mfma_f32_16x16x32_bf16 v[20:23], v[140:143], v[184:187], v[20:23]
ds_read_b128 v[172:175], v4 offset:0
s_waitcnt lgkmcnt(5)
v_mfma_f32_16x16x32_bf16 v[24:27], v[144:147], v[180:183], v[24:27]
ds_read_b128 v[176:179], v4 offset:1024
ds_read_b128 v[136:139], v4 offset:2048
v_mfma_f32_16x16x32_bf16 v[28:31], v[144:147], v[184:187], v[28:31]
buffer_load_dwordx4 v0, s[4:7], s49 offen offset:1024 sc1 lds
v_mfma_f32_16x16x32_bf16 v[32:35], v[148:151], v[180:183], v[32:35]
s_add_u32 m0, s42, 122880
s_add_u32 s49, s18, 122880
v_mfma_f32_16x16x32_bf16 v[36:39], v[148:151], v[184:187], v[36:39]
ds_read_b128 v[140:143], v4 offset:3072
v_mfma_f32_16x16x32_bf16 v[40:43], v[152:155], v[180:183], v[40:43]
buffer_load_dwordx4 v0, s[4:7], s49 offen offset:0 sc1 lds
v_mfma_f32_16x16x32_bf16 v[44:47], v[152:155], v[184:187], v[44:47]
ds_read_b128 v[144:147], v4 offset:4096
s_waitcnt lgkmcnt(6)
v_mfma_f32_16x16x32_bf16 v[48:51], v[156:159], v[180:183], v[48:51]
ds_read_b128 v[148:151], v4 offset:5120
v_mfma_f32_16x16x32_bf16 v[52:55], v[156:159], v[184:187], v[52:55]
v_mfma_f32_16x16x32_bf16 v[56:59], v[180:183], v[160:163], v[56:59]
buffer_load_dwordx4 v0, s[4:7], s49 offen offset:1024 sc1 lds
v_mfma_f32_16x16x32_bf16 v[60:63], v[184:187], v[160:163], v[60:63]
ds_read_b128 v[152:155], v4 offset:6144
v_mfma_f32_16x16x32_bf16 v[64:67], v[180:183], v[164:167], v[64:67]
ds_read_b128 v[156:159], v4 offset:7168
v_mfma_f32_16x16x32_bf16 v[68:71], v[184:187], v[164:167], v[68:71]
s_waitcnt lgkmcnt(6)
v_mfma_f32_16x16x32_bf16 v[72:75], v[180:183], v[168:171], v[72:75]
buffer_load_dwordx4 v[228:231], v0, s[4:7], s51 offen offset:1024 sc1
v_mfma_f32_16x16x32_bf16 v[76:79], v[184:187], v[168:171], v[76:79]
ds_read_b128 v[160:163], v4 offset:8192
s_waitcnt vmcnt(22)
v_mfma_f32_16x16x32_bf16 v[16:19], v[172:175], v[188:191], v[16:19]
ds_read_b128 v[164:167], v4 offset:9216
s_waitcnt vmcnt(21)
v_mfma_f32_16x16x32_bf16 v[20:23], v[172:175], v[192:195], v[20:23]
buffer_load_dwordx4 v[232:235], v1, s[4:7], s51 offen offset:1024 sc1
v_mfma_f32_16x16x32_bf16 v[24:27], v[176:179], v[188:191], v[24:27]
ds_read_b128 v[168:171], v4 offset:10240
v_mfma_f32_16x16x32_bf16 v[28:31], v[176:179], v[192:195], v[28:31]
s_waitcnt lgkmcnt(6)
v_mfma_f32_16x16x32_bf16 v[32:35], v[136:139], v[188:191], v[32:35]
buffer_load_dwordx4 v[180:183], v0, s[4:7], s51 offen offset:2048 sc1
v_mfma_f32_16x16x32_bf16 v[36:39], v[136:139], v[192:195], v[36:39]
ds_read_b128 v[172:175], v4 offset:11264
v_mfma_f32_16x16x32_bf16 v[40:43], v[140:143], v[188:191], v[40:43]
ds_read_b128 v[176:179], v4 offset:12288
v_mfma_f32_16x16x32_bf16 v[44:47], v[140:143], v[192:195], v[44:47]
v_mfma_f32_16x16x32_bf16 v[48:51], v[144:147], v[188:191], v[48:51]
buffer_load_dwordx4 v[184:187], v1, s[4:7], s51 offen offset:2048 sc1
v_mfma_f32_16x16x32_bf16 v[52:55], v[144:147], v[192:195], v[52:55]
s_add_u32 m0, s42, 131072
s_waitcnt lgkmcnt(5)
v_mfma_f32_16x16x32_bf16 v[56:59], v[188:191], v[148:151], v[56:59]
s_add_u32 s49, s18, 131072
ds_read_b128 v[136:139], v4 offset:13312
v_mfma_f32_16x16x32_bf16 v[60:63], v[192:195], v[148:151], v[60:63]
buffer_load_dwordx4 v0, s[4:7], s49 offen offset:0 sc1 lds
v_mfma_f32_16x16x32_bf16 v[64:67], v[188:191], v[152:155], v[64:67]
ds_read_b128 v[140:143], v4 offset:14336
ds_read_b128 v[144:147], v4 offset:15360
v_mfma_f32_16x16x32_bf16 v[68:71], v[192:195], v[152:155], v[68:71]
v_mfma_f32_16x16x32_bf16 v[72:75], v[188:191], v[156:159], v[72:75]
v_mfma_f32_16x16x32_bf16 v[76:79], v[192:195], v[156:159], v[76:79]
buffer_load_dwordx4 v0, s[4:7], s49 offen offset:1024 sc1 lds
s_waitcnt lgkmcnt(5)
s_waitcnt vmcnt(21)
v_mfma_f32_16x16x32_bf16 v[16:19], v[160:163], v[196:199], v[16:19]
s_barrier
s_waitcnt vmcnt(20)
v_mfma_f32_16x16x32_bf16 v[20:23], v[160:163], v[200:203], v[20:23]
s_add_u32 m0, s42, 139264
s_add_u32 s49, s18, 139264
v_mfma_f32_16x16x32_bf16 v[24:27], v[164:167], v[196:199], v[24:27]
buffer_load_dwordx4 v0, s[4:7], s49 offen offset:0 sc1 lds
v_mfma_f32_16x16x32_bf16 v[28:31], v[164:167], v[200:203], v[28:31]
ds_read_b128 v[148:151], v4 offset:16384
ds_read_b128 v[152:155], v4 offset:17408
v_mfma_f32_16x16x32_bf16 v[32:35], v[168:171], v[196:199], v[32:35]
ds_read_b128 v[156:159], v4 offset:18432
ds_read_b128 v[160:163], v4 offset:19456
v_mfma_f32_16x16x32_bf16 v[36:39], v[168:171], v[200:203], v[36:39]
s_waitcnt lgkmcnt(6)
v_mfma_f32_16x16x32_bf16 v[40:43], v[172:175], v[196:199], v[40:43]
buffer_load_dwordx4 v0, s[4:7], s49 offen offset:1024 sc1 lds
v_mfma_f32_16x16x32_bf16 v[44:47], v[172:175], v[200:203], v[44:47]
ds_read_b128 v[164:167], v4 offset:20480
v_mfma_f32_16x16x32_bf16 v[48:51], v[176:179], v[196:199], v[48:51]
ds_read_b128 v[168:171], v4 offset:21504
v_mfma_f32_16x16x32_bf16 v[52:55], v[176:179], v[200:203], v[52:55]
buffer_load_dwordx4 v[188:191], v0, s[4:7], s51 offen offset:3072 sc1
v_mfma_f32_16x16x32_bf16 v[56:59], v[196:199], v[136:139], v[56:59]
ds_read_b128 v[172:175], v4 offset:22528
v_mfma_f32_16x16x32_bf16 v[60:63], v[200:203], v[136:139], v[60:63]
s_waitcnt lgkmcnt(6)
v_mfma_f32_16x16x32_bf16 v[64:67], v[196:199], v[140:143], v[64:67]
ds_read_b128 v[176:179], v4 offset:23552
v_mfma_f32_16x16x32_bf16 v[68:71], v[200:203], v[140:143], v[68:71]
buffer_load_dwordx4 v[192:195], v1, s[4:7], s51 offen offset:3072 sc1
v_mfma_f32_16x16x32_bf16 v[72:75], v[196:199], v[144:147], v[72:75]
s_add_u32 m0, s42, 147456
s_add_u32 s49, s18, 147456
v_mfma_f32_16x16x32_bf16 v[76:79], v[200:203], v[144:147], v[76:79]
ds_read_b128 v[136:139], v4 offset:24576
s_waitcnt vmcnt(23)
v_mfma_f32_16x16x32_bf16 v[16:19], v[148:151], v[204:207], v[16:19]
buffer_load_dwordx4 v0, s[4:7], s49 offen offset:0 sc1 lds
s_waitcnt vmcnt(23)
v_mfma_f32_16x16x32_bf16 v[20:23], v[148:151], v[208:211], v[20:23]
s_add_u32 s51, s16, 16384
s_waitcnt lgkmcnt(5)
v_mfma_f32_16x16x32_bf16 v[24:27], v[152:155], v[204:207], v[24:27]
ds_read_b128 v[140:143], v4 offset:25600
ds_read_b128 v[144:147], v4 offset:26624
v_mfma_f32_16x16x32_bf16 v[28:31], v[152:155], v[208:211], v[28:31]
v_add_f32 v112, v112, v114
v_add_f32 v116, v116, v118
v_mfma_f32_16x16x32_bf16 v[32:35], v[156:159], v[204:207], v[32:35]
buffer_load_dwordx4 v[196:199], v0, s[4:7], s51 offen offset:0 sc1
v_mfma_f32_16x16x32_bf16 v[36:39], v[156:159], v[208:211], v[36:39]
ds_read_b128 v[148:151], v4 offset:27648
v_add_f32 v113, v113, v115
v_mfma_f32_16x16x32_bf16 v[40:43], v[160:163], v[204:207], v[40:43]
ds_read_b128 v[152:155], v4 offset:28672
v_add_f32 v117, v117, v119
v_mfma_f32_16x16x32_bf16 v[44:47], v[160:163], v[208:211], v[44:47]
v_permlane16_swap_b32 v112, v113
s_waitcnt lgkmcnt(6)
v_mfma_f32_16x16x32_bf16 v[48:51], v[164:167], v[204:207], v[48:51]
buffer_load_dwordx4 v[200:203], v1, s[4:7], s51 offen offset:0 sc1
v_mfma_f32_16x16x32_bf16 v[52:55], v[164:167], v[208:211], v[52:55]
ds_read_b128 v[156:159], v4 offset:29696
v_permlane16_swap_b32 v116, v117
v_mfma_f32_16x16x32_bf16 v[56:59], v[204:207], v[168:171], v[56:59]
ds_read_b128 v[160:163], v4 offset:30720
v_add_f32 v112, v112, v113
v_mfma_f32_16x16x32_bf16 v[60:63], v[208:211], v[168:171], v[60:63]
buffer_load_dwordx4 v0, s[4:7], s49 offen offset:1024 sc1 lds
v_mfma_f32_16x16x32_bf16 v[64:67], v[204:207], v[172:175], v[64:67]
s_add_u32 m0, s42, 0
s_add_u32 s49, s18, 155648
v_mfma_f32_16x16x32_bf16 v[68:71], v[208:211], v[172:175], v[68:71]
ds_read_b128 v[164:167], v4 offset:31744
s_waitcnt lgkmcnt(6)
v_mfma_f32_16x16x32_bf16 v[72:75], v[204:207], v[176:179], v[72:75]
buffer_load_dwordx4 v0, s[4:7], s49 offen offset:0 sc1 lds
v_mfma_f32_16x16x32_bf16 v[76:79], v[208:211], v[176:179], v[76:79]
v_add_f32 v116, v116, v117
v_mov_b32 v113, v112
s_waitcnt vmcnt(22)
v_mfma_f32_16x16x32_bf16 v[16:19], v[136:139], v[212:215], v[16:19]
s_barrier
s_waitcnt vmcnt(21)
v_mfma_f32_16x16x32_bf16 v[20:23], v[136:139], v[216:219], v[20:23]
ds_read_b128 v[168:171], v4 offset:32768
ds_read_b128 v[172:175], v4 offset:33792
v_mfma_f32_16x16x32_bf16 v[24:27], v[140:143], v[212:215], v[24:27]
buffer_load_dwordx4 v0, s[4:7], s49 offen offset:1024 sc1 lds
v_mfma_f32_16x16x32_bf16 v[28:31], v[140:143], v[216:219], v[28:31]
ds_read_b128 v[176:179], v4 offset:34816
s_waitcnt lgkmcnt(6)
v_mfma_f32_16x16x32_bf16 v[32:35], v[144:147], v[212:215], v[32:35]
ds_read_b128 v[136:139], v4 offset:35840
v_mov_b32 v117, v116
v_mfma_f32_16x16x32_bf16 v[36:39], v[144:147], v[216:219], v[36:39]
buffer_load_dwordx4 v[204:207], v0, s[4:7], s51 offen offset:1024 sc1
v_mfma_f32_16x16x32_bf16 v[40:43], v[148:151], v[212:215], v[40:43]
ds_read_b128 v[140:143], v4 offset:36864
v_permlane32_swap_b32 v112, v113
v_mfma_f32_16x16x32_bf16 v[44:47], v[148:151], v[216:219], v[44:47]
v_permlane32_swap_b32 v116, v117
v_add_f32 v112, v112, v113
v_mfma_f32_16x16x32_bf16 v[48:51], v[152:155], v[212:215], v[48:51]
ds_read_b128 v[144:147], v4 offset:37888
v_add_f32 v116, v116, v117
v_mfma_f32_16x16x32_bf16 v[52:55], v[152:155], v[216:219], v[52:55]
v_mov_b32 v113, v112
s_waitcnt lgkmcnt(6)
v_mfma_f32_16x16x32_bf16 v[56:59], v[212:215], v[156:159], v[56:59]
buffer_load_dwordx4 v[208:211], v1, s[4:7], s51 offen offset:1024 sc1
v_mfma_f32_16x16x32_bf16 v[60:63], v[216:219], v[156:159], v[60:63]
s_add_u32 m0, s85, 24576
s_add_u32 s49, s20, 0
v_mfma_f32_16x16x32_bf16 v[64:67], v[212:215], v[160:163], v[64:67]
ds_read_b128 v[148:151], v4 offset:38912
ds_read_b128 v[152:155], v4 offset:39936
v_mfma_f32_16x16x32_bf16 v[68:71], v[216:219], v[160:163], v[68:71]
buffer_load_dwordx4 v0, s[4:7], s49 offen offset:0 sc1 lds
v_mfma_f32_16x16x32_bf16 v[72:75], v[212:215], v[164:167], v[72:75]
ds_read_b128 v[156:159], v4 offset:40960
v_mov_b32 v117, v116
v_mfma_f32_16x16x32_bf16 v[76:79], v[216:219], v[164:167], v[76:79]
v_permlane16_swap_b32 v112, v113
s_waitcnt lgkmcnt(6)
s_waitcnt vmcnt(24)
v_mfma_f32_16x16x32_bf16 v[16:19], v[168:171], v[220:223], v[16:19]
s_add_u32 s48, s40, 8192
v_lshlrev_b32 v86, 9, v9
v_and_b32 v86, 2048, v86
buffer_load_dword v86, v86, s[4:7], s48 offen
s_waitcnt vmcnt(24)
v_mfma_f32_16x16x32_bf16 v[20:23], v[168:171], v[224:227], v[20:23]
ds_read_b128 v[160:163], v4 offset:41984
v_permlane16_swap_b32 v116, v117
v_mfma_f32_16x16x32_bf16 v[24:27], v[172:175], v[220:223], v[24:27]
ds_read_b128 v[164:167], v4 offset:43008
v_mul_f32 v236, 0x3acccccd, v112
v_mfma_f32_16x16x32_bf16 v[28:31], v[172:175], v[224:227], v[28:31]
buffer_load_dwordx4 v[212:215], v0, s[4:7], s51 offen offset:2048 sc1
v_mfma_f32_16x16x32_bf16 v[32:35], v[176:179], v[220:223], v[32:35]
ds_read_b128 v[168:171], v4 offset:44032
v_mul_f32 v238, 0x3acccccd, v116
v_mfma_f32_16x16x32_bf16 v[36:39], v[176:179], v[224:227], v[36:39]
v_mul_f32 v113, 0x3acccccd, v113
s_waitcnt lgkmcnt(6)
v_mfma_f32_16x16x32_bf16 v[40:43], v[136:139], v[220:223], v[40:43]
ds_read_b128 v[172:175], v4 offset:45056
v_mul_f32 v117, 0x3acccccd, v117
v_mfma_f32_16x16x32_bf16 v[44:47], v[136:139], v[224:227], v[44:47]
buffer_load_dwordx4 v[216:219], v1, s[4:7], s51 offen offset:2048 sc1
v_mfma_f32_16x16x32_bf16 v[48:51], v[140:143], v[220:223], v[48:51]
ds_read_b128 v[176:179], v4 offset:46080
v_fma_f32 v113, -v236, v236, v113
v_mfma_f32_16x16x32_bf16 v[52:55], v[140:143], v[224:227], v[52:55]
v_fma_f32 v117, -v238, v238, v117
v_max_f32 v113, 0, v113
v_mfma_f32_16x16x32_bf16 v[56:59], v[220:223], v[144:147], v[56:59]
buffer_load_dwordx4 v0, s[4:7], s49 offen offset:1024 sc1 lds
v_mfma_f32_16x16x32_bf16 v[60:63], v[224:227], v[144:147], v[60:63]
ds_read_b128 v[136:139], v4 offset:47104
s_waitcnt lgkmcnt(6)
v_mfma_f32_16x16x32_bf16 v[64:67], v[220:223], v[148:151], v[64:67]
ds_read_b128 v[140:143], v4 offset:48128
v_max_f32 v117, 0, v117
v_mfma_f32_16x16x32_bf16 v[68:71], v[224:227], v[148:151], v[68:71]
v_add_f32 v113, 0x3727c5ac, v113
v_add_f32 v117, 0x3727c5ac, v117
v_mfma_f32_16x16x32_bf16 v[72:75], v[220:223], v[152:155], v[72:75]
buffer_load_dwordx4 v0, s[4:7], s49 offen offset:2048 sc1 lds
v_mfma_f32_16x16x32_bf16 v[76:79], v[224:227], v[152:155], v[76:79]
v_rsq_f32 v237, v113
s_waitcnt vmcnt(23)
v_mfma_f32_16x16x32_bf16 v[16:19], v[156:159], v[228:231], v[16:19]
s_barrier
s_waitcnt vmcnt(22)
v_mfma_f32_16x16x32_bf16 v[20:23], v[156:159], v[232:235], v[20:23]
ds_read_b128 v[144:147], v4 offset:49152
s_waitcnt lgkmcnt(5)
v_mfma_f32_16x16x32_bf16 v[24:27], v[160:163], v[228:231], v[24:27]
buffer_load_dwordx4 v[220:223], v0, s[4:7], s51 offen offset:3072 sc1
v_mfma_f32_16x16x32_bf16 v[28:31], v[160:163], v[232:235], v[28:31]
ds_read_b128 v[148:151], v4 offset:50176
ds_read_b128 v[152:155], v4 offset:51200
v_mfma_f32_16x16x32_bf16 v[32:35], v[164:167], v[228:231], v[32:35]
ds_read_b128 v[156:159], v4 offset:52224
v_mfma_f32_16x16x32_bf16 v[36:39], v[164:167], v[232:235], v[36:39]
buffer_load_dwordx4 v[224:227], v1, s[4:7], s51 offen offset:3072 sc1
v_mfma_f32_16x16x32_bf16 v[40:43], v[168:171], v[228:231], v[40:43]
ds_read_b128 v[160:163], v4 offset:53248
v_mfma_f32_16x16x32_bf16 v[44:47], v[168:171], v[232:235], v[44:47]
s_waitcnt lgkmcnt(6)
v_mfma_f32_16x16x32_bf16 v[48:51], v[172:175], v[228:231], v[48:51]
buffer_load_dwordx4 v0, s[4:7], s49 offen offset:3072 sc1 lds
v_mfma_f32_16x16x32_bf16 v[52:55], v[172:175], v[232:235], v[52:55]
s_add_u32 m0, s85, 40960
s_add_u32 s49, s20, 4096
v_mfma_f32_16x16x32_bf16 v[56:59], v[228:231], v[176:179], v[56:59]
ds_read_b128 v[164:167], v4 offset:54272
ds_read_b128 v[168:171], v4 offset:55296
v_mfma_f32_16x16x32_bf16 v[60:63], v[232:235], v[176:179], v[60:63]
v_rsq_f32 v239, v117
v_mfma_f32_16x16x32_bf16 v[64:67], v[228:231], v[136:139], v[64:67]
buffer_load_dwordx4 v0, s[4:7], s49 offen offset:0 sc1 lds
v_mfma_f32_16x16x32_bf16 v[68:71], v[232:235], v[136:139], v[68:71]
ds_read_b128 v[172:175], v4 offset:56320
s_waitcnt lgkmcnt(6)
v_mfma_f32_16x16x32_bf16 v[72:75], v[228:231], v[140:143], v[72:75]
ds_read_b128 v[176:179], v4 offset:57344
v_cndmask_b32 v114, v236, v237, s[66:67]
v_mfma_f32_16x16x32_bf16 v[76:79], v[232:235], v[140:143], v[76:79]
buffer_load_dwordx4 v0, s[4:7], s49 offen offset:1024 sc1 lds
s_waitcnt vmcnt(26)
v_mfma_f32_16x16x32_bf16 v[16:19], v[144:147], v[180:183], v[16:19]
ds_read_b128 v[136:139], v4 offset:58368
v_cndmask_b32 v118, v238, v239, s[66:67]
s_waitcnt vmcnt(25)
v_mfma_f32_16x16x32_bf16 v[20:23], v[144:147], v[184:187], v[20:23]
ds_write_b32 v108, v114 offset:0
ds_write_b32 v108, v118 offset:128
v_mfma_f32_16x16x32_bf16 v[24:27], v[148:151], v[180:183], v[24:27]
ds_read_b128 v[140:143], v4 offset:59392
v_mul_f32 v240, 0x3ea52b5c, v237
v_mfma_f32_16x16x32_bf16 v[28:31], v[148:151], v[184:187], v[28:31]
v_mul_f32 v241, 0x3ea52b5c, v239
s_waitcnt lgkmcnt(8)
v_mfma_f32_16x16x32_bf16 v[32:35], v[152:155], v[180:183], v[32:35]
buffer_load_dwordx4 v0, s[4:7], s49 offen offset:2048 sc1 lds
v_mfma_f32_16x16x32_bf16 v[36:39], v[152:155], v[184:187], v[36:39]
ds_read_b128 v[144:147], v4 offset:60416
v_cndmask_b32_e64 v242, v237, 1.0, s[60:61]
v_mfma_f32_16x16x32_bf16 v[40:43], v[156:159], v[180:183], v[40:43]
ds_read_b128 v[148:151], v4 offset:61440
v_cndmask_b32_e64 v243, v239, 1.0, s[60:61]
v_mfma_f32_16x16x32_bf16 v[44:47], v[156:159], v[184:187], v[44:47]
buffer_load_dwordx4 v0, s[4:7], s49 offen offset:3072 sc1 lds
v_mfma_f32_16x16x32_bf16 v[48:51], v[160:163], v[180:183], v[48:51]
s_add_u32 m0, s85, 57344
s_add_u32 s49, s20, 8192
v_mfma_f32_16x16x32_bf16 v[52:55], v[160:163], v[184:187], v[52:55]
ds_read_b128 v[152:155], v4 offset:62464
s_waitcnt lgkmcnt(8)
v_mfma_f32_16x16x32_bf16 v[56:59], v[180:183], v[164:167], v[56:59]
buffer_load_dwordx4 v0, s[4:7], s49 offen offset:0 sc1 lds
v_mfma_f32_16x16x32_bf16 v[60:63], v[184:187], v[164:167], v[60:63]
ds_read_b128 v[156:159], v4 offset:63488
s_waitcnt lgkmcnt(5)
ds_read_b128 v[112:115], v109 offset:0
v_mfma_f32_16x16x32_bf16 v[64:67], v[180:183], v[168:171], v[64:67]
ds_read_b128 v[160:163], v4 offset:64512
ds_read_b128 v[116:119], v109 offset:64
v_mfma_f32_16x16x32_bf16 v[68:71], v[184:187], v[168:171], v[68:71]
buffer_load_dwordx4 v0, s[4:7], s49 offen offset:1024 sc1 lds
v_mfma_f32_16x16x32_bf16 v[72:75], v[180:183], v[172:175], v[72:75]
ds_read_b128 v[120:123], v109 offset:128
ds_read_b128 v[124:127], v109 offset:192
v_mfma_f32_16x16x32_bf16 v[76:79], v[184:187], v[172:175], v[76:79]
s_waitcnt lgkmcnt(9)
s_waitcnt vmcnt(24)
v_mfma_f32_16x16x32_bf16 v[16:19], v[176:179], v[188:191], v[16:19]
s_barrier
s_waitcnt vmcnt(23)
v_mfma_f32_16x16x32_bf16 v[20:23], v[176:179], v[192:195], v[20:23]
buffer_load_dwordx4 v0, s[4:7], s49 offen offset:2048 sc1 lds
v_mfma_f32_16x16x32_bf16 v[24:27], v[136:139], v[188:191], v[24:27]
ds_read_b128 v[164:167], v5 offset:0
ds_read_b128 v[168:171], v5 offset:1024
v_mfma_f32_16x16x32_bf16 v[28:31], v[136:139], v[192:195], v[28:31]
ds_read_b128 v[172:175], v5 offset:2048
v_mfma_f32_16x16x32_bf16 v[32:35], v[140:143], v[188:191], v[32:35]
buffer_load_dwordx4 v0, s[4:7], s49 offen offset:3072 sc1 lds
v_mfma_f32_16x16x32_bf16 v[36:39], v[140:143], v[192:195], v[36:39]
s_add_u32 m0, s85, 73728
s_waitcnt lgkmcnt(9)
v_mfma_f32_16x16x32_bf16 v[40:43], v[144:147], v[188:191], v[40:43]
s_add_u32 s49, s20, 12288
ds_read_b128 v[176:179], v5 offset:3072
v_mfma_f32_16x16x32_bf16 v[44:47], v[144:147], v[192:195], v[44:47]
ds_read_b128 v[136:139], v5 offset:4096
v_mfma_f32_16x16x32_bf16 v[48:51], v[148:151], v[188:191], v[48:51]
buffer_load_dwordx4 v0, s[4:7], s49 offen offset:0 sc1 lds
v_mfma_f32_16x16x32_bf16 v[52:55], v[148:151], v[192:195], v[52:55]
ds_read_b128 v[140:143], v5 offset:5120
v_mfma_f32_16x16x32_bf16 v[56:59], v[188:191], v[152:155], v[56:59]
ds_read_b128 v[144:147], v5 offset:6144
v_mfma_f32_16x16x32_bf16 v[60:63], v[192:195], v[152:155], v[60:63]
s_waitcnt lgkmcnt(6)
v_mfma_f32_16x16x32_bf16 v[64:67], v[188:191], v[156:159], v[64:67]
buffer_load_dwordx4 v0, s[4:7], s49 offen offset:1024 sc1 lds
v_mfma_f32_16x16x32_bf16 v[68:71], v[192:195], v[156:159], v[68:71]
ds_read_b128 v[148:151], v5 offset:7168
v_mfma_f32_16x16x32_bf16 v[72:75], v[188:191], v[160:163], v[72:75]
ds_read_b128 v[152:155], v5 offset:8192
v_mfma_f32_16x16x32_bf16 v[76:79], v[192:195], v[160:163], v[76:79]
buffer_load_dwordx4 v0, s[4:7], s49 offen offset:2048 sc1 lds
s_waitcnt vmcnt(26)
v_mfma_f32_16x16x32_bf16 v[16:19], v[164:167], v[196:199], v[16:19]
ds_read_b128 v[156:159], v5 offset:9216
s_waitcnt vmcnt(25)
v_mfma_f32_16x16x32_bf16 v[20:23], v[164:167], v[200:203], v[20:23]
s_waitcnt lgkmcnt(6)
v_mfma_f32_16x16x32_bf16 v[24:27], v[168:171], v[196:199], v[24:27]
buffer_load_dword v3, v111, s[4:7], s37 offen
v_mfma_f32_16x16x32_bf16 v[28:31], v[168:171], v[200:203], v[28:31]
ds_read_b128 v[160:163], v5 offset:10240
v_mfma_f32_16x16x32_bf16 v[32:35], v[172:175], v[196:199], v[32:35]
ds_read_b128 v[164:167], v5 offset:11264
v_mfma_f32_16x16x32_bf16 v[36:39], v[172:175], v[200:203], v[36:39]
v_mfma_f32_16x16x32_bf16 v[40:43], v[176:179], v[196:199], v[40:43]
buffer_load_dword v14, v110, s[4:7], s38 offen
v_mfma_f32_16x16x32_bf16 v[44:47], v[176:179], v[200:203], v[44:47]
ds_read_b128 v[168:171], v5 offset:12288
s_waitcnt lgkmcnt(6)
v_mfma_f32_16x16x32_bf16 v[48:51], v[136:139], v[196:199], v[48:51]
ds_read_b128 v[172:175], v5 offset:13312
v_mfma_f32_16x16x32_bf16 v[52:55], v[136:139], v[200:203], v[52:55]
buffer_load_dwordx4 v0, s[4:7], s49 offen offset:3072 sc1 lds
v_mfma_f32_16x16x32_bf16 v[56:59], v[196:199], v[140:143], v[56:59]
s_add_u32 m0, s85, 90112
s_add_u32 s49, s20, 16384
v_mfma_f32_16x16x32_bf16 v[60:63], v[200:203], v[140:143], v[60:63]
ds_read_b128 v[176:179], v5 offset:14336
v_mfma_f32_16x16x32_bf16 v[64:67], v[196:199], v[144:147], v[64:67]
ds_read_b128 v[136:139], v5 offset:15360
v_mfma_f32_16x16x32_bf16 v[68:71], v[200:203], v[144:147], v[68:71]
s_waitcnt lgkmcnt(6)
v_mfma_f32_16x16x32_bf16 v[72:75], v[196:199], v[148:151], v[72:75]
buffer_load_dwordx4 v0, s[4:7], s49 offen offset:0 sc1 lds
v_mfma_f32_16x16x32_bf16 v[76:79], v[200:203], v[148:151], v[76:79]
s_waitcnt vmcnt(25)
v_mfma_f32_16x16x32_bf16 v[16:19], v[152:155], v[204:207], v[16:19]
s_barrier
s_waitcnt vmcnt(24)
v_mfma_f32_16x16x32_bf16 v[20:23], v[152:155], v[208:211], v[20:23]
buffer_load_dwordx4 v0, s[4:7], s49 offen offset:1024 sc1 lds
v_mfma_f32_16x16x32_bf16 v[24:27], v[156:159], v[204:207], v[24:27]
ds_read_b128 v[140:143], v5 offset:16384
ds_read_b128 v[144:147], v5 offset:17408
v_mfma_f32_16x16x32_bf16 v[28:31], v[156:159], v[208:211], v[28:31]
ds_read_b128 v[148:151], v5 offset:18432
s_waitcnt lgkmcnt(6)
v_mfma_f32_16x16x32_bf16 v[32:35], v[160:163], v[204:207], v[32:35]
buffer_load_dwordx4 v0, s[4:7], s49 offen offset:2048 sc1 lds
v_mfma_f32_16x16x32_bf16 v[36:39], v[160:163], v[208:211], v[36:39]
ds_read_b128 v[152:155], v5 offset:19456
v_mfma_f32_16x16x32_bf16 v[40:43], v[164:167], v[204:207], v[40:43]
ds_read_b128 v[156:159], v5 offset:20480
ds_read_b128 v[188:191], v106 offset:128
v_mfma_f32_16x16x32_bf16 v[44:47], v[164:167], v[208:211], v[44:47]
buffer_load_dwordx4 v0, s[4:7], s49 offen offset:3072 sc1 lds
v_mfma_f32_16x16x32_bf16 v[48:51], v[168:171], v[204:207], v[48:51]
s_add_u32 m0, s85, 106496
s_add_u32 s49, s20, 20480
v_mfma_f32_16x16x32_bf16 v[52:55], v[168:171], v[208:211], v[52:55]
ds_read_b128 v[160:163], v5 offset:21504
s_waitcnt lgkmcnt(7)
v_mfma_f32_16x16x32_bf16 v[56:59], v[204:207], v[172:175], v[56:59]
ds_read_b128 v[164:167], v5 offset:22528
ds_read_b128 v[192:195], v106 offset:192
v_mfma_f32_16x16x32_bf16 v[60:63], v[208:211], v[172:175], v[60:63]
buffer_load_dwordx4 v0, s[4:7], s49 offen offset:0 sc1 lds
v_mfma_f32_16x16x32_bf16 v[64:67], v[204:207], v[176:179], v[64:67]
ds_read_b128 v[168:171], v5 offset:23552
ds_read_b128 v[196:199], v106 offset:256
v_mfma_f32_16x16x32_bf16 v[68:71], v[208:211], v[176:179], v[68:71]
ds_read_b32 v228, v107 offset:320
ds_read_b32 v229, v107 offset:384
v_mfma_f32_16x16x32_bf16 v[72:75], v[204:207], v[136:139], v[72:75]
buffer_load_dwordx4 v0, s[4:7], s49 offen offset:1024 sc1 lds
v_mfma_f32_16x16x32_bf16 v[76:79], v[208:211], v[136:139], v[76:79]
ds_read_b128 v[172:175], v0 offset:0
s_waitcnt lgkmcnt(11)
s_waitcnt vmcnt(26)
v_mfma_f32_16x16x32_bf16 v[16:19], v[140:143], v[212:215], v[16:19]
ds_read_b128 v[176:179], v0 offset:1024
ds_read_b32 v230, v107 offset:448
s_waitcnt vmcnt(25)
v_mfma_f32_16x16x32_bf16 v[20:23], v[140:143], v[216:219], v[20:23]
ds_read_b128 v[180:183], v106 offset:0
ds_read_b128 v[184:187], v106 offset:64
v_mfma_f32_16x16x32_bf16 v[24:27], v[144:147], v[212:215], v[24:27]
buffer_load_dwordx4 v0, s[4:7], s49 offen offset:2048 sc1 lds
v_mfma_f32_16x16x32_bf16 v[28:31], v[144:147], v[216:219], v[28:31]
ds_read_b128 v[136:139], v0 offset:2048
v_mfma_f32_16x16x32_bf16 v[32:35], v[148:151], v[212:215], v[32:35]
ds_read_b128 v[140:143], v0 offset:3072
v_mfma_f32_16x16x32_bf16 v[36:39], v[148:151], v[216:219], v[36:39]
s_waitcnt lgkmcnt(13)
v_mfma_f32_16x16x32_bf16 v[40:43], v[152:155], v[212:215], v[40:43]
buffer_load_dwordx4 v0, s[4:7], s49 offen offset:3072 sc1 lds
v_mfma_f32_16x16x32_bf16 v[44:47], v[152:155], v[216:219], v[44:47]
s_add_u32 m0, s44, 122880
s_add_u32 s49, s20, 24576
v_mfma_f32_16x16x32_bf16 v[48:51], v[156:159], v[212:215], v[48:51]
ds_read_b128 v[144:147], v0 offset:4096
ds_read_b128 v[148:151], v0 offset:5120
v_mfma_f32_16x16x32_bf16 v[52:55], v[156:159], v[216:219], v[52:55]
buffer_load_dwordx4 v0, s[4:7], s49 offen offset:0 sc1 lds
v_mfma_f32_16x16x32_bf16 v[56:59], v[212:215], v[160:163], v[56:59]
ds_read_b128 v[152:155], v0 offset:6144
v_mfma_f32_16x16x32_bf16 v[60:63], v[216:219], v[160:163], v[60:63]
s_waitcnt lgkmcnt(9)
v_mfma_f32_16x16x32_bf16 v[64:67], v[212:215], v[164:167], v[64:67]
ds_read_b128 v[156:159], v0 offset:7168
v_mfma_f32_16x16x32_bf16 v[68:71], v[216:219], v[164:167], v[68:71]
v_mfma_f32_16x16x32_bf16 v[72:75], v[212:215], v[168:171], v[72:75]
v_mfma_f32_16x16x32_bf16 v[76:79], v[216:219], v[168:171], v[76:79]
s_waitcnt vmcnt(25)
v_mfma_f32_16x16x32_bf16 v[16:19], v[172:175], v[220:223], v[16:19]
s_waitcnt vmcnt(24)
v_mfma_f32_16x16x32_bf16 v[20:23], v[172:175], v[224:227], v[20:23]
s_waitcnt lgkmcnt(4)
v_mfma_f32_16x16x32_bf16 v[24:27], v[176:179], v[220:223], v[24:27]
v_mfma_f32_16x16x32_bf16 v[28:31], v[176:179], v[224:227], v[28:31]
v_mfma_f32_16x16x32_bf16 v[32:35], v[136:139], v[220:223], v[32:35]
v_mfma_f32_16x16x32_bf16 v[36:39], v[136:139], v[224:227], v[36:39]
v_mfma_f32_16x16x32_bf16 v[40:43], v[140:143], v[220:223], v[40:43]
v_mfma_f32_16x16x32_bf16 v[44:47], v[140:143], v[224:227], v[44:47]
s_waitcnt lgkmcnt(1)
v_mfma_f32_16x16x32_bf16 v[48:51], v[144:147], v[220:223], v[48:51]
v_mfma_f32_16x16x32_bf16 v[52:55], v[144:147], v[224:227], v[52:55]
v_mfma_f32_16x16x32_bf16 v[56:59], v[220:223], v[148:151], v[56:59]
v_mfma_f32_16x16x32_bf16 v[60:63], v[224:227], v[148:151], v[60:63]
v_mfma_f32_16x16x32_bf16 v[64:67], v[220:223], v[152:155], v[64:67]
v_mfma_f32_16x16x32_bf16 v[68:71], v[224:227], v[152:155], v[68:71]
s_waitcnt lgkmcnt(0)
v_mfma_f32_16x16x32_bf16 v[72:75], v[220:223], v[156:159], v[72:75]
v_mfma_f32_16x16x32_bf16 v[76:79], v[224:227], v[156:159], v[76:79]
C_p1e1:
v_pk_fma_f32 v[36:37], v[188:189], v[238:239], v[36:37] op_sel_hi:[1,0,1] neg_lo:[0,1,0] neg_hi:[0,1,0]
v_pk_fma_f32 v[38:39], v[190:191], v[238:239], v[38:39] op_sel_hi:[1,0,1] neg_lo:[0,1,0] neg_hi:[0,1,0]
v_pk_mul_f32 v[36:37], v[36:37], v[238:239] op_sel:[0,1] op_sel_hi:[1,1]
v_pk_mul_f32 v[38:39], v[38:39], v[238:239] op_sel:[0,1] op_sel_hi:[1,1]
v_cvt_pk_bf16_f32 v164, v36, v37
v_cvt_pk_bf16_f32 v165, v38, v39
v_pk_fma_f32 v[44:45], v[192:193], v[238:239], v[44:45] op_sel_hi:[1,0,1] neg_lo:[0,1,0] neg_hi:[0,1,0]
v_pk_fma_f32 v[46:47], v[194:195], v[238:239], v[46:47] op_sel_hi:[1,0,1] neg_lo:[0,1,0] neg_hi:[0,1,0]
v_pk_mul_f32 v[44:45], v[44:45], v[238:239] op_sel:[0,1] op_sel_hi:[1,1]
v_pk_mul_f32 v[46:47], v[46:47], v[238:239] op_sel:[0,1] op_sel_hi:[1,1]
v_cvt_pk_bf16_f32 v168, v44, v45
v_cvt_pk_bf16_f32 v169, v46, v47
v_pk_fma_f32 v[52:53], v[196:197], v[238:239], v[52:53] op_sel_hi:[1,0,1] neg_lo:[0,1,0] neg_hi:[0,1,0]
v_pk_fma_f32 v[54:55], v[198:199], v[238:239], v[54:55] op_sel_hi:[1,0,1] neg_lo:[0,1,0] neg_hi:[0,1,0]
v_pk_mul_f32 v[52:53], v[52:53], v[242:243] op_sel:[0,1] op_sel_hi:[1,1]
v_pk_mul_f32 v[54:55], v[54:55], v[242:243] op_sel:[0,1] op_sel_hi:[1,1]
v_cvt_pk_bf16_f32 v172, v52, v53
v_cvt_pk_bf16_f32 v173, v54, v55
v_cvt_pk_bf16_f32 v166, v52, v53
v_cvt_pk_bf16_f32 v167, v54, v55
v_cndmask_b32_e64 v146, 0, v172, s[56:57]
v_cndmask_b32_e64 v148, 0, v172, s[58:59]
v_cndmask_b32_e64 v147, 0, v173, s[56:57]
v_cndmask_b32_e64 v149, 0, v173, s[58:59]
v_pk_fma_f32 v[60:61], v[120:121], v[228:229], v[60:61] op_sel:[0,0,0] op_sel_hi:[1,0,1] neg_lo:[1,0,0] neg_hi:[1,0,0]
v_pk_fma_f32 v[62:63], v[122:123], v[228:229], v[62:63] op_sel:[0,0,0] op_sel_hi:[1,0,1] neg_lo:[1,0,0] neg_hi:[1,0,0]
v_pk_mul_f32 v[60:61], v[60:61], v[124:125]
v_pk_mul_f32 v[62:63], v[62:63], v[126:127]
v_cvt_pk_bf16_f32 v208, v60, v61
v_cvt_pk_bf16_f32 v209, v62, v63
v_pk_fma_f32 v[68:69], v[120:121], v[228:229], v[68:69] op_sel:[0,1,0] op_sel_hi:[1,1,1] neg_lo:[1,0,0] neg_hi:[1,0,0]
v_pk_fma_f32 v[70:71], v[122:123], v[228:229], v[70:71] op_sel:[0,1,0] op_sel_hi:[1,1,1] neg_lo:[1,0,0] neg_hi:[1,0,0]
v_pk_mul_f32 v[68:69], v[68:69], v[124:125]
v_pk_mul_f32 v[70:71], v[70:71], v[126:127]
v_cvt_pk_bf16_f32 v214, v68, v69
v_cvt_pk_bf16_f32 v215, v70, v71
v_pk_fma_f32 v[76:77], v[120:121], v[230:231], v[76:77] op_sel:[0,0,0] op_sel_hi:[1,0,1] neg_lo:[1,0,0] neg_hi:[1,0,0]
v_pk_fma_f32 v[78:79], v[122:123], v[230:231], v[78:79] op_sel:[0,0,0] op_sel_hi:[1,0,1] neg_lo:[1,0,0] neg_hi:[1,0,0]
v_pk_mul_f32 v[76:77], v[76:77], v[124:125]
v_pk_mul_f32 v[78:79], v[78:79], v[126:127]
v_cvt_pk_bf16_f32 v220, v76, v77
v_cvt_pk_bf16_f32 v221, v78, v79
v_permlane32_swap_b32 v172, v166
v_permlane32_swap_b32 v173, v167
v_cndmask_b32 v220, v220, v102, s[62:63]
v_cndmask_b32 v221, v221, v102, s[62:63]
s_add_u32 s54, s41, 1048576
s_cmp_lg_u32 s12, 3
s_cbranch_scc1 KX34
v_mov_b32 v80, v164
v_mov_b32 v81, v165
v_mov_b32 v82, v166
v_mov_b32 v83, s89
buffer_store_dwordx4 v[80:83], v0, s[4:7], s54 offen offset:0 sc1
v_mov_b32 v84, v167
v_mov_b32 v85, v168
v_mov_b32 v86, v169
v_mov_b32 v87, s89
buffer_store_dwordx4 v[84:87], v0, s[4:7], s54 offen offset:1024 sc1
v_mov_b32 v128, v208
v_mov_b32 v129, v209
v_mov_b32 v130, v214
v_mov_b32 v131, s89
buffer_store_dwordx4 v[128:131], v0, s[4:7], s54 offen offset:2048 sc1
v_mov_b32 v132, v215
v_mov_b32 v133, v220
v_mov_b32 v134, v221
v_mov_b32 v135, s89
buffer_store_dwordx4 v[132:135], v0, s[4:7], s54 offen offset:3072 sc1
KX34:
ds_write_b64 v100, v[164:165] offset:0
ds_write_b64 v100, v[166:167] offset:512
ds_write_b64 v100, v[168:169] offset:1024
ds_write_b64 v100, v[208:209] offset:1536
ds_write_b64 v100, v[214:215] offset:2048
ds_write_b64 v100, v[220:221] offset:2560
v_pk_fma_f32 v[32:33], v[188:189], v[236:237], v[32:33] op_sel_hi:[1,0,1] neg_lo:[0,1,0] neg_hi:[0,1,0]
v_pk_fma_f32 v[34:35], v[190:191], v[236:237], v[34:35] op_sel_hi:[1,0,1] neg_lo:[0,1,0] neg_hi:[0,1,0]
v_pk_mul_f32 v[32:33], v[32:33], v[236:237] op_sel:[0,1] op_sel_hi:[1,1]
v_pk_mul_f32 v[34:35], v[34:35], v[236:237] op_sel:[0,1] op_sel_hi:[1,1]
v_cvt_pk_bf16_f32 v158, v32, v33
v_cvt_pk_bf16_f32 v159, v34, v35
v_pk_fma_f32 v[40:41], v[192:193], v[236:237], v[40:41] op_sel_hi:[1,0,1] neg_lo:[0,1,0] neg_hi:[0,1,0]
v_pk_fma_f32 v[42:43], v[194:195], v[236:237], v[42:43] op_sel_hi:[1,0,1] neg_lo:[0,1,0] neg_hi:[0,1,0]
v_pk_mul_f32 v[40:41], v[40:41], v[236:237] op_sel:[0,1] op_sel_hi:[1,1]
v_pk_mul_f32 v[42:43], v[42:43], v[236:237] op_sel:[0,1] op_sel_hi:[1,1]
v_cvt_pk_bf16_f32 v162, v40, v41
v_cvt_pk_bf16_f32 v163, v42, v43
v_pk_fma_f32 v[48:49], v[196:197], v[236:237], v[48:49] op_sel_hi:[1,0,1] neg_lo:[0,1,0] neg_hi:[0,1,0]
v_pk_fma_f32 v[50:51], v[198:199], v[236:237], v[50:51] op_sel_hi:[1,0,1] neg_lo:[0,1,0] neg_hi:[0,1,0]
v_pk_mul_f32 v[48:49], v[48:49], v[242:243] op_sel:[0,0] op_sel_hi:[1,0]
v_pk_mul_f32 v[50:51], v[50:51], v[242:243] op_sel:[0,0] op_sel_hi:[1,0]
v_cvt_pk_bf16_f32 v170, v48, v49
v_cvt_pk_bf16_f32 v171, v50, v51
v_cvt_pk_bf16_f32 v160, v48, v49
v_cvt_pk_bf16_f32 v161, v50, v51
v_cndmask_b32_e64 v138, 0, v170, s[56:57]
v_cndmask_b32_e64 v140, 0, v170, s[58:59]
v_cndmask_b32_e64 v139, 0, v171, s[56:57]
v_cndmask_b32_e64 v141, 0, v171, s[58:59]
v_pk_fma_f32 v[56:57], v[112:113], v[228:229], v[56:57] op_sel:[0,0,0] op_sel_hi:[1,0,1] neg_lo:[1,0,0] neg_hi:[1,0,0]
v_pk_fma_f32 v[58:59], v[114:115], v[228:229], v[58:59] op_sel:[0,0,0] op_sel_hi:[1,0,1] neg_lo:[1,0,0] neg_hi:[1,0,0]
v_pk_mul_f32 v[56:57], v[56:57], v[116:117]
v_pk_mul_f32 v[58:59], v[58:59], v[118:119]
v_cvt_pk_bf16_f32 v206, v56, v57
v_cvt_pk_bf16_f32 v207, v58, v59
v_pk_fma_f32 v[64:65], v[112:113], v[228:229], v[64:65] op_sel:[0,1,0] op_sel_hi:[1,1,1] neg_lo:[1,0,0] neg_hi:[1,0,0]
v_pk_fma_f32 v[66:67], v[114:115], v[228:229], v[66:67] op_sel:[0,1,0] op_sel_hi:[1,1,1] neg_lo:[1,0,0] neg_hi:[1,0,0]
v_pk_mul_f32 v[64:65], v[64:65], v[116:117]
v_pk_mul_f32 v[66:67], v[66:67], v[118:119]
v_cvt_pk_bf16_f32 v212, v64, v65
v_cvt_pk_bf16_f32 v213, v66, v67
v_pk_fma_f32 v[72:73], v[112:113], v[230:231], v[72:73] op_sel:[0,0,0] op_sel_hi:[1,0,1] neg_lo:[1,0,0] neg_hi:[1,0,0]
v_pk_fma_f32 v[74:75], v[114:115], v[230:231], v[74:75] op_sel:[0,0,0] op_sel_hi:[1,0,1] neg_lo:[1,0,0] neg_hi:[1,0,0]
v_pk_mul_f32 v[72:73], v[72:73], v[116:117]
v_pk_mul_f32 v[74:75], v[74:75], v[118:119]
v_cvt_pk_bf16_f32 v218, v72, v73
v_cvt_pk_bf16_f32 v219, v74, v75
v_permlane32_swap_b32 v170, v160
v_permlane32_swap_b32 v171, v161
v_cndmask_b32 v218, v218, v102, s[62:63]
v_cndmask_b32 v219, v219, v102, s[62:63]
v_pk_fma_f32 v[20:21], v[180:181], v[238:239], v[20:21] op_sel_hi:[1,0,1] neg_lo:[0,1,0] neg_hi:[0,1,0]
v_pk_fma_f32 v[22:23], v[182:183], v[238:239], v[22:23] op_sel_hi:[1,0,1] neg_lo:[0,1,0] neg_hi:[0,1,0]
v_cvt_pk_bf16_f32 v144, v20, v21
v_cvt_pk_bf16_f32 v145, v22, v23
v_pk_fma_f32 v[28:29], v[184:185], v[238:239], v[28:29] op_sel_hi:[1,0,1] neg_lo:[0,1,0] neg_hi:[0,1,0]
v_pk_fma_f32 v[30:31], v[186:187], v[238:239], v[30:31] op_sel_hi:[1,0,1] neg_lo:[0,1,0] neg_hi:[0,1,0]
v_cvt_pk_bf16_f32 v150, v28, v29
v_cvt_pk_bf16_f32 v151, v30, v31
v_pk_fma_f32 v[16:17], v[180:181], v[236:237], v[16:17] op_sel_hi:[1,0,1] neg_lo:[0,1,0] neg_hi:[0,1,0]
v_pk_fma_f32 v[18:19], v[182:183], v[236:237], v[18:19] op_sel_hi:[1,0,1] neg_lo:[0,1,0] neg_hi:[0,1,0]
v_cvt_pk_bf16_f32 v136, v16, v17
v_cvt_pk_bf16_f32 v137, v18, v19
v_mfma_f32_16x16x32_bf16 v[36:39], v[164:167], v[144:147], v[88:91]
v_mfma_f32_16x16x32_bf16 v[32:35], v[158:161], v[144:147], v[92:95]
v_mfma_f32_16x16x32_bf16 v[44:47], v[166:169], v[148:151], v[88:91]
v_mfma_f32_16x16x32_bf16 v[40:43], v[160:163], v[148:151], v[92:95]
v_pk_fma_f32 v[24:25], v[184:185], v[236:237], v[24:25] op_sel_hi:[1,0,1] neg_lo:[0,1,0] neg_hi:[0,1,0]
v_pk_fma_f32 v[26:27], v[186:187], v[236:237], v[26:27] op_sel_hi:[1,0,1] neg_lo:[0,1,0] neg_hi:[0,1,0]
v_cvt_pk_bf16_f32 v142, v24, v25
v_cvt_pk_bf16_f32 v143, v26, v27
s_waitcnt lgkmcnt(0)
s_barrier
ds_read_b64 v[152:153], v101 offset:0
ds_read_b64 v[154:155], v101 offset:512
ds_read_b64 v[156:157], v101 offset:1024
ds_read_b64 v[204:205], v101 offset:1536
ds_read_b64 v[210:211], v101 offset:2048
ds_read_b64 v[216:217], v101 offset:2560
v_mfma_f32_16x16x32_bf16 v[20:23], v[158:161], v[136:139], v[88:91]
v_mfma_f32_16x16x32_bf16 v[28:31], v[160:163], v[140:143], v[88:91]
s_add_u32 s55, s17, 1048576
v_max_f32 v32, v32, v36
v_max_f32 v33, v33, v37
v_max_f32 v34, v34, v38
v_max_f32 v35, v35, v39
v_max_f32 v40, v40, v44
v_max_f32 v41, v41, v45
s_add_u32 m0, s43, 0
s_add_u32 s49, s19, 0
buffer_load_dwordx4 v0, s[4:7], s49 offen offset:0 sc1 lds
v_max_f32 v42, v42, v46
v_max_f32 v43, v43, v47
v_max3_f32 v172, v32, v33, v34
v_max3_f32 v173, v40, v41, v42
v_max_f32 v172, v172, v35
v_max_f32 v173, v173, v43
s_nop 1
v_permlane16_swap_b32 v172, v173
v_max_f32 v172, v172, v173
buffer_load_dwordx4 v0, s[4:7], s49 offen offset:1024 sc1 lds
v_mov_b32 v173, v172
s_nop 1
v_permlane32_swap_b32 v172, v173
v_max_f32 v172, v172, v173
v_mul_f32_e64 v172, -v172, v241
v_mov_b32 v173, v172
s_nop 1
v_permlane16_swap_b32 v172, v173
v_fma_f32 v32, v32, v241, v172
v_fma_f32 v33, v33, v241, v172
buffer_load_dwordx4 v0, s[4:7], s49 offen offset:2048 sc1 lds
v_fma_f32 v34, v34, v241, v172
v_fma_f32 v35, v35, v241, v172
v_exp_f32 v32, v32
v_exp_f32 v33, v33
v_exp_f32 v34, v34
v_exp_f32 v35, v35
v_fma_f32 v40, v40, v241, v173
v_fma_f32 v41, v41, v241, v173
s_add_u32 m0, s43, 12288
s_add_u32 s49, s19, 12288
buffer_load_dwordx4 v0, s[4:7], s49 offen offset:0 sc1 lds
v_fma_f32 v42, v42, v241, v173
v_fma_f32 v43, v43, v241, v173
v_exp_f32 v40, v40
v_exp_f32 v41, v41
v_exp_f32 v42, v42
v_exp_f32 v43, v43
v_cvt_pk_bf16_f32 v36, v32, v33
v_cvt_pk_bf16_f32 v37, v34, v35
buffer_load_dwordx4 v0, s[4:7], s49 offen offset:1024 sc1 lds
v_and_b32 v58, v104, v36
v_and_b32 v59, v105, v37
v_bfi_b32 v56, v104, 0, v36
v_bfi_b32 v57, v105, 0, v37
v_cvt_pk_bf16_f32 v44, v40, v41
v_cvt_pk_bf16_f32 v45, v42, v43
v_and_b32 v62, v104, v44
v_and_b32 v63, v105, v45
buffer_load_dwordx4 v0, s[4:7], s49 offen offset:2048 sc1 lds
v_bfi_b32 v60, v104, 0, v44
v_bfi_b32 v61, v105, 0, v45
v_mfma_f32_16x16x32_bf16 v[120:123], v[218:221], v[56:59], 0
s_nop 0
v_mfma_f32_16x16x32_bf16 v[124:127], v[218:221], v[60:63], 0
v_mfma_f32_16x16x32_bf16 v[72:75], v[206:209], v[56:59], 0
v_mfma_f32_16x16x32_bf16 v[76:79], v[212:215], v[60:63], 0
v_add_u32 v196, 20480, v11
s_nop 2
v_mov_b32 v176, v120
s_nop 0
v_mov_b32 v177, v124
v_permlane32_swap_b32 v120, v176
s_nop 0
v_permlane32_swap_b32 v124, v177
v_rcp_f32 v176, v176
v_rcp_f32 v177, v177
v_cndmask_b32 v120, v124, v120, s[56:57]
v_cndmask_b32 v121, v125, v121, s[56:57]
v_cndmask_b32 v122, v126, v122, s[56:57]
v_cndmask_b32 v123, v127, v123, s[56:57]
v_pk_mul_f32 v[72:73], v[72:73], v[176:177] op_sel:[0,0] op_sel_hi:[1,0]
v_pk_mul_f32 v[74:75], v[74:75], v[176:177] op_sel:[0,0] op_sel_hi:[1,0]
v_cvt_pk_bf16_f32 v184, v72, v73
v_cvt_pk_bf16_f32 v185, v74, v75
v_pk_mul_f32 v[76:77], v[76:77], v[176:177] op_sel:[0,1] op_sel_hi:[1,1]
v_pk_mul_f32 v[78:79], v[78:79], v[176:177] op_sel:[0,1] op_sel_hi:[1,1]
v_cvt_pk_bf16_f32 v186, v76, v77
v_cvt_pk_bf16_f32 v187, v78, v79
buffer_store_dwordx4 v[184:187], v1, s[4:7], s37 offen
v_cndmask_b32 v194, v177, v176, s[56:57]
v_pk_mul_f32 v[120:121], v[120:121], v[194:195] op_sel_hi:[1,0]
v_pk_mul_f32 v[122:123], v[122:123], v[194:195] op_sel_hi:[1,0]
v_cvt_pk_bf16_f32 v190, v120, v121
v_cvt_pk_bf16_f32 v191, v122, v123
s_mov_b32 exec_hi, 0
buffer_store_dwordx2 v[190:191], v196, s[4:7], s38 offen
s_mov_b32 exec_hi, -1
s_waitcnt lgkmcnt(0)
s_cmp_eq_u32 s34, 0
s_cbranch_scc1 KX37
KX36:
buffer_load_dwordx4 v[80:83], v0, s[4:7], s55 offen offset:0 sc1
buffer_load_dwordx4 v[84:87], v0, s[4:7], s55 offen offset:1024 sc1
buffer_load_dwordx4 v[128:131], v0, s[4:7], s55 offen offset:2048 sc1
buffer_load_dwordx4 v[132:135], v0, s[4:7], s55 offen offset:3072 sc1
s_waitcnt vmcnt(0)
v_xor_b32 v83, s89, v83
v_xor_b32 v87, s89, v87
v_xor_b32 v131, s89, v131
v_xor_b32 v135, s89, v135
v_or3_b32 v83, v83, v87, v131
v_or_b32 v83, v83, v135
v_cmp_ne_u32 vcc, 0, v83
s_nop 1
s_cmp_eq_u64 vcc, 0
s_cbranch_scc1 KX37a
s_sub_u32 s45, s45, 1
s_cbranch_scc0 KX36
s_mov_b32 s45, 0
KX37a:
v_mov_b32 v152, v80
v_mov_b32 v153, v81
v_mov_b32 v154, v82
v_mov_b32 v155, v84
v_mov_b32 v156, v85
v_mov_b32 v157, v86
v_mov_b32 v204, v128
v_mov_b32 v205, v129
v_mov_b32 v210, v130
v_mov_b32 v211, v132
v_mov_b32 v216, v133
v_mov_b32 v217, v134
s_nop 1
KX37:
v_mfma_f32_16x16x32_bf16 v[16:19], v[152:155], v[136:139], v[96:99]
v_mfma_f32_16x16x32_bf16 v[24:27], v[154:157], v[140:143], v[96:99]
s_nop 6
v_max_f32 v16, v16, v20
v_max_f32 v17, v17, v21
v_max_f32 v18, v18, v22
v_max_f32 v19, v19, v23
v_max_f32 v24, v24, v28
v_max_f32 v25, v25, v29
v_max_f32 v26, v26, v30
v_max_f32 v27, v27, v31
v_max3_f32 v170, v16, v17, v18
v_max3_f32 v171, v24, v25, v26
v_max_f32 v170, v170, v19
v_max_f32 v171, v171, v27
s_nop 1
v_permlane16_swap_b32 v170, v171
v_max_f32 v170, v170, v171
v_mov_b32 v171, v170
s_nop 1
v_permlane32_swap_b32 v170, v171
v_max_f32 v170, v170, v171
v_mul_f32_e64 v170, -v170, v240
v_mov_b32 v171, v170
s_nop 1
v_permlane16_swap_b32 v170, v171
v_fma_f32 v16, v16, v240, v170
v_fma_f32 v17, v17, v240, v170
v_fma_f32 v18, v18, v240, v170
v_fma_f32 v19, v19, v240, v170
v_exp_f32 v16, v16
v_exp_f32 v17, v17
v_exp_f32 v18, v18
v_exp_f32 v19, v19
v_fma_f32 v24, v24, v240, v171
v_fma_f32 v25, v25, v240, v171
v_fma_f32 v26, v26, v240, v171
v_fma_f32 v27, v27, v240, v171
v_exp_f32 v24, v24
v_exp_f32 v25, v25
v_exp_f32 v26, v26
v_exp_f32 v27, v27
v_cvt_pk_bf16_f32 v20, v16, v17
v_cvt_pk_bf16_f32 v21, v18, v19
v_and_b32 v50, v104, v20
v_and_b32 v51, v105, v21
v_bfi_b32 v48, v104, 0, v20
v_bfi_b32 v49, v105, 0, v21
v_cvt_pk_bf16_f32 v28, v24, v25
v_cvt_pk_bf16_f32 v29, v26, v27
v_and_b32 v54, v104, v28
v_and_b32 v55, v105, v29
v_bfi_b32 v52, v104, 0, v28
v_bfi_b32 v53, v105, 0, v29
v_mfma_f32_16x16x32_bf16 v[112:115], v[216:219], v[48:51], 0
s_nop 0
v_mfma_f32_16x16x32_bf16 v[116:119], v[216:219], v[52:55], 0
v_mfma_f32_16x16x32_bf16 v[64:67], v[204:207], v[48:51], 0
v_mfma_f32_16x16x32_bf16 v[68:71], v[210:213], v[52:55], 0
s_nop 3
v_mov_b32 v174, v112
s_nop 0
v_mov_b32 v175, v116
v_permlane32_swap_b32 v112, v174
s_nop 0
v_permlane32_swap_b32 v116, v175
v_rcp_f32 v174, v174
v_rcp_f32 v175, v175
v_cndmask_b32 v112, v116, v112, s[56:57]
v_cndmask_b32 v113, v117, v113, s[56:57]
v_cndmask_b32 v114, v118, v114, s[56:57]
v_cndmask_b32 v115, v119, v115, s[56:57]
v_pk_mul_f32 v[64:65], v[64:65], v[174:175] op_sel:[0,0] op_sel_hi:[1,0]
v_pk_mul_f32 v[66:67], v[66:67], v[174:175] op_sel:[0,0] op_sel_hi:[1,0]
v_cvt_pk_bf16_f32 v180, v64, v65
v_cvt_pk_bf16_f32 v181, v66, v67
v_pk_mul_f32 v[68:69], v[68:69], v[174:175] op_sel:[0,1] op_sel_hi:[1,1]
v_pk_mul_f32 v[70:71], v[70:71], v[174:175] op_sel:[0,1] op_sel_hi:[1,1]
v_cvt_pk_bf16_f32 v182, v68, v69
v_cvt_pk_bf16_f32 v183, v70, v71
buffer_store_dwordx4 v[180:183], v0, s[4:7], s37 offen
v_cndmask_b32 v192, v175, v174, s[56:57]
v_pk_mul_f32 v[112:113], v[112:113], v[192:193] op_sel_hi:[1,0]
v_pk_mul_f32 v[114:115], v[114:115], v[192:193] op_sel_hi:[1,0]
v_cvt_pk_bf16_f32 v188, v112, v113
v_cvt_pk_bf16_f32 v189, v114, v115
s_mov_b32 exec_hi, 0
buffer_store_dwordx2 v[188:189], v11, s[4:7], s38 offen
s_mov_b32 exec_hi, -1
v_add_u32 v16, s85, v0
v_add_u32 v17, s85, v4
v_add_u32 v18, s44, v4
s_waitcnt vmcnt(10)
ds_read_b128 v[128:131], v16 offset:24576
ds_read_b128 v[132:135], v16 offset:25600
ds_read_b128 v[136:139], v16 offset:26624
ds_read_b128 v[140:143], v16 offset:27648
ds_read_b128 v[144:147], v16 offset:40960
ds_read_b128 v[148:151], v16 offset:41984
ds_read_b128 v[152:155], v16 offset:43008
ds_read_b128 v[156:159], v16 offset:44032
ds_read_b128 v[160:163], v16 offset:57344
ds_read_b128 v[164:167], v16 offset:58368
ds_read_b128 v[168:171], v16 offset:59392
ds_read_b128 v[172:175], v16 offset:60416
ds_read_b128 v[176:179], v17 offset:8192
ds_read_b128 v[180:183], v17 offset:9216
ds_read_b128 v[184:187], v17 offset:10240
ds_read_b128 v[188:191], v17 offset:11264
ds_read_b128 v[192:195], v17 offset:24576
ds_read_b128 v[196:199], v17 offset:25600
ds_read_b128 v[200:203], v17 offset:26624
ds_read_b128 v[204:207], v17 offset:27648
ds_read_b128 v[208:211], v17 offset:40960
ds_read_b128 v[212:215], v17 offset:41984
ds_read_b128 v[216:219], v17 offset:43008
ds_read_b128 v[220:223], v17 offset:44032
ds_read_b128 v[224:227], v18 offset:57344
s_add_u32 s48, s12, 1
s_and_b32 s48, s48, 3
s_mul_i32 s48, s48, 15360
s_add_u32 s48, s48, 98304
v_add_u32 v228, s48, v0
s_add_u32 s48, s12, 2
s_and_b32 s48, s48, 3
s_mul_i32 s48, s48, 15360
s_add_u32 s48, s48, 103424
v_add_u32 v229, s48, v0
s_add_u32 s48, s12, 3
s_and_b32 s48, s48, 3
s_mul_i32 s48, s48, 15360
s_add_u32 s48, s48, 108544
v_add_u32 v230, s48, v0
s_mul_i32 s48, s12, 15360
s_add_u32 s48, s48, 98304
v_add_u32 v231, s48, v0
v_lshlrev_b32 v232, 5, v9
v_and_b32 v233, 0x180, v232
s_lshl_b32 s54, s14, 2
s_add_u32 s54, s54, s40
s_add_u32 s54, s54, 8192
s_waitcnt vmcnt(0) lgkmcnt(0)
s_barrier
s_cmp_lg_u32 s12, 0
s_cbranch_scc1 SY38
s_mov_b64 exec, 1
s_cmp_eq_u32 s15, 0
s_cbranch_scc1 SY40
buffer_store_dword v10, off, s[4:7], s54
s_branch SY41
SY40:
buffer_wbl2 sc1
s_waitcnt vmcnt(0)
buffer_store_dword v10, off, s[4:7], s54 sc1
SY41:
s_mov_b64 exec, -1
s_add_u32 s48, s40, 8192
PL42:
buffer_load_dword v18, v9, s[4:7], s48 offen sc1
s_waitcnt vmcnt(0)
v_cmp_ne_u32 vcc, s89, v18
s_nop 1
s_cmp_eq_u64 vcc, 0
s_cbranch_scc1 PL43
s_sub_u32 s45, s45, 1
s_cbranch_scc0 PL42
s_mov_b32 s45, 0
PL43:
s_cmp_lg_u32 s15, 0
s_cbranch_scc1 SY39
buffer_inv sc1
s_waitcnt vmcnt(0)
s_branch SY39
SY38:
SY39:
s_barrier
s_add_u32 s51, s22, 2621440
buffer_load_dwordx4 v[56:59], v0, s[4:7], s51 offen offset:0 sc1
buffer_load_dwordx4 v[60:63], v0, s[4:7], s51 offen offset:1024 sc1
buffer_load_dwordx4 v[64:67], v0, s[4:7], s51 offen offset:2048 sc1
buffer_load_dwordx4 v[68:71], v0, s[4:7], s51 offen offset:3072 sc1
s_add_u32 s51, s22, 2625536
buffer_load_dwordx4 v[72:75], v0, s[4:7], s51 offen offset:0 sc1
s_add_u32 s51, s23, 2621440
buffer_load_dwordx4 v[76:79], v0, s[4:7], s51 offen offset:0 sc1
s_waitcnt vmcnt(5)
v_mfma_f32_16x16x32_bf16 v[16:19], v[128:131], v[56:59], 0
buffer_load_dwordx4 v[80:83], v0, s[4:7], s51 offen offset:1024 sc1
v_mfma_f32_16x16x32_bf16 v[20:23], v[132:135], v[56:59], 0
v_mfma_f32_16x16x32_bf16 v[24:27], v[136:139], v[56:59], 0
v_mfma_f32_16x16x32_bf16 v[28:31], v[140:143], v[56:59], 0
v_mfma_f32_16x16x32_bf16 v[32:35], v[144:147], v[56:59], 0
s_waitcnt vmcnt(5)
v_mfma_f32_16x16x32_bf16 v[16:19], v[148:151], v[60:63], v[16:19]
buffer_load_dwordx4 v[84:87], v0, s[4:7], s51 offen offset:2048 sc1
v_mfma_f32_16x16x32_bf16 v[20:23], v[152:155], v[60:63], v[20:23]
v_mfma_f32_16x16x32_bf16 v[24:27], v[156:159], v[60:63], v[24:27]
v_mfma_f32_16x16x32_bf16 v[28:31], v[160:163], v[60:63], v[28:31]
v_mfma_f32_16x16x32_bf16 v[32:35], v[164:167], v[60:63], v[32:35]
s_waitcnt vmcnt(5)
v_mfma_f32_16x16x32_bf16 v[16:19], v[168:171], v[64:67], v[16:19]
buffer_load_dwordx4 v[88:91], v0, s[4:7], s51 offen offset:3072 sc1
v_mfma_f32_16x16x32_bf16 v[20:23], v[172:175], v[64:67], v[20:23]
s_add_u32 s51, s23, 2625536
v_mfma_f32_16x16x32_bf16 v[24:27], v[176:179], v[64:67], v[24:27]
v_mfma_f32_16x16x32_bf16 v[28:31], v[180:183], v[64:67], v[28:31]
v_mfma_f32_16x16x32_bf16 v[32:35], v[184:187], v[64:67], v[32:35]
s_waitcnt vmcnt(5)
v_mfma_f32_16x16x32_bf16 v[16:19], v[188:191], v[68:71], v[16:19]
buffer_load_dwordx4 v[92:95], v0, s[4:7], s51 offen offset:0 sc1
v_mfma_f32_16x16x32_bf16 v[20:23], v[192:195], v[68:71], v[20:23]
s_add_u32 s51, s24, 2621440
v_mfma_f32_16x16x32_bf16 v[24:27], v[196:199], v[68:71], v[24:27]
v_mfma_f32_16x16x32_bf16 v[28:31], v[200:203], v[68:71], v[28:31]
v_mfma_f32_16x16x32_bf16 v[32:35], v[204:207], v[68:71], v[32:35]
s_waitcnt vmcnt(5)
v_mfma_f32_16x16x32_bf16 v[16:19], v[208:211], v[72:75], v[16:19]
buffer_load_dwordx4 v[96:99], v0, s[4:7], s51 offen offset:0 sc1
v_mfma_f32_16x16x32_bf16 v[20:23], v[212:215], v[72:75], v[20:23]
v_mfma_f32_16x16x32_bf16 v[24:27], v[216:219], v[72:75], v[24:27]
v_mfma_f32_16x16x32_bf16 v[28:31], v[220:223], v[72:75], v[28:31]
v_mfma_f32_16x16x32_bf16 v[32:35], v[224:227], v[72:75], v[32:35]
s_waitcnt vmcnt(5)
v_mfma_f32_16x16x32_bf16 v[36:39], v[128:131], v[76:79], 0
buffer_load_dwordx4 v[100:103], v0, s[4:7], s51 offen offset:1024 sc1
v_mfma_f32_16x16x32_bf16 v[40:43], v[132:135], v[76:79], 0
v_mfma_f32_16x16x32_bf16 v[44:47], v[136:139], v[76:79], 0
v_mfma_f32_16x16x32_bf16 v[48:51], v[140:143], v[76:79], 0
ds_write_b128 v228, v[16:19] offset:0
v_mfma_f32_16x16x32_bf16 v[52:55], v[144:147], v[76:79], 0
s_waitcnt vmcnt(5)
v_mfma_f32_16x16x32_bf16 v[36:39], v[148:151], v[80:83], v[36:39]
buffer_load_dwordx4 v[104:107], v0, s[4:7], s51 offen offset:2048 sc1
v_mfma_f32_16x16x32_bf16 v[40:43], v[152:155], v[80:83], v[40:43]
ds_write_b128 v228, v[20:23] offset:1024
v_mfma_f32_16x16x32_bf16 v[44:47], v[156:159], v[80:83], v[44:47]
ds_write_b128 v228, v[24:27] offset:2048
v_mfma_f32_16x16x32_bf16 v[48:51], v[160:163], v[80:83], v[48:51]
ds_write_b128 v228, v[28:31] offset:3072
v_mfma_f32_16x16x32_bf16 v[52:55], v[164:167], v[80:83], v[52:55]
s_waitcnt vmcnt(5)
v_mfma_f32_16x16x32_bf16 v[36:39], v[168:171], v[84:87], v[36:39]
buffer_load_dwordx4 v[108:111], v0, s[4:7], s51 offen offset:3072 sc1
v_mfma_f32_16x16x32_bf16 v[40:43], v[172:175], v[84:87], v[40:43]
s_add_u32 s51, s24, 2625536
v_mfma_f32_16x16x32_bf16 v[44:47], v[176:179], v[84:87], v[44:47]
ds_write_b128 v228, v[32:35] offset:4096
v_mfma_f32_16x16x32_bf16 v[48:51], v[180:183], v[84:87], v[48:51]
v_mfma_f32_16x16x32_bf16 v[52:55], v[184:187], v[84:87], v[52:55]
s_waitcnt vmcnt(5)
v_mfma_f32_16x16x32_bf16 v[36:39], v[188:191], v[88:91], v[36:39]
buffer_load_dwordx4 v[112:115], v0, s[4:7], s51 offen offset:0 sc1
v_mfma_f32_16x16x32_bf16 v[40:43], v[192:195], v[88:91], v[40:43]
s_add_u32 s51, s25, 2621440
v_mfma_f32_16x16x32_bf16 v[44:47], v[196:199], v[88:91], v[44:47]
v_mfma_f32_16x16x32_bf16 v[48:51], v[200:203], v[88:91], v[48:51]
v_mfma_f32_16x16x32_bf16 v[52:55], v[204:207], v[88:91], v[52:55]
s_waitcnt vmcnt(5)
v_mfma_f32_16x16x32_bf16 v[36:39], v[208:211], v[92:95], v[36:39]
buffer_load_dwordx4 v[116:119], v0, s[4:7], s51 offen offset:0 sc1
v_mfma_f32_16x16x32_bf16 v[40:43], v[212:215], v[92:95], v[40:43]
v_mfma_f32_16x16x32_bf16 v[44:47], v[216:219], v[92:95], v[44:47]
v_mfma_f32_16x16x32_bf16 v[48:51], v[220:223], v[92:95], v[48:51]
v_mfma_f32_16x16x32_bf16 v[52:55], v[224:227], v[92:95], v[52:55]
s_waitcnt vmcnt(5)
v_mfma_f32_16x16x32_bf16 v[16:19], v[128:131], v[96:99], 0
buffer_load_dwordx4 v[120:123], v0, s[4:7], s51 offen offset:1024 sc1
v_mfma_f32_16x16x32_bf16 v[20:23], v[132:135], v[96:99], 0
v_mfma_f32_16x16x32_bf16 v[24:27], v[136:139], v[96:99], 0
v_mfma_f32_16x16x32_bf16 v[28:31], v[140:143], v[96:99], 0
ds_write_b128 v229, v[36:39] offset:0
v_mfma_f32_16x16x32_bf16 v[32:35], v[144:147], v[96:99], 0
s_waitcnt vmcnt(5)
v_mfma_f32_16x16x32_bf16 v[16:19], v[148:151], v[100:103], v[16:19]
buffer_load_dwordx4 v[124:127], v0, s[4:7], s51 offen offset:2048 sc1
v_mfma_f32_16x16x32_bf16 v[20:23], v[152:155], v[100:103], v[20:23]
ds_write_b128 v229, v[40:43] offset:1024
v_mfma_f32_16x16x32_bf16 v[24:27], v[156:159], v[100:103], v[24:27]
ds_write_b128 v229, v[44:47] offset:2048
v_mfma_f32_16x16x32_bf16 v[28:31], v[160:163], v[100:103], v[28:31]
ds_write_b128 v229, v[48:51] offset:3072
v_mfma_f32_16x16x32_bf16 v[32:35], v[164:167], v[100:103], v[32:35]
s_waitcnt vmcnt(5)
v_mfma_f32_16x16x32_bf16 v[16:19], v[168:171], v[104:107], v[16:19]
buffer_load_dwordx4 v[56:59], v0, s[4:7], s51 offen offset:3072 sc1
v_mfma_f32_16x16x32_bf16 v[20:23], v[172:175], v[104:107], v[20:23]
s_add_u32 s51, s25, 2625536
v_mfma_f32_16x16x32_bf16 v[24:27], v[176:179], v[104:107], v[24:27]
ds_write_b128 v229, v[52:55] offset:4096
v_mfma_f32_16x16x32_bf16 v[28:31], v[180:183], v[104:107], v[28:31]
v_lshlrev_b32 v36, 16, v246
v_and_b32 v37, 0xffff0000, v246
v_mfma_f32_16x16x32_bf16 v[32:35], v[184:187], v[104:107], v[32:35]
v_lshlrev_b32 v38, 16, v247
s_waitcnt vmcnt(5)
v_mfma_f32_16x16x32_bf16 v[16:19], v[188:191], v[108:111], v[16:19]
buffer_load_dwordx4 v[60:63], v0, s[4:7], s51 offen offset:0 sc1
v_mfma_f32_16x16x32_bf16 v[20:23], v[192:195], v[108:111], v[20:23]
v_and_b32 v39, 0xffff0000, v247
v_lshlrev_b32 v40, 16, v248
v_mfma_f32_16x16x32_bf16 v[24:27], v[196:199], v[108:111], v[24:27]
v_and_b32 v41, 0xffff0000, v248
v_lshlrev_b32 v42, 16, v249
v_mfma_f32_16x16x32_bf16 v[28:31], v[200:203], v[108:111], v[28:31]
v_and_b32 v43, 0xffff0000, v249
v_lshlrev_b32 v44, 16, v250
v_mfma_f32_16x16x32_bf16 v[32:35], v[204:207], v[108:111], v[32:35]
v_and_b32 v45, 0xffff0000, v250
v_lshlrev_b32 v46, 16, v251
s_waitcnt vmcnt(5)
v_mfma_f32_16x16x32_bf16 v[16:19], v[208:211], v[112:115], v[16:19]
buffer_load_dword v3, v232, s[4:7], s30 offen
v_mfma_f32_16x16x32_bf16 v[20:23], v[212:215], v[112:115], v[20:23]
v_and_b32 v47, 0xffff0000, v251
v_lshlrev_b32 v48, 16, v252
v_and_b32 v49, 0xffff0000, v252
v_lshlrev_b32 v50, 16, v253
v_mfma_f32_16x16x32_bf16 v[24:27], v[216:219], v[112:115], v[24:27]
buffer_load_dword v14, v233, s[4:7], s31 offen
v_and_b32 v51, 0xffff0000, v253
v_lshlrev_b32 v52, 16, v254
v_mfma_f32_16x16x32_bf16 v[28:31], v[220:223], v[112:115], v[28:31]
v_and_b32 v53, 0xffff0000, v254
v_lshlrev_b32 v54, 16, v255
v_and_b32 v55, 0xffff0000, v255
v_mfma_f32_16x16x32_bf16 v[32:35], v[224:227], v[112:115], v[32:35]
s_add_u32 s53, s32, 21102592
buffer_load_dword v234, off, s[4:7], s53
s_waitcnt vmcnt(7)
v_mfma_f32_16x16x32_bf16 v[36:39], v[128:131], v[116:119], v[36:39]
s_add_u32 m0, s43, 24576
s_add_u32 s49, s19, 24576
v_mfma_f32_16x16x32_bf16 v[40:43], v[132:135], v[116:119], v[40:43]
buffer_load_dwordx4 v0, s[4:7], s49 offen offset:0 sc1 lds
v_mfma_f32_16x16x32_bf16 v[44:47], v[136:139], v[116:119], v[44:47]
v_mfma_f32_16x16x32_bf16 v[48:51], v[140:143], v[116:119], v[48:51]
buffer_load_dwordx4 v0, s[4:7], s49 offen offset:1024 sc1 lds
v_mfma_f32_16x16x32_bf16 v[52:55], v[144:147], v[116:119], v[52:55]
s_waitcnt vmcnt(8)
v_mfma_f32_16x16x32_bf16 v[36:39], v[148:151], v[120:123], v[36:39]
buffer_load_dwordx4 v0, s[4:7], s49 offen offset:2048 sc1 lds
v_mfma_f32_16x16x32_bf16 v[40:43], v[152:155], v[120:123], v[40:43]
s_add_u32 m0, s43, 36864
s_add_u32 s49, s19, 36864
v_mfma_f32_16x16x32_bf16 v[44:47], v[156:159], v[120:123], v[44:47]
buffer_load_dwordx4 v0, s[4:7], s49 offen offset:0 sc1 lds
v_mfma_f32_16x16x32_bf16 v[48:51], v[160:163], v[120:123], v[48:51]
ds_write_b128 v230, v[16:19] offset:0
v_mfma_f32_16x16x32_bf16 v[52:55], v[164:167], v[120:123], v[52:55]
buffer_load_dwordx4 v0, s[4:7], s49 offen offset:1024 sc1 lds
s_waitcnt vmcnt(10)
v_mfma_f32_16x16x32_bf16 v[36:39], v[168:171], v[124:127], v[36:39]
ds_write_b128 v230, v[20:23] offset:1024
ds_write_b128 v230, v[24:27] offset:2048
v_mfma_f32_16x16x32_bf16 v[40:43], v[172:175], v[124:127], v[40:43]
buffer_load_dwordx4 v0, s[4:7], s49 offen offset:2048 sc1 lds
v_mfma_f32_16x16x32_bf16 v[44:47], v[176:179], v[124:127], v[44:47]
s_add_u32 m0, s43, 49152
s_add_u32 s49, s19, 49152
ds_write_b128 v230, v[28:31] offset:3072
ds_write_b128 v230, v[32:35] offset:4096
v_mfma_f32_16x16x32_bf16 v[48:51], v[180:183], v[124:127], v[48:51]
buffer_load_dwordx4 v0, s[4:7], s49 offen offset:0 sc1 lds
s_waitcnt lgkmcnt(0)
s_barrier
v_mfma_f32_16x16x32_bf16 v[52:55], v[184:187], v[124:127], v[52:55]
ds_read_b128 v[64:67], v231 offset:0
s_waitcnt vmcnt(11)
v_mfma_f32_16x16x32_bf16 v[36:39], v[188:191], v[56:59], v[36:39]
buffer_load_dwordx4 v0, s[4:7], s49 offen offset:1024 sc1 lds
v_mfma_f32_16x16x32_bf16 v[40:43], v[192:195], v[56:59], v[40:43]
ds_read_b128 v[84:87], v231 offset:5120
ds_read_b128 v[16:19], v231 offset:10240
v_mfma_f32_16x16x32_bf16 v[44:47], v[196:199], v[56:59], v[44:47]
buffer_load_dwordx4 v0, s[4:7], s49 offen offset:2048 sc1 lds
v_mfma_f32_16x16x32_bf16 v[48:51], v[200:203], v[56:59], v[48:51]
ds_read_b128 v[68:71], v231 offset:1024
ds_read_b128 v[88:91], v231 offset:6144
v_mfma_f32_16x16x32_bf16 v[52:55], v[204:207], v[56:59], v[52:55]
ds_read_b128 v[20:23], v231 offset:11264
s_waitcnt vmcnt(12)
v_mfma_f32_16x16x32_bf16 v[36:39], v[208:211], v[60:63], v[36:39]
ds_read_b128 v[72:75], v231 offset:2048
ds_read_b128 v[92:95], v231 offset:7168
v_mfma_f32_16x16x32_bf16 v[40:43], v[212:215], v[60:63], v[40:43]
ds_read_b128 v[24:27], v231 offset:12288
ds_read_b128 v[76:79], v231 offset:3072
v_mfma_f32_16x16x32_bf16 v[44:47], v[216:219], v[60:63], v[44:47]
ds_read_b128 v[96:99], v231 offset:8192
ds_read_b128 v[28:31], v231 offset:13312
v_mfma_f32_16x16x32_bf16 v[48:51], v[220:223], v[60:63], v[48:51]
ds_read_b128 v[80:83], v231 offset:4096
ds_read_b128 v[100:103], v231 offset:9216
v_mfma_f32_16x16x32_bf16 v[52:55], v[224:227], v[60:63], v[52:55]
ds_read_b128 v[32:35], v231 offset:14336
s_waitcnt lgkmcnt(13)
v_add_f32 v64, v64, v84
v_add_f32 v65, v65, v85
v_add_f32 v66, v66, v86
v_add_f32 v67, v67, v87
s_waitcnt lgkmcnt(10)
v_add_f32 v68, v68, v88
v_add_f32 v69, v69, v89
v_add_f32 v70, v70, v90
v_add_f32 v71, v71, v91
s_waitcnt lgkmcnt(7)
v_add_f32 v72, v72, v92
v_add_f32 v73, v73, v93
v_add_f32 v74, v74, v94
v_add_f32 v75, v75, v95
s_waitcnt lgkmcnt(4)
v_add_f32 v76, v76, v96
v_add_f32 v77, v77, v97
v_add_f32 v78, v78, v98
v_add_f32 v79, v79, v99
s_waitcnt lgkmcnt(1)
v_add_f32 v80, v80, v100
v_add_f32 v81, v81, v101
v_add_f32 v82, v82, v102
v_add_f32 v83, v83, v103
v_add_f32 v64, v64, v16
v_add_f32 v65, v65, v17
v_add_f32 v66, v66, v18
v_add_f32 v67, v67, v19
v_add_f32 v68, v68, v20
v_add_f32 v69, v69, v21
v_add_f32 v70, v70, v22
v_add_f32 v71, v71, v23
v_add_f32 v72, v72, v24
v_add_f32 v73, v73, v25
v_add_f32 v74, v74, v26
v_add_f32 v75, v75, v27
v_add_f32 v76, v76, v28
v_add_f32 v77, v77, v29
v_add_f32 v78, v78, v30
v_add_f32 v79, v79, v31
s_waitcnt lgkmcnt(0)
v_add_f32 v80, v80, v32
v_add_f32 v81, v81, v33
v_add_f32 v82, v82, v34
v_add_f32 v83, v83, v35
v_mov_b32 v24, 0x3f803f80
v_pk_add_f32 v[36:37], v[36:37], v[64:65]
v_pk_add_f32 v[38:39], v[38:39], v[66:67]
v_cvt_pk_bf16_f32 v246, v36, v37
v_cvt_pk_bf16_f32 v247, v38, v39
v_pk_add_f32 v[40:41], v[40:41], v[68:69]
v_pk_add_f32 v[42:43], v[42:43], v[70:71]
v_cvt_pk_bf16_f32 v248, v40, v41
v_cvt_pk_bf16_f32 v249, v42, v43
buffer_store_dwordx4 v[246:249], v0, s[4:7], s30 offen
v_pk_add_f32 v[44:45], v[44:45], v[72:73]
v_pk_add_f32 v[46:47], v[46:47], v[74:75]
v_cvt_pk_bf16_f32 v250, v44, v45
v_cvt_pk_bf16_f32 v251, v46, v47
v_pk_add_f32 v[48:49], v[48:49], v[76:77]
v_pk_add_f32 v[50:51], v[50:51], v[78:79]
v_cvt_pk_bf16_f32 v252, v48, v49
v_cvt_pk_bf16_f32 v253, v50, v51
buffer_store_dwordx4 v[250:253], v0, s[4:7], s30 offen offset:1024
v_pk_add_f32 v[52:53], v[52:53], v[80:81]
v_pk_add_f32 v[54:55], v[54:55], v[82:83]
v_cvt_pk_bf16_f32 v254, v52, v53
v_cvt_pk_bf16_f32 v255, v54, v55
buffer_store_dwordx2 v[254:255], v11, s[4:7], s31 offen
v_dot2_f32_bf16 v16, v246, v24, 0
v_dot2_f32_bf16 v17, v246, v246, 0
v_dot2_f32_bf16 v18, v247, v24, 0
v_dot2_f32_bf16 v19, v247, v247, 0
v_dot2_f32_bf16 v20, v248, v24, 0
v_dot2_f32_bf16 v21, v248, v248, 0
v_dot2_f32_bf16 v22, v249, v24, 0
v_dot2_f32_bf16 v23, v249, v249, 0
v_dot2_f32_bf16 v16, v250, v24, v16
v_dot2_f32_bf16 v17, v250, v250, v17
v_dot2_f32_bf16 v18, v251, v24, v18
v_dot2_f32_bf16 v19, v251, v251, v19
v_dot2_f32_bf16 v20, v252, v24, v20
v_dot2_f32_bf16 v21, v252, v252, v21
v_dot2_f32_bf16 v22, v253, v24, v22
v_dot2_f32_bf16 v23, v253, v253, v23
v_dot2_f32_bf16 v16, v254, v24, v16
v_dot2_f32_bf16 v17, v254, v254, v17
v_dot2_f32_bf16 v18, v255, v24, v18
v_dot2_f32_bf16 v19, v255, v255, v19
v_pk_add_f32 v[20:21], v[20:21], v[22:23]
s_nop 1
v_pk_add_f32 v[16:17], v[16:17], v[18:19]
v_pk_add_f32 v[16:17], v[16:17], v[20:21]
s_nop 1
v_permlane16_swap_b32 v16, v17
v_add_f32 v16, v16, v17
v_mov_b32 v17, v16
s_nop 1
v_permlane32_swap_b32 v16, v17
v_add_f32 v16, v16, v17
v_mov_b32 v17, v16
s_nop 1
v_permlane16_swap_b32 v16, v17
s_mov_b32 exec_lo, 0xffff
s_mov_b32 exec_hi, 0
buffer_store_dwordx2 v[16:17], v13, s[4:7], s53 offen
s_mov_b64 exec, -1
s_waitcnt vmcnt(13)
s_cmp_eq_u32 s12, 0
s_cbranch_scc1 SY44
s_add_u32 m0, s78, 61440
s_add_u32 s49, s36, 61440
buffer_load_dwordx4 v0, s[4:7], s49 offen offset:0 sc1 lds
buffer_load_dwordx4 v0, s[4:7], s49 offen offset:1024 sc1 lds
buffer_load_dwordx4 v0, s[4:7], s49 offen offset:2048 sc1 lds
buffer_load_dwordx4 v0, s[4:7], s49 offen offset:3072 sc1 lds
SY44:
v_lshrrev_b32 v232, 9, v0
v_mul_u32_u24 v229, 49152, v232
v_lshrrev_b32 v232, 8, v0
v_lshlrev_b32 v232, 4, v232
v_add_u32 v232, 160256, v232
v_and_b32 v233, 0x1f0, v0
v_min_u32 v233, 368, v233
v_lshl_add_u32 v229, v233, 3, v229
s_lshl_b32 s54, s14, 2
s_add_u32 s54, s54, s40
s_add_u32 s54, s54, 10240
s_cmp_lg_u32 s12, 0
s_cbranch_scc1 SY45
s_waitcnt vmcnt(0)
SY45:
s_waitcnt vmcnt(4)
s_barrier
s_cmp_lg_u32 s12, 0
s_cbranch_scc1 SY46
s_mov_b64 exec, 1
s_cmp_eq_u32 s15, 0
s_cbranch_scc1 SY48
buffer_store_dword v10, off, s[4:7], s54
s_branch SY49
SY48:
buffer_wbl2 sc1
s_waitcnt vmcnt(0)
buffer_store_dword v10, off, s[4:7], s54 sc1
SY49:
s_mov_b64 exec, -1
s_add_u32 s48, s40, 10240
PL50:
buffer_load_dword v18, v9, s[4:7], s48 offen sc1
s_waitcnt vmcnt(0)
v_cmp_ne_u32 vcc, s89, v18
s_nop 1
s_cmp_eq_u64 vcc, 0
s_cbranch_scc1 PL51
s_sub_u32 s45, s45, 1
s_cbranch_scc0 PL50
s_mov_b32 s45, 0
PL51:
s_cmp_lg_u32 s15, 0
s_cbranch_scc1 SY47
buffer_inv sc1
s_waitcnt vmcnt(0)
s_branch SY47
SY46:
SY47:
s_barrier
s_add_u32 s51, s16, 0
buffer_load_dwordx4 v[112:115], v0, s[4:7], s51 offen offset:0 sc1
buffer_load_dwordx4 v[116:119], v1, s[4:7], s51 offen offset:0 sc1
buffer_load_dwordx4 v[120:123], v0, s[4:7], s51 offen offset:1024 sc1
buffer_load_dwordx4 v[124:127], v1, s[4:7], s51 offen offset:1024 sc1
s_barrier
ds_read_b128 v[160:163], v0 offset:0
ds_read_b128 v[164:167], v0 offset:1024
ds_read_b128 v[168:171], v0 offset:2048
ds_read_b128 v[172:175], v0 offset:3072
ds_read_b128 v[176:179], v0 offset:4096
ds_read_b128 v[180:183], v0 offset:5120
s_waitcnt lgkmcnt(4)
s_waitcnt vmcnt(3)
v_mfma_f32_16x16x32_bf16 v[16:19], v[160:163], v[112:115], 0
buffer_load_dwordx4 v[128:131], v0, s[4:7], s51 offen offset:2048 sc1
s_waitcnt vmcnt(3)
v_mfma_f32_16x16x32_bf16 v[20:23], v[160:163], v[116:119], 0
ds_read_b128 v[184:187], v0 offset:6144
ds_read_b128 v[188:191], v0 offset:7168
v_mfma_f32_16x16x32_bf16 v[24:27], v[164:167], v[112:115], 0
ds_read_b128 v[160:163], v0 offset:8192
v_mfma_f32_16x16x32_bf16 v[28:31], v[164:167], v[116:119], 0
s_waitcnt lgkmcnt(5)
v_mfma_f32_16x16x32_bf16 v[32:35], v[168:171], v[112:115], 0
ds_read_b128 v[164:167], v0 offset:9216
v_mfma_f32_16x16x32_bf16 v[36:39], v[168:171], v[116:119], 0
buffer_load_dwordx4 v[132:135], v1, s[4:7], s51 offen offset:2048 sc1
v_mfma_f32_16x16x32_bf16 v[40:43], v[172:175], v[112:115], 0
ds_read_b128 v[168:171], v0 offset:10240
v_mfma_f32_16x16x32_bf16 v[44:47], v[172:175], v[116:119], 0
s_waitcnt lgkmcnt(5)
v_mfma_f32_16x16x32_bf16 v[48:51], v[176:179], v[112:115], 0
ds_read_b128 v[172:175], v0 offset:11264
v_mfma_f32_16x16x32_bf16 v[52:55], v[176:179], v[116:119], 0
buffer_load_dwordx4 v[136:139], v0, s[4:7], s51 offen offset:3072 sc1
v_mfma_f32_16x16x32_bf16 v[56:59], v[180:183], v[112:115], 0
ds_read_b128 v[176:179], v0 offset:12288
v_mfma_f32_16x16x32_bf16 v[60:63], v[180:183], v[116:119], 0
s_waitcnt lgkmcnt(5)
v_mfma_f32_16x16x32_bf16 v[64:67], v[184:187], v[112:115], 0
ds_read_b128 v[180:183], v0 offset:13312
v_mfma_f32_16x16x32_bf16 v[68:71], v[184:187], v[116:119], 0
v_mfma_f32_16x16x32_bf16 v[72:75], v[188:191], v[112:115], 0
buffer_load_dwordx4 v[140:143], v1, s[4:7], s51 offen offset:3072 sc1
v_mfma_f32_16x16x32_bf16 v[76:79], v[188:191], v[116:119], 0
s_add_u32 s51, s16, 4096
s_waitcnt lgkmcnt(4)
v_mfma_f32_16x16x32_bf16 v[80:83], v[160:163], v[112:115], 0
ds_read_b128 v[184:187], v0 offset:14336
ds_read_b128 v[188:191], v0 offset:15360
v_mfma_f32_16x16x32_bf16 v[84:87], v[160:163], v[116:119], 0
v_mfma_f32_16x16x32_bf16 v[88:91], v[164:167], v[112:115], 0
buffer_load_dwordx4 v[144:147], v0, s[4:7], s51 offen offset:0 sc1
v_mfma_f32_16x16x32_bf16 v[92:95], v[164:167], v[116:119], 0
ds_read_b128 v[160:163], v0 offset:16384
s_waitcnt lgkmcnt(5)
v_mfma_f32_16x16x32_bf16 v[96:99], v[168:171], v[112:115], 0
ds_read_b128 v[164:167], v0 offset:17408
v_mfma_f32_16x16x32_bf16 v[100:103], v[168:171], v[116:119], 0
v_mfma_f32_16x16x32_bf16 v[104:107], v[172:175], v[112:115], 0
ds_read_b128 v[168:171], v0 offset:18432
v_mfma_f32_16x16x32_bf16 v[108:111], v[172:175], v[116:119], 0
s_waitcnt lgkmcnt(5)
s_waitcnt vmcnt(6)
v_mfma_f32_16x16x32_bf16 v[16:19], v[176:179], v[120:123], v[16:19]
buffer_load_dwordx4 v[148:151], v1, s[4:7], s51 offen offset:0 sc1
s_waitcnt vmcnt(6)
v_mfma_f32_16x16x32_bf16 v[20:23], v[176:179], v[124:127], v[20:23]
ds_read_b128 v[172:175], v0 offset:19456
v_mfma_f32_16x16x32_bf16 v[24:27], v[180:183], v[120:123], v[24:27]
ds_read_b128 v[176:179], v0 offset:20480
v_mfma_f32_16x16x32_bf16 v[28:31], v[180:183], v[124:127], v[28:31]
s_waitcnt lgkmcnt(5)
v_mfma_f32_16x16x32_bf16 v[32:35], v[184:187], v[120:123], v[32:35]
buffer_load_dwordx4 v[152:155], v0, s[4:7], s51 offen offset:1024 sc1
v_mfma_f32_16x16x32_bf16 v[36:39], v[184:187], v[124:127], v[36:39]
ds_read_b128 v[180:183], v0 offset:21504
v_mfma_f32_16x16x32_bf16 v[40:43], v[188:191], v[120:123], v[40:43]
ds_read_b128 v[184:187], v0 offset:22528
v_mfma_f32_16x16x32_bf16 v[44:47], v[188:191], v[124:127], v[44:47]
s_waitcnt lgkmcnt(5)
v_mfma_f32_16x16x32_bf16 v[48:51], v[160:163], v[120:123], v[48:51]
buffer_load_dwordx4 v[156:159], v1, s[4:7], s51 offen offset:1024 sc1
v_mfma_f32_16x16x32_bf16 v[52:55], v[160:163], v[124:127], v[52:55]
s_add_u32 m0, s43, 73728
s_add_u32 s49, s19, 73728
v_mfma_f32_16x16x32_bf16 v[56:59], v[164:167], v[120:123], v[56:59]
ds_read_b128 v[188:191], v0 offset:23552
v_mfma_f32_16x16x32_bf16 v[60:63], v[164:167], v[124:127], v[60:63]
s_waitcnt lgkmcnt(4)
v_mfma_f32_16x16x32_bf16 v[64:67], v[168:171], v[120:123], v[64:67]
s_barrier
v_mfma_f32_16x16x32_bf16 v[68:71], v[168:171], v[124:127], v[68:71]
buffer_load_dwordx4 v0, s[4:7], s49 offen offset:0 sc1 lds
v_mfma_f32_16x16x32_bf16 v[72:75], v[172:175], v[120:123], v[72:75]
ds_read_b128 v[160:163], v0 offset:24576
ds_read_b128 v[164:167], v0 offset:25600
v_mfma_f32_16x16x32_bf16 v[76:79], v[172:175], v[124:127], v[76:79]
ds_read_b128 v[168:171], v0 offset:26624
s_waitcnt lgkmcnt(5)
v_mfma_f32_16x16x32_bf16 v[80:83], v[176:179], v[120:123], v[80:83]
ds_read_b128 v[172:175], v0 offset:27648
v_mfma_f32_16x16x32_bf16 v[84:87], v[176:179], v[124:127], v[84:87]
buffer_load_dwordx4 v0, s[4:7], s49 offen offset:1024 sc1 lds
v_mfma_f32_16x16x32_bf16 v[88:91], v[180:183], v[120:123], v[88:91]
ds_read_b128 v[176:179], v0 offset:28672
v_mfma_f32_16x16x32_bf16 v[92:95], v[180:183], v[124:127], v[92:95]
s_waitcnt lgkmcnt(5)
v_mfma_f32_16x16x32_bf16 v[96:99], v[184:187], v[120:123], v[96:99]
ds_read_b128 v[180:183], v0 offset:29696
v_mfma_f32_16x16x32_bf16 v[100:103], v[184:187], v[124:127], v[100:103]
buffer_load_dwordx4 v0, s[4:7], s49 offen offset:2048 sc1 lds
v_mfma_f32_16x16x32_bf16 v[104:107], v[188:191], v[120:123], v[104:107]
s_add_u32 m0, s43, 86016
s_add_u32 s49, s19, 86016
v_mfma_f32_16x16x32_bf16 v[108:111], v[188:191], v[124:127], v[108:111]
ds_read_b128 v[184:187], v0 offset:30720
s_waitcnt lgkmcnt(5)
s_waitcnt vmcnt(10)
v_mfma_f32_16x16x32_bf16 v[16:19], v[160:163], v[128:131], v[16:19]
ds_read_b128 v[188:191], v0 offset:31744
s_waitcnt vmcnt(9)
v_mfma_f32_16x16x32_bf16 v[20:23], v[160:163], v[132:135], v[20:23]
v_mfma_f32_16x16x32_bf16 v[24:27], v[164:167], v[128:131], v[24:27]
buffer_load_dwordx4 v0, s[4:7], s49 offen offset:0 sc1 lds
v_mfma_f32_16x16x32_bf16 v[28:31], v[164:167], v[132:135], v[28:31]
ds_read_b128 v[160:163], v0 offset:32768
s_waitcnt lgkmcnt(5)
v_mfma_f32_16x16x32_bf16 v[32:35], v[168:171], v[128:131], v[32:35]
ds_read_b128 v[164:167], v0 offset:33792
v_mfma_f32_16x16x32_bf16 v[36:39], v[168:171], v[132:135], v[36:39]
v_mfma_f32_16x16x32_bf16 v[40:43], v[172:175], v[128:131], v[40:43]
buffer_load_dwordx4 v0, s[4:7], s49 offen offset:1024 sc1 lds
v_mfma_f32_16x16x32_bf16 v[44:47], v[172:175], v[132:135], v[44:47]
ds_read_b128 v[168:171], v0 offset:34816
s_waitcnt lgkmcnt(5)
v_mfma_f32_16x16x32_bf16 v[48:51], v[176:179], v[128:131], v[48:51]
ds_read_b128 v[172:175], v0 offset:35840
v_mfma_f32_16x16x32_bf16 v[52:55], v[176:179], v[132:135], v[52:55]
v_mfma_f32_16x16x32_bf16 v[56:59], v[180:183], v[128:131], v[56:59]
ds_read_b128 v[176:179], v0 offset:36864
v_mfma_f32_16x16x32_bf16 v[60:63], v[180:183], v[132:135], v[60:63]
s_waitcnt lgkmcnt(5)
v_mfma_f32_16x16x32_bf16 v[64:67], v[184:187], v[128:131], v[64:67]
buffer_load_dwordx4 v0, s[4:7], s49 offen offset:2048 sc1 lds
v_mfma_f32_16x16x32_bf16 v[68:71], v[184:187], v[132:135], v[68:71]
ds_read_b128 v[180:183], v0 offset:37888
v_mfma_f32_16x16x32_bf16 v[72:75], v[188:191], v[128:131], v[72:75]
ds_read_b128 v[184:187], v0 offset:38912
v_mfma_f32_16x16x32_bf16 v[76:79], v[188:191], v[132:135], v[76:79]
s_waitcnt lgkmcnt(5)
v_mfma_f32_16x16x32_bf16 v[80:83], v[160:163], v[128:131], v[80:83]
buffer_load_dwordx4 v[192:195], v0, s[4:7], s51 offen offset:2048 sc1
v_mfma_f32_16x16x32_bf16 v[84:87], v[160:163], v[132:135], v[84:87]
ds_read_b128 v[188:191], v0 offset:39936
v_mfma_f32_16x16x32_bf16 v[88:91], v[164:167], v[128:131], v[88:91]
ds_read_b128 v[160:163], v0 offset:40960
v_mfma_f32_16x16x32_bf16 v[92:95], v[164:167], v[132:135], v[92:95]
s_waitcnt lgkmcnt(5)
v_mfma_f32_16x16x32_bf16 v[96:99], v[168:171], v[128:131], v[96:99]
buffer_load_dwordx4 v[196:199], v1, s[4:7], s51 offen offset:2048 sc1
v_mfma_f32_16x16x32_bf16 v[100:103], v[168:171], v[132:135], v[100:103]
ds_read_b128 v[164:167], v0 offset:41984
v_mfma_f32_16x16x32_bf16 v[104:107], v[172:175], v[128:131], v[104:107]
ds_read_b128 v[168:171], v0 offset:43008
v_mfma_f32_16x16x32_bf16 v[108:111], v[172:175], v[132:135], v[108:111]
s_waitcnt lgkmcnt(5)
s_waitcnt vmcnt(13)
v_mfma_f32_16x16x32_bf16 v[16:19], v[176:179], v[136:139], v[16:19]
buffer_load_dwordx4 v[200:203], v0, s[4:7], s51 offen offset:3072 sc1
s_waitcnt vmcnt(13)
v_mfma_f32_16x16x32_bf16 v[20:23], v[176:179], v[140:143], v[20:23]
ds_read_b128 v[172:175], v0 offset:44032
v_mfma_f32_16x16x32_bf16 v[24:27], v[180:183], v[136:139], v[24:27]
ds_read_b128 v[176:179], v0 offset:45056
v_mfma_f32_16x16x32_bf16 v[28:31], v[180:183], v[140:143], v[28:31]
s_waitcnt lgkmcnt(5)
v_mfma_f32_16x16x32_bf16 v[32:35], v[184:187], v[136:139], v[32:35]
ds_read_b128 v[180:183], v0 offset:46080
v_mfma_f32_16x16x32_bf16 v[36:39], v[184:187], v[140:143], v[36:39]
buffer_load_dwordx4 v[204:207], v1, s[4:7], s51 offen offset:3072 sc1
v_mfma_f32_16x16x32_bf16 v[40:43], v[188:191], v[136:139], v[40:43]
s_add_u32 m0, s43, 98304
s_add_u32 s49, s19, 98304
v_mfma_f32_16x16x32_bf16 v[44:47], v[188:191], v[140:143], v[44:47]
ds_read_b128 v[184:187], v0 offset:47104
s_waitcnt lgkmcnt(5)
v_mfma_f32_16x16x32_bf16 v[48:51], v[160:163], v[136:139], v[48:51]
ds_read_b128 v[188:191], v0 offset:48128
v_mfma_f32_16x16x32_bf16 v[52:55], v[160:163], v[140:143], v[52:55]
buffer_load_dwordx4 v0, s[4:7], s49 offen offset:0 sc1 lds
v_mfma_f32_16x16x32_bf16 v[56:59], v[164:167], v[136:139], v[56:59]
v_mfma_f32_16x16x32_bf16 v[60:63], v[164:167], v[140:143], v[60:63]
s_waitcnt lgkmcnt(4)
v_mfma_f32_16x16x32_bf16 v[64:67], v[168:171], v[136:139], v[64:67]
s_barrier
v_mfma_f32_16x16x32_bf16 v[68:71], v[168:171], v[140:143], v[68:71]
ds_read_b128 v[160:163], v0 offset:49152
ds_read_b128 v[164:167], v0 offset:50176
v_mfma_f32_16x16x32_bf16 v[72:75], v[172:175], v[136:139], v[72:75]
buffer_load_dwordx4 v0, s[4:7], s49 offen offset:1024 sc1 lds
v_mfma_f32_16x16x32_bf16 v[76:79], v[172:175], v[140:143], v[76:79]
ds_read_b128 v[168:171], v0 offset:51200
s_waitcnt lgkmcnt(5)
v_mfma_f32_16x16x32_bf16 v[80:83], v[176:179], v[136:139], v[80:83]
ds_read_b128 v[172:175], v0 offset:52224
v_mfma_f32_16x16x32_bf16 v[84:87], v[176:179], v[140:143], v[84:87]
v_mfma_f32_16x16x32_bf16 v[88:91], v[180:183], v[136:139], v[88:91]
buffer_load_dwordx4 v0, s[4:7], s49 offen offset:2048 sc1 lds
v_mfma_f32_16x16x32_bf16 v[92:95], v[180:183], v[140:143], v[92:95]
s_add_u32 m0, s43, 110592
s_waitcnt lgkmcnt(4)
v_mfma_f32_16x16x32_bf16 v[96:99], v[184:187], v[136:139], v[96:99]
s_add_u32 s49, s19, 110592
ds_read_b128 v[176:179], v0 offset:53248
v_mfma_f32_16x16x32_bf16 v[100:103], v[184:187], v[140:143], v[100:103]
ds_read_b128 v[180:183], v0 offset:54272
v_mfma_f32_16x16x32_bf16 v[104:107], v[188:191], v[136:139], v[104:107]
ds_read_b128 v[184:187], v0 offset:55296
v_mfma_f32_16x16x32_bf16 v[108:111], v[188:191], v[140:143], v[108:111]
s_waitcnt lgkmcnt(5)
s_waitcnt vmcnt(16)
v_mfma_f32_16x16x32_bf16 v[16:19], v[160:163], v[144:147], v[16:19]
buffer_load_dwordx4 v0, s[4:7], s49 offen offset:0 sc1 lds
s_waitcnt vmcnt(16)
v_mfma_f32_16x16x32_bf16 v[20:23], v[160:163], v[148:151], v[20:23]
ds_read_b128 v[188:191], v0 offset:56320
v_mfma_f32_16x16x32_bf16 v[24:27], v[164:167], v[144:147], v[24:27]
ds_read_b128 v[160:163], v0 offset:57344
v_mfma_f32_16x16x32_bf16 v[28:31], v[164:167], v[148:151], v[28:31]
s_waitcnt lgkmcnt(5)
v_mfma_f32_16x16x32_bf16 v[32:35], v[168:171], v[144:147], v[32:35]
buffer_load_dwordx4 v0, s[4:7], s49 offen offset:1024 sc1 lds
v_mfma_f32_16x16x32_bf16 v[36:39], v[168:171], v[148:151], v[36:39]
ds_read_b128 v[164:167], v0 offset:58368
v_mfma_f32_16x16x32_bf16 v[40:43], v[172:175], v[144:147], v[40:43]
ds_read_b128 v[168:171], v0 offset:59392
v_mfma_f32_16x16x32_bf16 v[44:47], v[172:175], v[148:151], v[44:47]
s_waitcnt lgkmcnt(5)
v_mfma_f32_16x16x32_bf16 v[48:51], v[176:179], v[144:147], v[48:51]
buffer_load_dwordx4 v0, s[4:7], s49 offen offset:2048 sc1 lds
v_mfma_f32_16x16x32_bf16 v[52:55], v[176:179], v[148:151], v[52:55]
s_add_u32 s51, s16, 8192
ds_read_b128 v[172:175], v0 offset:60416
v_mfma_f32_16x16x32_bf16 v[56:59], v[180:183], v[144:147], v[56:59]
ds_read_b128 v[176:179], v0 offset:61440
v_mfma_f32_16x16x32_bf16 v[60:63], v[180:183], v[148:151], v[60:63]
s_waitcnt lgkmcnt(5)
v_mfma_f32_16x16x32_bf16 v[64:67], v[184:187], v[144:147], v[64:67]
buffer_load_dwordx4 v[112:115], v0, s[4:7], s51 offen offset:0 sc1
v_mfma_f32_16x16x32_bf16 v[68:71], v[184:187], v[148:151], v[68:71]
ds_read_b128 v[180:183], v0 offset:62464
v_mfma_f32_16x16x32_bf16 v[72:75], v[188:191], v[144:147], v[72:75]
ds_read_b128 v[184:187], v0 offset:63488
v_mfma_f32_16x16x32_bf16 v[76:79], v[188:191], v[148:151], v[76:79]
s_waitcnt lgkmcnt(5)
v_mfma_f32_16x16x32_bf16 v[80:83], v[160:163], v[144:147], v[80:83]
ds_read_b128 v[188:191], v0 offset:64512
v_mfma_f32_16x16x32_bf16 v[84:87], v[160:163], v[148:151], v[84:87]
buffer_load_dwordx4 v[116:119], v1, s[4:7], s51 offen offset:0 sc1
v_mfma_f32_16x16x32_bf16 v[88:91], v[164:167], v[144:147], v[88:91]
ds_read_b128 v[160:163], v4 offset:0
v_mfma_f32_16x16x32_bf16 v[92:95], v[164:167], v[148:151], v[92:95]
s_waitcnt lgkmcnt(5)
v_mfma_f32_16x16x32_bf16 v[96:99], v[168:171], v[144:147], v[96:99]
ds_read_b128 v[164:167], v4 offset:1024
v_mfma_f32_16x16x32_bf16 v[100:103], v[168:171], v[148:151], v[100:103]
buffer_load_dwordx4 v[120:123], v0, s[4:7], s51 offen offset:1024 sc1
v_mfma_f32_16x16x32_bf16 v[104:107], v[172:175], v[144:147], v[104:107]
ds_read_b128 v[168:171], v4 offset:2048
v_mfma_f32_16x16x32_bf16 v[108:111], v[172:175], v[148:151], v[108:111]
s_waitcnt lgkmcnt(5)
s_waitcnt vmcnt(20)
v_mfma_f32_16x16x32_bf16 v[16:19], v[176:179], v[152:155], v[16:19]
ds_read_b128 v[172:175], v4 offset:3072
s_waitcnt vmcnt(19)
v_mfma_f32_16x16x32_bf16 v[20:23], v[176:179], v[156:159], v[20:23]
s_lshl_b32 s55, s14, 10
s_add_u32 s55, s55, C_p3e1-M_pc
v_lshlrev_b32 v233, 5, v9
v_and_b32 v233, 0x380, v233
v_add_u32 v233, s55, v233
v_min_u32 v233, M_last-M_pc-4, v233
global_load_dword v233, v233, s[86:87]
v_mfma_f32_16x16x32_bf16 v[24:27], v[180:183], v[152:155], v[24:27]
ds_read_b128 v[176:179], v4 offset:4096
v_mfma_f32_16x16x32_bf16 v[28:31], v[180:183], v[156:159], v[28:31]
s_waitcnt lgkmcnt(5)
v_mfma_f32_16x16x32_bf16 v[32:35], v[184:187], v[152:155], v[32:35]
ds_read_b128 v[180:183], v4 offset:5120
v_mfma_f32_16x16x32_bf16 v[36:39], v[184:187], v[156:159], v[36:39]
buffer_load_dwordx4 v[124:127], v1, s[4:7], s51 offen offset:1024 sc1
v_mfma_f32_16x16x32_bf16 v[40:43], v[188:191], v[152:155], v[40:43]
s_add_u32 m0, s43, 122880
s_add_u32 s49, s19, 122880
v_mfma_f32_16x16x32_bf16 v[44:47], v[188:191], v[156:159], v[44:47]
ds_read_b128 v[184:187], v4 offset:6144
s_waitcnt lgkmcnt(5)
v_mfma_f32_16x16x32_bf16 v[48:51], v[160:163], v[152:155], v[48:51]
ds_read_b128 v[188:191], v4 offset:7168
v_mfma_f32_16x16x32_bf16 v[52:55], v[160:163], v[156:159], v[52:55]
v_mfma_f32_16x16x32_bf16 v[56:59], v[164:167], v[152:155], v[56:59]
buffer_load_dwordx4 v0, s[4:7], s49 offen offset:0 sc1 lds
v_mfma_f32_16x16x32_bf16 v[60:63], v[164:167], v[156:159], v[60:63]
s_waitcnt lgkmcnt(4)
v_mfma_f32_16x16x32_bf16 v[64:67], v[168:171], v[152:155], v[64:67]
s_waitcnt vmcnt(16)
s_barrier
v_mfma_f32_16x16x32_bf16 v[68:71], v[168:171], v[156:159], v[68:71]
ds_read_b128 v[160:163], v4 offset:8192
ds_read_b128 v[164:167], v4 offset:9216
v_mfma_f32_16x16x32_bf16 v[72:75], v[172:175], v[152:155], v[72:75]
buffer_load_dwordx4 v0, s[4:7], s49 offen offset:1024 sc1 lds
v_mfma_f32_16x16x32_bf16 v[76:79], v[172:175], v[156:159], v[76:79]
ds_read_b128 v[168:171], v4 offset:10240
s_waitcnt lgkmcnt(5)
v_mfma_f32_16x16x32_bf16 v[80:83], v[176:179], v[152:155], v[80:83]
ds_read_b128 v[172:175], v4 offset:11264
v_mfma_f32_16x16x32_bf16 v[84:87], v[176:179], v[156:159], v[84:87]
v_mfma_f32_16x16x32_bf16 v[88:91], v[180:183], v[152:155], v[88:91]
ds_read_b128 v[176:179], v4 offset:12288
v_mfma_f32_16x16x32_bf16 v[92:95], v[180:183], v[156:159], v[92:95]
s_waitcnt lgkmcnt(5)
v_mfma_f32_16x16x32_bf16 v[96:99], v[184:187], v[152:155], v[96:99]
buffer_load_dwordx4 v0, s[4:7], s49 offen offset:2048 sc1 lds
v_mfma_f32_16x16x32_bf16 v[100:103], v[184:187], v[156:159], v[100:103]
s_add_u32 m0, s43, 135168
s_add_u32 s49, s19, 135168
v_mfma_f32_16x16x32_bf16 v[104:107], v[188:191], v[152:155], v[104:107]
ds_read_b128 v[180:183], v4 offset:13312
ds_read_b128 v[184:187], v4 offset:14336
v_mfma_f32_16x16x32_bf16 v[108:111], v[188:191], v[156:159], v[108:111]
s_waitcnt lgkmcnt(5)
s_waitcnt vmcnt(17)
v_mfma_f32_16x16x32_bf16 v[16:19], v[160:163], v[192:195], v[16:19]
buffer_load_dwordx4 v0, s[4:7], s49 offen offset:0 sc1 lds
s_waitcnt vmcnt(17)
v_mfma_f32_16x16x32_bf16 v[20:23], v[160:163], v[196:199], v[20:23]
ds_read_b128 v[188:191], v4 offset:15360
v_mfma_f32_16x16x32_bf16 v[24:27], v[164:167], v[192:195], v[24:27]
ds_read_b128 v[160:163], v4 offset:16384
v_mfma_f32_16x16x32_bf16 v[28:31], v[164:167], v[196:199], v[28:31]
s_waitcnt lgkmcnt(5)
v_mfma_f32_16x16x32_bf16 v[32:35], v[168:171], v[192:195], v[32:35]
buffer_load_dwordx4 v0, s[4:7], s49 offen offset:1024 sc1 lds
v_mfma_f32_16x16x32_bf16 v[36:39], v[168:171], v[196:199], v[36:39]
ds_read_b128 v[164:167], v4 offset:17408
v_mfma_f32_16x16x32_bf16 v[40:43], v[172:175], v[192:195], v[40:43]
ds_read_b128 v[168:171], v4 offset:18432
v_mfma_f32_16x16x32_bf16 v[44:47], v[172:175], v[196:199], v[44:47]
s_waitcnt lgkmcnt(5)
v_mfma_f32_16x16x32_bf16 v[48:51], v[176:179], v[192:195], v[48:51]
buffer_load_dwordx4 v0, s[4:7], s49 offen offset:2048 sc1 lds
v_mfma_f32_16x16x32_bf16 v[52:55], v[176:179], v[196:199], v[52:55]
ds_read_b128 v[172:175], v4 offset:19456
v_mfma_f32_16x16x32_bf16 v[56:59], v[180:183], v[192:195], v[56:59]
ds_read_b128 v[176:179], v4 offset:20480
v_mfma_f32_16x16x32_bf16 v[60:63], v[180:183], v[196:199], v[60:63]
s_waitcnt lgkmcnt(5)
v_mfma_f32_16x16x32_bf16 v[64:67], v[184:187], v[192:195], v[64:67]
ds_read_b128 v[180:183], v4 offset:21504
v_mfma_f32_16x16x32_bf16 v[68:71], v[184:187], v[196:199], v[68:71]
buffer_load_dwordx4 v[128:131], v0, s[4:7], s51 offen offset:2048 sc1
v_mfma_f32_16x16x32_bf16 v[72:75], v[188:191], v[192:195], v[72:75]
ds_read_b128 v[184:187], v4 offset:22528
v_mfma_f32_16x16x32_bf16 v[76:79], v[188:191], v[196:199], v[76:79]
s_waitcnt lgkmcnt(5)
v_mfma_f32_16x16x32_bf16 v[80:83], v[160:163], v[192:195], v[80:83]
ds_read_b128 v[188:191], v4 offset:23552
v_mfma_f32_16x16x32_bf16 v[84:87], v[160:163], v[196:199], v[84:87]
buffer_load_dwordx4 v[132:135], v1, s[4:7], s51 offen offset:2048 sc1
v_mfma_f32_16x16x32_bf16 v[88:91], v[164:167], v[192:195], v[88:91]
ds_read_b128 v[160:163], v4 offset:24576
v_mfma_f32_16x16x32_bf16 v[92:95], v[164:167], v[196:199], v[92:95]
s_waitcnt lgkmcnt(5)
v_mfma_f32_16x16x32_bf16 v[96:99], v[168:171], v[192:195], v[96:99]
ds_read_b128 v[164:167], v4 offset:25600
v_mfma_f32_16x16x32_bf16 v[100:103], v[168:171], v[196:199], v[100:103]
v_mfma_f32_16x16x32_bf16 v[104:107], v[172:175], v[192:195], v[104:107]
buffer_load_dwordx4 v[136:139], v0, s[4:7], s51 offen offset:3072 sc1
v_mfma_f32_16x16x32_bf16 v[108:111], v[172:175], v[196:199], v[108:111]
ds_read_b128 v[168:171], v4 offset:26624
s_waitcnt lgkmcnt(5)
s_waitcnt vmcnt(21)
v_mfma_f32_16x16x32_bf16 v[16:19], v[176:179], v[200:203], v[16:19]
ds_read_b128 v[172:175], v4 offset:27648
s_waitcnt vmcnt(20)
v_mfma_f32_16x16x32_bf16 v[20:23], v[176:179], v[204:207], v[20:23]
v_mfma_f32_16x16x32_bf16 v[24:27], v[180:183], v[200:203], v[24:27]
buffer_load_dwordx4 v[140:143], v1, s[4:7], s51 offen offset:3072 sc1
v_mfma_f32_16x16x32_bf16 v[28:31], v[180:183], v[204:207], v[28:31]
s_add_u32 m0, s43, 147456
s_waitcnt lgkmcnt(4)
v_mfma_f32_16x16x32_bf16 v[32:35], v[184:187], v[200:203], v[32:35]
s_add_u32 s49, s19, 147456
ds_read_b128 v[176:179], v4 offset:28672
v_mfma_f32_16x16x32_bf16 v[36:39], v[184:187], v[204:207], v[36:39]
ds_read_b128 v[180:183], v4 offset:29696
v_mfma_f32_16x16x32_bf16 v[40:43], v[188:191], v[200:203], v[40:43]
ds_read_b128 v[184:187], v4 offset:30720
v_mfma_f32_16x16x32_bf16 v[44:47], v[188:191], v[204:207], v[44:47]
s_waitcnt lgkmcnt(5)
v_mfma_f32_16x16x32_bf16 v[48:51], v[160:163], v[200:203], v[48:51]
buffer_load_dwordx4 v0, s[4:7], s49 offen offset:0 sc1 lds
v_mfma_f32_16x16x32_bf16 v[52:55], v[160:163], v[204:207], v[52:55]
ds_read_b128 v[188:191], v4 offset:31744
v_mfma_f32_16x16x32_bf16 v[56:59], v[164:167], v[200:203], v[56:59]
v_mfma_f32_16x16x32_bf16 v[60:63], v[164:167], v[204:207], v[60:63]
s_waitcnt lgkmcnt(4)
v_mfma_f32_16x16x32_bf16 v[64:67], v[168:171], v[200:203], v[64:67]
s_waitcnt vmcnt(16)
s_barrier
buffer_load_dwordx4 v0, s[4:7], s49 offen offset:1024 sc1 lds
v_mfma_f32_16x16x32_bf16 v[68:71], v[168:171], v[204:207], v[68:71]
ds_read_b128 v[160:163], v4 offset:32768
ds_read_b128 v[164:167], v4 offset:33792
v_mfma_f32_16x16x32_bf16 v[72:75], v[172:175], v[200:203], v[72:75]
ds_read_b128 v[168:171], v4 offset:34816
v_mfma_f32_16x16x32_bf16 v[76:79], v[172:175], v[204:207], v[76:79]
s_waitcnt lgkmcnt(5)
v_mfma_f32_16x16x32_bf16 v[80:83], v[176:179], v[200:203], v[80:83]
buffer_load_dwordx4 v0, s[4:7], s49 offen offset:2048 sc1 lds
v_mfma_f32_16x16x32_bf16 v[84:87], v[176:179], v[204:207], v[84:87]
s_add_u32 m0, s43, 0
s_add_u32 s49, s19, 159744
v_mfma_f32_16x16x32_bf16 v[88:91], v[180:183], v[200:203], v[88:91]
ds_read_b128 v[172:175], v4 offset:35840
ds_read_b128 v[176:179], v4 offset:36864
v_mfma_f32_16x16x32_bf16 v[92:95], v[180:183], v[204:207], v[92:95]
s_waitcnt lgkmcnt(5)
v_mfma_f32_16x16x32_bf16 v[96:99], v[184:187], v[200:203], v[96:99]
buffer_load_dwordx4 v0, s[4:7], s49 offen offset:0 sc1 lds
v_mfma_f32_16x16x32_bf16 v[100:103], v[184:187], v[204:207], v[100:103]
ds_read_b128 v[180:183], v4 offset:37888
v_mfma_f32_16x16x32_bf16 v[104:107], v[188:191], v[200:203], v[104:107]
ds_read_b128 v[184:187], v4 offset:38912
v_mfma_f32_16x16x32_bf16 v[108:111], v[188:191], v[204:207], v[108:111]
s_waitcnt lgkmcnt(5)
s_waitcnt vmcnt(18)
v_mfma_f32_16x16x32_bf16 v[16:19], v[160:163], v[112:115], v[16:19]
ds_read_b128 v[188:191], v4 offset:39936
s_waitcnt vmcnt(17)
v_mfma_f32_16x16x32_bf16 v[20:23], v[160:163], v[116:119], v[20:23]
buffer_load_dwordx4 v0, s[4:7], s49 offen offset:1024 sc1 lds
v_mfma_f32_16x16x32_bf16 v[24:27], v[164:167], v[112:115], v[24:27]
ds_read_b128 v[160:163], v4 offset:40960
v_mfma_f32_16x16x32_bf16 v[28:31], v[164:167], v[116:119], v[28:31]
s_waitcnt lgkmcnt(5)
v_mfma_f32_16x16x32_bf16 v[32:35], v[168:171], v[112:115], v[32:35]
ds_read_b128 v[164:167], v4 offset:41984
v_mfma_f32_16x16x32_bf16 v[36:39], v[168:171], v[116:119], v[36:39]
buffer_load_dwordx4 v0, s[4:7], s49 offen offset:2048 sc1 lds
v_mfma_f32_16x16x32_bf16 v[40:43], v[172:175], v[112:115], v[40:43]
s_add_u32 s51, s16, 12288
ds_read_b128 v[168:171], v4 offset:43008
v_mfma_f32_16x16x32_bf16 v[44:47], v[172:175], v[116:119], v[44:47]
s_waitcnt lgkmcnt(5)
v_mfma_f32_16x16x32_bf16 v[48:51], v[176:179], v[112:115], v[48:51]
ds_read_b128 v[172:175], v4 offset:44032
v_mfma_f32_16x16x32_bf16 v[52:55], v[176:179], v[116:119], v[52:55]
v_mfma_f32_16x16x32_bf16 v[56:59], v[180:183], v[112:115], v[56:59]
buffer_load_dwordx4 v[144:147], v0, s[4:7], s51 offen offset:0 sc1
v_mfma_f32_16x16x32_bf16 v[60:63], v[180:183], v[116:119], v[60:63]
ds_read_b128 v[176:179], v4 offset:45056
s_waitcnt lgkmcnt(5)
v_mfma_f32_16x16x32_bf16 v[64:67], v[184:187], v[112:115], v[64:67]
ds_read_b128 v[180:183], v4 offset:46080
v_mfma_f32_16x16x32_bf16 v[68:71], v[184:187], v[116:119], v[68:71]
v_mfma_f32_16x16x32_bf16 v[72:75], v[188:191], v[112:115], v[72:75]
buffer_load_dwordx4 v[148:151], v1, s[4:7], s51 offen offset:0 sc1
v_mfma_f32_16x16x32_bf16 v[76:79], v[188:191], v[116:119], v[76:79]
ds_read_b128 v[184:187], v4 offset:47104
s_waitcnt lgkmcnt(5)
v_mfma_f32_16x16x32_bf16 v[80:83], v[160:163], v[112:115], v[80:83]
ds_read_b128 v[188:191], v4 offset:48128
v_mfma_f32_16x16x32_bf16 v[84:87], v[160:163], v[116:119], v[84:87]
v_mfma_f32_16x16x32_bf16 v[88:91], v[164:167], v[112:115], v[88:91]
ds_read_b128 v[160:163], v4 offset:49152
v_mfma_f32_16x16x32_bf16 v[92:95], v[164:167], v[116:119], v[92:95]
s_waitcnt lgkmcnt(5)
v_mfma_f32_16x16x32_bf16 v[96:99], v[168:171], v[112:115], v[96:99]
buffer_load_dwordx4 v[152:155], v0, s[4:7], s51 offen offset:1024 sc1
v_mfma_f32_16x16x32_bf16 v[100:103], v[168:171], v[116:119], v[100:103]
ds_read_b128 v[164:167], v4 offset:50176
v_mfma_f32_16x16x32_bf16 v[104:107], v[172:175], v[112:115], v[104:107]
ds_read_b128 v[168:171], v4 offset:51200
v_mfma_f32_16x16x32_bf16 v[108:111], v[172:175], v[116:119], v[108:111]
s_waitcnt lgkmcnt(5)
s_waitcnt vmcnt(21)
v_mfma_f32_16x16x32_bf16 v[16:19], v[176:179], v[120:123], v[16:19]
buffer_load_dwordx4 v[156:159], v1, s[4:7], s51 offen offset:1024 sc1
s_waitcnt vmcnt(20)
v_mfma_f32_16x16x32_bf16 v[20:23], v[176:179], v[124:127], v[20:23]
s_add_u32 m0, s43, 12288
s_add_u32 s49, s19, 172032
v_mfma_f32_16x16x32_bf16 v[24:27], v[180:183], v[120:123], v[24:27]
ds_read_b128 v[172:175], v4 offset:52224
ds_read_b128 v[176:179], v4 offset:53248
v_mfma_f32_16x16x32_bf16 v[28:31], v[180:183], v[124:127], v[28:31]
s_waitcnt lgkmcnt(5)
v_mfma_f32_16x16x32_bf16 v[32:35], v[184:187], v[120:123], v[32:35]
buffer_load_dwordx4 v0, s[4:7], s49 offen offset:0 sc1 lds
v_mfma_f32_16x16x32_bf16 v[36:39], v[184:187], v[124:127], v[36:39]
ds_read_b128 v[180:183], v4 offset:54272
v_mfma_f32_16x16x32_bf16 v[40:43], v[188:191], v[120:123], v[40:43]
ds_read_b128 v[184:187], v4 offset:55296
v_mfma_f32_16x16x32_bf16 v[44:47], v[188:191], v[124:127], v[44:47]
s_waitcnt lgkmcnt(5)
v_mfma_f32_16x16x32_bf16 v[48:51], v[160:163], v[120:123], v[48:51]
buffer_load_dwordx4 v0, s[4:7], s49 offen offset:1024 sc1 lds
v_mfma_f32_16x16x32_bf16 v[52:55], v[160:163], v[124:127], v[52:55]
ds_read_b128 v[188:191], v4 offset:56320
v_mfma_f32_16x16x32_bf16 v[56:59], v[164:167], v[120:123], v[56:59]
v_mfma_f32_16x16x32_bf16 v[60:63], v[164:167], v[124:127], v[60:63]
s_waitcnt lgkmcnt(4)
v_mfma_f32_16x16x32_bf16 v[64:67], v[168:171], v[120:123], v[64:67]
s_waitcnt vmcnt(16)
s_barrier
v_mfma_f32_16x16x32_bf16 v[68:71], v[168:171], v[124:127], v[68:71]
buffer_load_dwordx4 v0, s[4:7], s49 offen offset:2048 sc1 lds
v_mfma_f32_16x16x32_bf16 v[72:75], v[172:175], v[120:123], v[72:75]
s_add_u32 m0, s43, 24576
s_add_u32 s49, s19, 184320
v_mfma_f32_16x16x32_bf16 v[76:79], v[172:175], v[124:127], v[76:79]
ds_read_b128 v[160:163], v4 offset:57344
s_waitcnt lgkmcnt(3)
v_mfma_f32_16x16x32_bf16 v[80:83], v[176:179], v[120:123], v[80:83]
ds_read_b128 v[164:167], v4 offset:58368
ds_read_b128 v[168:171], v4 offset:59392
v_mfma_f32_16x16x32_bf16 v[84:87], v[176:179], v[124:127], v[84:87]
buffer_load_dwordx4 v0, s[4:7], s49 offen offset:0 sc1 lds
v_mfma_f32_16x16x32_bf16 v[88:91], v[180:183], v[120:123], v[88:91]
ds_read_b128 v[172:175], v4 offset:60416
ds_read_b128 v[176:179], v4 offset:61440
v_mfma_f32_16x16x32_bf16 v[92:95], v[180:183], v[124:127], v[92:95]
s_waitcnt lgkmcnt(5)
v_mfma_f32_16x16x32_bf16 v[96:99], v[184:187], v[120:123], v[96:99]
ds_read_b128 v[180:183], v4 offset:62464
v_mfma_f32_16x16x32_bf16 v[100:103], v[184:187], v[124:127], v[100:103]
v_mfma_f32_16x16x32_bf16 v[104:107], v[188:191], v[120:123], v[104:107]
buffer_load_dwordx4 v0, s[4:7], s49 offen offset:1024 sc1 lds
v_mfma_f32_16x16x32_bf16 v[108:111], v[188:191], v[124:127], v[108:111]
ds_read_b128 v[184:187], v4 offset:63488
s_waitcnt lgkmcnt(5)
s_waitcnt vmcnt(18)
v_mfma_f32_16x16x32_bf16 v[16:19], v[160:163], v[128:131], v[16:19]
ds_read_b128 v[188:191], v4 offset:64512
s_waitcnt vmcnt(17)
v_mfma_f32_16x16x32_bf16 v[20:23], v[160:163], v[132:135], v[20:23]
v_mfma_f32_16x16x32_bf16 v[24:27], v[164:167], v[128:131], v[24:27]
buffer_load_dwordx4 v0, s[4:7], s49 offen offset:2048 sc1 lds
v_mfma_f32_16x16x32_bf16 v[28:31], v[164:167], v[132:135], v[28:31]
ds_read_b128 v[160:163], v5 offset:0
s_waitcnt lgkmcnt(5)
v_mfma_f32_16x16x32_bf16 v[32:35], v[168:171], v[128:131], v[32:35]
ds_read_b128 v[164:167], v5 offset:1024
v_mfma_f32_16x16x32_bf16 v[36:39], v[168:171], v[132:135], v[36:39]
v_mfma_f32_16x16x32_bf16 v[40:43], v[172:175], v[128:131], v[40:43]
ds_read_b128 v[168:171], v5 offset:2048
v_mfma_f32_16x16x32_bf16 v[44:47], v[172:175], v[132:135], v[44:47]
s_waitcnt lgkmcnt(5)
v_mfma_f32_16x16x32_bf16 v[48:51], v[176:179], v[128:131], v[48:51]
buffer_load_dwordx4 v[192:195], v0, s[4:7], s51 offen offset:2048 sc1
v_mfma_f32_16x16x32_bf16 v[52:55], v[176:179], v[132:135], v[52:55]
ds_read_b128 v[172:175], v5 offset:3072
v_mfma_f32_16x16x32_bf16 v[56:59], v[180:183], v[128:131], v[56:59]
ds_read_b128 v[176:179], v5 offset:4096
v_mfma_f32_16x16x32_bf16 v[60:63], v[180:183], v[132:135], v[60:63]
s_waitcnt lgkmcnt(5)
v_mfma_f32_16x16x32_bf16 v[64:67], v[184:187], v[128:131], v[64:67]
buffer_load_dwordx4 v[196:199], v1, s[4:7], s51 offen offset:2048 sc1
v_mfma_f32_16x16x32_bf16 v[68:71], v[184:187], v[132:135], v[68:71]
ds_read_b128 v[180:183], v5 offset:5120
v_mfma_f32_16x16x32_bf16 v[72:75], v[188:191], v[128:131], v[72:75]
ds_read_b128 v[184:187], v5 offset:6144
v_mfma_f32_16x16x32_bf16 v[76:79], v[188:191], v[132:135], v[76:79]
s_waitcnt lgkmcnt(5)
v_mfma_f32_16x16x32_bf16 v[80:83], v[160:163], v[128:131], v[80:83]
buffer_load_dwordx2 v[234:235], v13, s[4:7], s33 offen offset:0 sc1
v_mfma_f32_16x16x32_bf16 v[84:87], v[160:163], v[132:135], v[84:87]
ds_read_b128 v[188:191], v5 offset:7168
v_mfma_f32_16x16x32_bf16 v[88:91], v[164:167], v[128:131], v[88:91]
ds_read_b128 v[160:163], v5 offset:8192
v_mfma_f32_16x16x32_bf16 v[92:95], v[164:167], v[132:135], v[92:95]
s_waitcnt lgkmcnt(5)
v_mfma_f32_16x16x32_bf16 v[96:99], v[168:171], v[128:131], v[96:99]
buffer_load_dwordx2 v[236:237], v13, s[4:7], s33 offen offset:128 sc1
v_mfma_f32_16x16x32_bf16 v[100:103], v[168:171], v[132:135], v[100:103]
ds_read_b128 v[164:167], v5 offset:9216
v_mfma_f32_16x16x32_bf16 v[104:107], v[172:175], v[128:131], v[104:107]
ds_read_b128 v[168:171], v5 offset:10240
v_mfma_f32_16x16x32_bf16 v[108:111], v[172:175], v[132:135], v[108:111]
s_waitcnt lgkmcnt(5)
s_waitcnt vmcnt(21)
v_mfma_f32_16x16x32_bf16 v[16:19], v[176:179], v[136:139], v[16:19]
ds_read_b128 v[172:175], v5 offset:11264
s_waitcnt vmcnt(20)
v_mfma_f32_16x16x32_bf16 v[20:23], v[176:179], v[140:143], v[20:23]
buffer_load_dwordx2 v[238:239], v13, s[4:7], s33 offen offset:1024 sc1
v_mfma_f32_16x16x32_bf16 v[24:27], v[180:183], v[136:139], v[24:27]
ds_read_b128 v[176:179], v5 offset:12288
v_mfma_f32_16x16x32_bf16 v[28:31], v[180:183], v[140:143], v[28:31]
s_waitcnt lgkmcnt(5)
v_mfma_f32_16x16x32_bf16 v[32:35], v[184:187], v[136:139], v[32:35]
ds_read_b128 v[180:183], v5 offset:13312
v_mfma_f32_16x16x32_bf16 v[36:39], v[184:187], v[140:143], v[36:39]
buffer_load_dwordx2 v[240:241], v13, s[4:7], s33 offen offset:1152 sc1
v_mfma_f32_16x16x32_bf16 v[40:43], v[188:191], v[136:139], v[40:43]
ds_read_b128 v[184:187], v5 offset:14336
v_mfma_f32_16x16x32_bf16 v[44:47], v[188:191], v[140:143], v[44:47]
s_waitcnt lgkmcnt(5)
v_mfma_f32_16x16x32_bf16 v[48:51], v[160:163], v[136:139], v[48:51]
ds_read_b128 v[188:191], v5 offset:15360
v_mfma_f32_16x16x32_bf16 v[52:55], v[160:163], v[140:143], v[52:55]
v_mfma_f32_16x16x32_bf16 v[56:59], v[164:167], v[136:139], v[56:59]
buffer_load_dwordx4 v[200:203], v0, s[4:7], s51 offen offset:3072 sc1
v_mfma_f32_16x16x32_bf16 v[60:63], v[164:167], v[140:143], v[60:63]
s_waitcnt lgkmcnt(4)
v_mfma_f32_16x16x32_bf16 v[64:67], v[168:171], v[136:139], v[64:67]
s_waitcnt vmcnt(17)
s_barrier
v_mfma_f32_16x16x32_bf16 v[68:71], v[168:171], v[140:143], v[68:71]
ds_read_b128 v[160:163], v5 offset:16384
ds_read_b128 v[164:167], v5 offset:17408
v_mfma_f32_16x16x32_bf16 v[72:75], v[172:175], v[136:139], v[72:75]
buffer_load_dwordx4 v[204:207], v1, s[4:7], s51 offen offset:3072 sc1
v_mfma_f32_16x16x32_bf16 v[76:79], v[172:175], v[140:143], v[76:79]
s_add_u32 m0, s43, 36864
s_waitcnt lgkmcnt(4)
v_mfma_f32_16x16x32_bf16 v[80:83], v[176:179], v[136:139], v[80:83]
s_add_u32 s49, s19, 196608
ds_read_b128 v[168:171], v5 offset:18432
v_mfma_f32_16x16x32_bf16 v[84:87], v[176:179], v[140:143], v[84:87]
ds_read_b128 v[172:175], v5 offset:19456
v_mfma_f32_16x16x32_bf16 v[88:91], v[180:183], v[136:139], v[88:91]
ds_read_b128 v[176:179], v5 offset:20480
v_mfma_f32_16x16x32_bf16 v[92:95], v[180:183], v[140:143], v[92:95]
s_waitcnt lgkmcnt(5)
v_mfma_f32_16x16x32_bf16 v[96:99], v[184:187], v[136:139], v[96:99]
buffer_load_dwordx4 v0, s[4:7], s49 offen offset:0 sc1 lds
v_mfma_f32_16x16x32_bf16 v[100:103], v[184:187], v[140:143], v[100:103]
ds_read_b128 v[180:183], v5 offset:21504
v_mfma_f32_16x16x32_bf16 v[104:107], v[188:191], v[136:139], v[104:107]
ds_read_b128 v[184:187], v5 offset:22528
v_mfma_f32_16x16x32_bf16 v[108:111], v[188:191], v[140:143], v[108:111]
s_waitcnt lgkmcnt(5)
s_waitcnt vmcnt(18)
v_mfma_f32_16x16x32_bf16 v[16:19], v[160:163], v[144:147], v[16:19]
buffer_load_dwordx4 v0, s[4:7], s49 offen offset:1024 sc1 lds
s_waitcnt vmcnt(18)
v_mfma_f32_16x16x32_bf16 v[20:23], v[160:163], v[148:151], v[20:23]
ds_read_b128 v[188:191], v5 offset:23552
v_mfma_f32_16x16x32_bf16 v[24:27], v[164:167], v[144:147], v[24:27]
ds_read_b128 v[160:163], v5 offset:24576
v_mfma_f32_16x16x32_bf16 v[28:31], v[164:167], v[148:151], v[28:31]
s_waitcnt lgkmcnt(5)
v_mfma_f32_16x16x32_bf16 v[32:35], v[168:171], v[144:147], v[32:35]
buffer_load_dwordx4 v0, s[4:7], s49 offen offset:2048 sc1 lds
v_mfma_f32_16x16x32_bf16 v[36:39], v[168:171], v[148:151], v[36:39]
s_add_u32 m0, s43, 49152
s_add_u32 s49, s19, 208896
v_mfma_f32_16x16x32_bf16 v[40:43], v[172:175], v[144:147], v[40:43]
ds_read_b128 v[164:167], v5 offset:25600
ds_read_b128 v[168:171], v5 offset:26624
v_mfma_f32_16x16x32_bf16 v[44:47], v[172:175], v[148:151], v[44:47]
s_waitcnt lgkmcnt(5)
v_mfma_f32_16x16x32_bf16 v[48:51], v[176:179], v[144:147], v[48:51]
buffer_load_dwordx4 v0, s[4:7], s49 offen offset:0 sc1 lds
v_mfma_f32_16x16x32_bf16 v[52:55], v[176:179], v[148:151], v[52:55]
ds_read_b128 v[172:175], v5 offset:27648
v_mfma_f32_16x16x32_bf16 v[56:59], v[180:183], v[144:147], v[56:59]
ds_read_b128 v[176:179], v0 offset:0
v_mfma_f32_16x16x32_bf16 v[60:63], v[180:183], v[148:151], v[60:63]
s_waitcnt lgkmcnt(5)
v_mfma_f32_16x16x32_bf16 v[64:67], v[184:187], v[144:147], v[64:67]
ds_read_b128 v[180:183], v0 offset:1024
v_mfma_f32_16x16x32_bf16 v[68:71], v[184:187], v[148:151], v[68:71]
buffer_load_dwordx4 v0, s[4:7], s49 offen offset:1024 sc1 lds
v_mfma_f32_16x16x32_bf16 v[72:75], v[188:191], v[144:147], v[72:75]
ds_read_b128 v[184:187], v0 offset:2048
v_mfma_f32_16x16x32_bf16 v[76:79], v[188:191], v[148:151], v[76:79]
s_waitcnt lgkmcnt(5)
v_mfma_f32_16x16x32_bf16 v[80:83], v[160:163], v[144:147], v[80:83]
ds_read_b128 v[188:191], v0 offset:3072
v_mfma_f32_16x16x32_bf16 v[84:87], v[160:163], v[148:151], v[84:87]
buffer_load_dwordx4 v0, s[4:7], s49 offen offset:2048 sc1 lds
v_mfma_f32_16x16x32_bf16 v[88:91], v[164:167], v[144:147], v[88:91]
s_add_u32 s51, s16, 16384
ds_read_b128 v[160:163], v0 offset:4096
v_mfma_f32_16x16x32_bf16 v[92:95], v[164:167], v[148:151], v[92:95]
s_waitcnt lgkmcnt(5)
v_mfma_f32_16x16x32_bf16 v[96:99], v[168:171], v[144:147], v[96:99]
ds_read_b128 v[164:167], v0 offset:5120
v_mfma_f32_16x16x32_bf16 v[100:103], v[168:171], v[148:151], v[100:103]
v_mfma_f32_16x16x32_bf16 v[104:107], v[172:175], v[144:147], v[104:107]
buffer_load_dwordx4 v[112:115], v0, s[4:7], s51 offen offset:0 sc1
v_mfma_f32_16x16x32_bf16 v[108:111], v[172:175], v[148:151], v[108:111]
ds_read_b128 v[168:171], v0 offset:6144
s_waitcnt lgkmcnt(5)
s_waitcnt vmcnt(22)
v_mfma_f32_16x16x32_bf16 v[16:19], v[176:179], v[152:155], v[16:19]
ds_read_b128 v[172:175], v0 offset:7168
s_waitcnt vmcnt(21)
v_mfma_f32_16x16x32_bf16 v[20:23], v[176:179], v[156:159], v[20:23]
v_mfma_f32_16x16x32_bf16 v[24:27], v[180:183], v[152:155], v[24:27]
buffer_load_dwordx4 v[116:119], v1, s[4:7], s51 offen offset:0 sc1
v_mfma_f32_16x16x32_bf16 v[28:31], v[180:183], v[156:159], v[28:31]
ds_read_b128 v[176:179], v0 offset:8192
s_waitcnt lgkmcnt(5)
v_mfma_f32_16x16x32_bf16 v[32:35], v[184:187], v[152:155], v[32:35]
ds_read_b128 v[180:183], v0 offset:9216
v_mfma_f32_16x16x32_bf16 v[36:39], v[184:187], v[156:159], v[36:39]
v_mfma_f32_16x16x32_bf16 v[40:43], v[188:191], v[152:155], v[40:43]
ds_read_b128 v[184:187], v0 offset:10240
v_mfma_f32_16x16x32_bf16 v[44:47], v[188:191], v[156:159], v[44:47]
s_waitcnt lgkmcnt(5)
v_mfma_f32_16x16x32_bf16 v[48:51], v[160:163], v[152:155], v[48:51]
buffer_load_dwordx4 v[120:123], v0, s[4:7], s51 offen offset:1024 sc1
v_mfma_f32_16x16x32_bf16 v[52:55], v[160:163], v[156:159], v[52:55]
ds_read_b128 v[188:191], v0 offset:11264
v_mfma_f32_16x16x32_bf16 v[56:59], v[164:167], v[152:155], v[56:59]
v_mfma_f32_16x16x32_bf16 v[60:63], v[164:167], v[156:159], v[60:63]
s_waitcnt lgkmcnt(4)
v_mfma_f32_16x16x32_bf16 v[64:67], v[168:171], v[152:155], v[64:67]
s_waitcnt vmcnt(17)
s_barrier
buffer_load_dwordx4 v[124:127], v1, s[4:7], s51 offen offset:1024 sc1
v_mfma_f32_16x16x32_bf16 v[68:71], v[168:171], v[156:159], v[68:71]
s_add_u32 m0, s43, 61440
s_add_u32 s49, s19, 221184
v_mfma_f32_16x16x32_bf16 v[72:75], v[172:175], v[152:155], v[72:75]
ds_read_b128 v[160:163], v0 offset:12288
ds_read_b128 v[164:167], v0 offset:13312
v_mfma_f32_16x16x32_bf16 v[76:79], v[172:175], v[156:159], v[76:79]
ds_read_b128 v[168:171], v0 offset:14336
s_waitcnt lgkmcnt(5)
v_mfma_f32_16x16x32_bf16 v[80:83], v[176:179], v[152:155], v[80:83]
buffer_load_dwordx4 v0, s[4:7], s49 offen offset:0 sc1 lds
v_mfma_f32_16x16x32_bf16 v[84:87], v[176:179], v[156:159], v[84:87]
ds_read_b128 v[172:175], v0 offset:15360
v_mfma_f32_16x16x32_bf16 v[88:91], v[180:183], v[152:155], v[88:91]
ds_read_b128 v[176:179], v0 offset:16384
v_mfma_f32_16x16x32_bf16 v[92:95], v[180:183], v[156:159], v[92:95]
s_waitcnt lgkmcnt(5)
v_mfma_f32_16x16x32_bf16 v[96:99], v[184:187], v[152:155], v[96:99]
buffer_load_dwordx4 v0, s[4:7], s49 offen offset:1024 sc1 lds
v_mfma_f32_16x16x32_bf16 v[100:103], v[184:187], v[156:159], v[100:103]
ds_read_b128 v[180:183], v0 offset:17408
v_mfma_f32_16x16x32_bf16 v[104:107], v[188:191], v[152:155], v[104:107]
ds_read_b128 v[184:187], v0 offset:18432
v_mfma_f32_16x16x32_bf16 v[108:111], v[188:191], v[156:159], v[108:111]
s_waitcnt lgkmcnt(5)
s_waitcnt vmcnt(19)
v_mfma_f32_16x16x32_bf16 v[16:19], v[160:163], v[192:195], v[16:19]
ds_read_b128 v[188:191], v0 offset:19456
s_waitcnt vmcnt(18)
v_mfma_f32_16x16x32_bf16 v[20:23], v[160:163], v[196:199], v[20:23]
buffer_load_dwordx4 v0, s[4:7], s49 offen offset:2048 sc1 lds
v_mfma_f32_16x16x32_bf16 v[24:27], v[164:167], v[192:195], v[24:27]
s_add_u32 m0, s43, 73728
s_add_u32 s49, s19, 233472
v_mfma_f32_16x16x32_bf16 v[28:31], v[164:167], v[196:199], v[28:31]
ds_read_b128 v[160:163], v0 offset:20480
s_waitcnt lgkmcnt(5)
v_mfma_f32_16x16x32_bf16 v[32:35], v[168:171], v[192:195], v[32:35]
ds_read_b128 v[164:167], v0 offset:21504
v_mfma_f32_16x16x32_bf16 v[36:39], v[168:171], v[196:199], v[36:39]
buffer_load_dwordx4 v0, s[4:7], s49 offen offset:0 sc1 lds
v_mfma_f32_16x16x32_bf16 v[40:43], v[172:175], v[192:195], v[40:43]
ds_read_b128 v[168:171], v0 offset:22528
v_mfma_f32_16x16x32_bf16 v[44:47], v[172:175], v[196:199], v[44:47]
s_waitcnt lgkmcnt(5)
v_mfma_f32_16x16x32_bf16 v[48:51], v[176:179], v[192:195], v[48:51]
ds_read_b128 v[172:175], v0 offset:23552
v_mfma_f32_16x16x32_bf16 v[52:55], v[176:179], v[196:199], v[52:55]
v_mfma_f32_16x16x32_bf16 v[56:59], v[180:183], v[192:195], v[56:59]
buffer_load_dwordx4 v0, s[4:7], s49 offen offset:1024 sc1 lds
v_mfma_f32_16x16x32_bf16 v[60:63], v[180:183], v[196:199], v[60:63]
ds_read_b128 v[176:179], v0 offset:24576
s_waitcnt lgkmcnt(5)
v_mfma_f32_16x16x32_bf16 v[64:67], v[184:187], v[192:195], v[64:67]
ds_read_b128 v[180:183], v0 offset:25600
v_mfma_f32_16x16x32_bf16 v[68:71], v[184:187], v[196:199], v[68:71]
v_mfma_f32_16x16x32_bf16 v[72:75], v[188:191], v[192:195], v[72:75]
buffer_load_dwordx4 v0, s[4:7], s49 offen offset:2048 sc1 lds
v_mfma_f32_16x16x32_bf16 v[76:79], v[188:191], v[196:199], v[76:79]
ds_read_b128 v[184:187], v0 offset:26624
s_waitcnt lgkmcnt(5)
v_mfma_f32_16x16x32_bf16 v[80:83], v[160:163], v[192:195], v[80:83]
ds_read_b128 v[188:191], v0 offset:27648
v_mfma_f32_16x16x32_bf16 v[84:87], v[160:163], v[196:199], v[84:87]
v_mfma_f32_16x16x32_bf16 v[88:91], v[164:167], v[192:195], v[88:91]
ds_read_b128 v[160:163], v0 offset:28672
v_mfma_f32_16x16x32_bf16 v[92:95], v[164:167], v[196:199], v[92:95]
s_waitcnt lgkmcnt(5)
v_mfma_f32_16x16x32_bf16 v[96:99], v[168:171], v[192:195], v[96:99]
buffer_load_dwordx4 v[128:131], v0, s[4:7], s51 offen offset:2048 sc1
v_mfma_f32_16x16x32_bf16 v[100:103], v[168:171], v[196:199], v[100:103]
ds_read_b128 v[164:167], v0 offset:29696
v_mfma_f32_16x16x32_bf16 v[104:107], v[172:175], v[192:195], v[104:107]
ds_read_b128 v[168:171], v0 offset:30720
v_mfma_f32_16x16x32_bf16 v[108:111], v[172:175], v[196:199], v[108:111]
s_waitcnt lgkmcnt(5)
s_waitcnt vmcnt(18)
v_mfma_f32_16x16x32_bf16 v[16:19], v[176:179], v[200:203], v[16:19]
buffer_load_dwordx4 v[132:135], v1, s[4:7], s51 offen offset:2048 sc1
s_waitcnt vmcnt(18)
v_mfma_f32_16x16x32_bf16 v[20:23], v[176:179], v[204:207], v[20:23]
ds_read_b128 v[172:175], v0 offset:31744
v_add_f32 v234, v234, v236
v_mfma_f32_16x16x32_bf16 v[24:27], v[180:183], v[200:203], v[24:27]
ds_read_b128 v[176:179], v0 offset:32768
v_add_f32 v238, v238, v240
v_mfma_f32_16x16x32_bf16 v[28:31], v[180:183], v[204:207], v[28:31]
v_add_f32 v235, v235, v237
s_waitcnt lgkmcnt(5)
v_mfma_f32_16x16x32_bf16 v[32:35], v[184:187], v[200:203], v[32:35]
buffer_load_dwordx4 v[136:139], v0, s[4:7], s51 offen offset:3072 sc1
v_mfma_f32_16x16x32_bf16 v[36:39], v[184:187], v[204:207], v[36:39]
ds_read_b128 v[180:183], v0 offset:33792
v_add_f32 v239, v239, v241
v_mfma_f32_16x16x32_bf16 v[40:43], v[188:191], v[200:203], v[40:43]
ds_read_b128 v[184:187], v0 offset:34816
v_permlane16_swap_b32 v234, v235
v_mfma_f32_16x16x32_bf16 v[44:47], v[188:191], v[204:207], v[44:47]
v_permlane16_swap_b32 v238, v239
s_waitcnt lgkmcnt(5)
v_mfma_f32_16x16x32_bf16 v[48:51], v[160:163], v[200:203], v[48:51]
buffer_load_dwordx4 v[140:143], v1, s[4:7], s51 offen offset:3072 sc1
v_mfma_f32_16x16x32_bf16 v[52:55], v[160:163], v[204:207], v[52:55]
ds_read_b128 v[188:191], v0 offset:35840
v_add_f32 v234, v234, v235
v_mfma_f32_16x16x32_bf16 v[56:59], v[164:167], v[200:203], v[56:59]
v_add_f32 v238, v238, v239
v_mov_b32 v235, v234
v_mfma_f32_16x16x32_bf16 v[60:63], v[164:167], v[204:207], v[60:63]
v_mov_b32 v239, v238
s_waitcnt lgkmcnt(4)
v_mfma_f32_16x16x32_bf16 v[64:67], v[168:171], v[200:203], v[64:67]
s_waitcnt vmcnt(14)
s_barrier
v_mfma_f32_16x16x32_bf16 v[68:71], v[168:171], v[204:207], v[68:71]
s_add_u32 s48, s40, 12288
v_lshlrev_b32 v228, 9, v9
v_and_b32 v228, 2048, v228
buffer_load_dword v228, v228, s[4:7], s48 offen
v_mfma_f32_16x16x32_bf16 v[72:75], v[172:175], v[200:203], v[72:75]
ds_read_b128 v[160:163], v0 offset:36864
ds_read_b128 v[164:167], v0 offset:37888
v_mfma_f32_16x16x32_bf16 v[76:79], v[172:175], v[204:207], v[76:79]
ds_read_b128 v[168:171], v0 offset:38912
s_waitcnt lgkmcnt(5)
v_mfma_f32_16x16x32_bf16 v[80:83], v[176:179], v[200:203], v[80:83]
ds_read_b128 v[172:175], v0 offset:39936
v_permlane32_swap_b32 v234, v235
v_mfma_f32_16x16x32_bf16 v[84:87], v[176:179], v[204:207], v[84:87]
buffer_load_dword v3, v229, s[4:7], s39 offen
v_mfma_f32_16x16x32_bf16 v[88:91], v[180:183], v[200:203], v[88:91]
ds_read_b128 v[176:179], v0 offset:40960
v_permlane32_swap_b32 v238, v239
v_mfma_f32_16x16x32_bf16 v[92:95], v[180:183], v[204:207], v[92:95]
v_add_f32 v234, v234, v235
s_waitcnt lgkmcnt(5)
v_mfma_f32_16x16x32_bf16 v[96:99], v[184:187], v[200:203], v[96:99]
ds_read_b128 v[180:183], v0 offset:41984
v_add_f32 v238, v238, v239
v_mfma_f32_16x16x32_bf16 v[100:103], v[184:187], v[204:207], v[100:103]
v_mov_b32 v235, v234
v_mov_b32 v239, v238
v_mfma_f32_16x16x32_bf16 v[104:107], v[188:191], v[200:203], v[104:107]
ds_read_b128 v[184:187], v0 offset:43008
v_permlane16_swap_b32 v234, v235
v_mfma_f32_16x16x32_bf16 v[108:111], v[188:191], v[204:207], v[108:111]
v_permlane16_swap_b32 v238, v239
s_waitcnt lgkmcnt(5)
s_waitcnt vmcnt(15)
v_mfma_f32_16x16x32_bf16 v[16:19], v[160:163], v[112:115], v[16:19]
ds_read_b128 v[188:191], v0 offset:44032
v_mul_f32 v242, 0x3acccccd, v234
s_waitcnt vmcnt(14)
v_mfma_f32_16x16x32_bf16 v[20:23], v[160:163], v[116:119], v[20:23]
v_mul_f32 v244, 0x3acccccd, v238
v_mul_f32 v235, 0x3acccccd, v235
v_mfma_f32_16x16x32_bf16 v[24:27], v[164:167], v[112:115], v[24:27]
ds_read_b128 v[160:163], v0 offset:45056
v_mul_f32 v239, 0x3acccccd, v239
v_mfma_f32_16x16x32_bf16 v[28:31], v[164:167], v[116:119], v[28:31]
v_fma_f32 v235, -v242, v242, v235
s_waitcnt lgkmcnt(5)
v_mfma_f32_16x16x32_bf16 v[32:35], v[168:171], v[112:115], v[32:35]
ds_read_b128 v[164:167], v0 offset:46080
v_fma_f32 v239, -v244, v244, v239
v_mfma_f32_16x16x32_bf16 v[36:39], v[168:171], v[116:119], v[36:39]
v_max_f32 v235, 0, v235
v_max_f32 v239, 0, v239
v_mfma_f32_16x16x32_bf16 v[40:43], v[172:175], v[112:115], v[40:43]
ds_read_b128 v[168:171], v0 offset:47104
v_add_f32 v235, 0x3727c5ac, v235
v_mfma_f32_16x16x32_bf16 v[44:47], v[172:175], v[116:119], v[44:47]
v_add_f32 v239, 0x3727c5ac, v239
s_waitcnt lgkmcnt(5)
v_mfma_f32_16x16x32_bf16 v[48:51], v[176:179], v[112:115], v[48:51]
ds_read_b128 v[172:175], v0 offset:48128
v_mfma_f32_16x16x32_bf16 v[52:55], v[176:179], v[116:119], v[52:55]
v_rsq_f32 v243, v235
v_mfma_f32_16x16x32_bf16 v[56:59], v[180:183], v[112:115], v[56:59]
ds_read_b128 v[176:179], v0 offset:49152
v_mfma_f32_16x16x32_bf16 v[60:63], v[180:183], v[116:119], v[60:63]
s_waitcnt lgkmcnt(5)
v_mfma_f32_16x16x32_bf16 v[64:67], v[184:187], v[112:115], v[64:67]
ds_read_b128 v[180:183], v0 offset:50176
v_mfma_f32_16x16x32_bf16 v[68:71], v[184:187], v[116:119], v[68:71]
v_rsq_f32 v245, v239
v_mfma_f32_16x16x32_bf16 v[72:75], v[188:191], v[112:115], v[72:75]
ds_read_b128 v[184:187], v0 offset:51200
v_mul_f32 v236, 0xbfb8aa3b, v243
v_mfma_f32_16x16x32_bf16 v[76:79], v[188:191], v[116:119], v[76:79]
v_mul_f32 v237, v235, v243
s_waitcnt lgkmcnt(5)
v_mfma_f32_16x16x32_bf16 v[80:83], v[160:163], v[112:115], v[80:83]
ds_read_b128 v[188:191], v0 offset:52224
v_mul_f32 v240, 0xbfb8aa3b, v245
v_mfma_f32_16x16x32_bf16 v[84:87], v[160:163], v[116:119], v[84:87]
v_mul_f32 v241, v239, v245
v_mfma_f32_16x16x32_bf16 v[88:91], v[164:167], v[112:115], v[88:91]
ds_read_b128 v[160:163], v0 offset:53248
v_mfma_f32_16x16x32_bf16 v[92:95], v[164:167], v[116:119], v[92:95]
s_waitcnt lgkmcnt(5)
v_mfma_f32_16x16x32_bf16 v[96:99], v[168:171], v[112:115], v[96:99]
ds_read_b128 v[164:167], v0 offset:54272
v_mfma_f32_16x16x32_bf16 v[100:103], v[168:171], v[116:119], v[100:103]
v_mfma_f32_16x16x32_bf16 v[104:107], v[172:175], v[112:115], v[104:107]
ds_read_b128 v[168:171], v0 offset:55296
v_mfma_f32_16x16x32_bf16 v[108:111], v[172:175], v[116:119], v[108:111]
s_waitcnt lgkmcnt(5)
s_waitcnt vmcnt(13)
v_mfma_f32_16x16x32_bf16 v[16:19], v[176:179], v[120:123], v[16:19]
ds_read_b128 v[172:175], v0 offset:56320
s_waitcnt vmcnt(12)
v_mfma_f32_16x16x32_bf16 v[20:23], v[176:179], v[124:127], v[20:23]
v_mfma_f32_16x16x32_bf16 v[24:27], v[180:183], v[120:123], v[24:27]
ds_read_b128 v[176:179], v0 offset:57344
v_mfma_f32_16x16x32_bf16 v[28:31], v[180:183], v[124:127], v[28:31]
s_waitcnt lgkmcnt(5)
v_mfma_f32_16x16x32_bf16 v[32:35], v[184:187], v[120:123], v[32:35]
ds_read_b128 v[180:183], v0 offset:58368
v_mfma_f32_16x16x32_bf16 v[36:39], v[184:187], v[124:127], v[36:39]
v_mfma_f32_16x16x32_bf16 v[40:43], v[188:191], v[120:123], v[40:43]
ds_read_b128 v[184:187], v0 offset:59392
v_mfma_f32_16x16x32_bf16 v[44:47], v[188:191], v[124:127], v[44:47]
s_waitcnt lgkmcnt(5)
v_mfma_f32_16x16x32_bf16 v[48:51], v[160:163], v[120:123], v[48:51]
ds_read_b128 v[188:191], v0 offset:60416
v_mfma_f32_16x16x32_bf16 v[52:55], v[160:163], v[124:127], v[52:55]
v_mfma_f32_16x16x32_bf16 v[56:59], v[164:167], v[120:123], v[56:59]
v_mfma_f32_16x16x32_bf16 v[60:63], v[164:167], v[124:127], v[60:63]
s_waitcnt lgkmcnt(4)
v_mfma_f32_16x16x32_bf16 v[64:67], v[168:171], v[120:123], v[64:67]
s_waitcnt vmcnt(6)
s_barrier
v_mfma_f32_16x16x32_bf16 v[68:71], v[168:171], v[124:127], v[68:71]
ds_read_b128 v[160:163], v0 offset:61440
ds_read_b128 v[164:167], v0 offset:62464
v_mfma_f32_16x16x32_bf16 v[72:75], v[172:175], v[120:123], v[72:75]
ds_read_b128 v[168:171], v0 offset:63488
v_mfma_f32_16x16x32_bf16 v[76:79], v[172:175], v[124:127], v[76:79]
ds_read_b128 v[144:147], v232 offset:0
s_waitcnt lgkmcnt(6)
v_mfma_f32_16x16x32_bf16 v[80:83], v[176:179], v[120:123], v[80:83]
ds_read_b128 v[172:175], v0 offset:64512
ds_read_b128 v[148:151], v232 offset:64
v_mfma_f32_16x16x32_bf16 v[84:87], v[176:179], v[124:127], v[84:87]
ds_read_b128 v[152:155], v232 offset:128
ds_read_b128 v[156:159], v232 offset:192
v_mfma_f32_16x16x32_bf16 v[88:91], v[180:183], v[120:123], v[88:91]
ds_read_b128 v[176:179], v4 offset:0
ds_read_b128 v[192:195], v232 offset:256
v_mfma_f32_16x16x32_bf16 v[92:95], v[180:183], v[124:127], v[92:95]
ds_read_b128 v[196:199], v232 offset:320
s_waitcnt lgkmcnt(11)
v_mfma_f32_16x16x32_bf16 v[96:99], v[184:187], v[120:123], v[96:99]
ds_read_b128 v[180:183], v4 offset:1024
ds_read_b128 v[200:203], v232 offset:384
v_mfma_f32_16x16x32_bf16 v[100:103], v[184:187], v[124:127], v[100:103]
ds_read_b128 v[204:207], v232 offset:448
ds_read_b128 v[208:211], v232 offset:512
v_mfma_f32_16x16x32_bf16 v[104:107], v[188:191], v[120:123], v[104:107]
ds_read_b128 v[184:187], v4 offset:2048
ds_read_b128 v[212:215], v232 offset:576
v_mfma_f32_16x16x32_bf16 v[108:111], v[188:191], v[124:127], v[108:111]
ds_read_b128 v[216:219], v232 offset:640
s_waitcnt lgkmcnt(15)
s_waitcnt vmcnt(5)
v_mfma_f32_16x16x32_bf16 v[16:19], v[160:163], v[128:131], v[16:19]
ds_read_b128 v[188:191], v4 offset:3072
ds_read_b128 v[220:223], v232 offset:704
s_waitcnt vmcnt(4)
v_mfma_f32_16x16x32_bf16 v[20:23], v[160:163], v[132:135], v[20:23]
v_mfma_f32_16x16x32_bf16 v[24:27], v[164:167], v[128:131], v[24:27]
ds_read_b128 v[160:163], v4 offset:4096
v_mfma_f32_16x16x32_bf16 v[28:31], v[164:167], v[132:135], v[28:31]
s_waitcnt lgkmcnt(15)
v_mfma_f32_16x16x32_bf16 v[32:35], v[168:171], v[128:131], v[32:35]
ds_read_b128 v[164:167], v4 offset:5120
v_mfma_f32_16x16x32_bf16 v[36:39], v[168:171], v[132:135], v[36:39]
v_mfma_f32_16x16x32_bf16 v[40:43], v[172:175], v[128:131], v[40:43]
ds_read_b128 v[168:171], v4 offset:6144
v_mfma_f32_16x16x32_bf16 v[44:47], v[172:175], v[132:135], v[44:47]
s_waitcnt lgkmcnt(11)
v_mfma_f32_16x16x32_bf16 v[48:51], v[176:179], v[128:131], v[48:51]
ds_read_b128 v[172:175], v4 offset:7168
v_mfma_f32_16x16x32_bf16 v[52:55], v[176:179], v[132:135], v[52:55]
v_mfma_f32_16x16x32_bf16 v[56:59], v[180:183], v[128:131], v[56:59]
ds_read_b128 v[176:179], v4 offset:8192
v_mfma_f32_16x16x32_bf16 v[60:63], v[180:183], v[132:135], v[60:63]
s_waitcnt lgkmcnt(6)
v_mfma_f32_16x16x32_bf16 v[64:67], v[184:187], v[128:131], v[64:67]
ds_read_b128 v[180:183], v4 offset:9216
v_mfma_f32_16x16x32_bf16 v[68:71], v[184:187], v[132:135], v[68:71]
v_mfma_f32_16x16x32_bf16 v[72:75], v[188:191], v[128:131], v[72:75]
ds_read_b128 v[184:187], v4 offset:10240
v_mfma_f32_16x16x32_bf16 v[76:79], v[188:191], v[132:135], v[76:79]
s_waitcnt lgkmcnt(5)
v_mfma_f32_16x16x32_bf16 v[80:83], v[160:163], v[128:131], v[80:83]
ds_read_b128 v[188:191], v4 offset:11264
v_mfma_f32_16x16x32_bf16 v[84:87], v[160:163], v[132:135], v[84:87]
v_mfma_f32_16x16x32_bf16 v[88:91], v[164:167], v[128:131], v[88:91]
ds_read_b128 v[160:163], v4 offset:12288
v_mfma_f32_16x16x32_bf16 v[92:95], v[164:167], v[132:135], v[92:95]
s_waitcnt lgkmcnt(5)
v_mfma_f32_16x16x32_bf16 v[96:99], v[168:171], v[128:131], v[96:99]
ds_read_b128 v[164:167], v4 offset:13312
v_mfma_f32_16x16x32_bf16 v[100:103], v[168:171], v[132:135], v[100:103]
v_mfma_f32_16x16x32_bf16 v[104:107], v[172:175], v[128:131], v[104:107]
ds_read_b128 v[168:171], v4 offset:14336
v_mfma_f32_16x16x32_bf16 v[108:111], v[172:175], v[132:135], v[108:111]
s_waitcnt lgkmcnt(5)
s_waitcnt vmcnt(3)
v_mfma_f32_16x16x32_bf16 v[16:19], v[176:179], v[136:139], v[16:19]
ds_read_b128 v[172:175], v4 offset:15360
s_waitcnt vmcnt(2)
v_mfma_f32_16x16x32_bf16 v[20:23], v[176:179], v[140:143], v[20:23]
v_mfma_f32_16x16x32_bf16 v[24:27], v[180:183], v[136:139], v[24:27]
ds_read_b128 v[176:179], v4 offset:16384
v_mfma_f32_16x16x32_bf16 v[28:31], v[180:183], v[140:143], v[28:31]
s_waitcnt lgkmcnt(5)
v_mfma_f32_16x16x32_bf16 v[32:35], v[184:187], v[136:139], v[32:35]
ds_read_b128 v[180:183], v4 offset:17408
v_mfma_f32_16x16x32_bf16 v[36:39], v[184:187], v[140:143], v[36:39]
v_mfma_f32_16x16x32_bf16 v[40:43], v[188:191], v[136:139], v[40:43]
ds_read_b128 v[184:187], v4 offset:18432
v_mfma_f32_16x16x32_bf16 v[44:47], v[188:191], v[140:143], v[44:47]
s_waitcnt lgkmcnt(5)
v_mfma_f32_16x16x32_bf16 v[48:51], v[160:163], v[136:139], v[48:51]
ds_read_b128 v[188:191], v4 offset:19456
v_mfma_f32_16x16x32_bf16 v[52:55], v[160:163], v[140:143], v[52:55]
v_mfma_f32_16x16x32_bf16 v[56:59], v[164:167], v[136:139], v[56:59]
v_mfma_f32_16x16x32_bf16 v[60:63], v[164:167], v[140:143], v[60:63]
s_waitcnt lgkmcnt(4)
v_mfma_f32_16x16x32_bf16 v[64:67], v[168:171], v[136:139], v[64:67]
v_mfma_f32_16x16x32_bf16 v[68:71], v[168:171], v[140:143], v[68:71]
v_mfma_f32_16x16x32_bf16 v[72:75], v[172:175], v[136:139], v[72:75]
v_mfma_f32_16x16x32_bf16 v[76:79], v[172:175], v[140:143], v[76:79]
s_waitcnt lgkmcnt(2)
v_mfma_f32_16x16x32_bf16 v[80:83], v[176:179], v[136:139], v[80:83]
v_mfma_f32_16x16x32_bf16 v[84:87], v[176:179], v[140:143], v[84:87]
v_mfma_f32_16x16x32_bf16 v[88:91], v[180:183], v[136:139], v[88:91]
v_mfma_f32_16x16x32_bf16 v[92:95], v[180:183], v[140:143], v[92:95]
s_waitcnt lgkmcnt(0)
v_mfma_f32_16x16x32_bf16 v[96:99], v[184:187], v[136:139], v[96:99]
v_mfma_f32_16x16x32_bf16 v[100:103], v[184:187], v[140:143], v[100:103]
v_mfma_f32_16x16x32_bf16 v[104:107], v[188:191], v[136:139], v[104:107]
v_mfma_f32_16x16x32_bf16 v[108:111], v[188:191], v[140:143], v[108:111]
C_p3e1:
v_pk_fma_f32 v[16:17], v[144:145], v[242:243], v[16:17] op_sel_hi:[1,0,1] neg_lo:[0,1,0] neg_hi:[0,1,0]
v_pk_fma_f32 v[18:19], v[146:147], v[242:243], v[18:19] op_sel_hi:[1,0,1] neg_lo:[0,1,0] neg_hi:[0,1,0]
v_pk_fma_f32 v[32:33], v[152:153], v[242:243], v[32:33] op_sel_hi:[1,0,1] neg_lo:[0,1,0] neg_hi:[0,1,0]
v_pk_fma_f32 v[34:35], v[154:155], v[242:243], v[34:35] op_sel_hi:[1,0,1] neg_lo:[0,1,0] neg_hi:[0,1,0]
v_pk_mul_f32 v[16:17], v[16:17], v[236:237] op_sel_hi:[1,0]
v_pk_mul_f32 v[18:19], v[18:19], v[236:237] op_sel_hi:[1,0]
v_pk_mul_f32 v[32:33], v[32:33], v[236:237] op_sel_hi:[1,0]
v_pk_mul_f32 v[34:35], v[34:35], v[236:237] op_sel_hi:[1,0]
v_exp_f32 v16, v16
v_exp_f32 v17, v17
v_pk_fma_f32 v[24:25], v[148:149], v[242:243], v[24:25] op_sel_hi:[1,0,1] neg_lo:[0,1,0] neg_hi:[0,1,0]
v_exp_f32 v18, v18
v_exp_f32 v19, v19
v_pk_fma_f32 v[26:27], v[150:151], v[242:243], v[26:27] op_sel_hi:[1,0,1] neg_lo:[0,1,0] neg_hi:[0,1,0]
v_exp_f32 v32, v32
v_exp_f32 v33, v33
v_pk_fma_f32 v[40:41], v[156:157], v[242:243], v[40:41] op_sel_hi:[1,0,1] neg_lo:[0,1,0] neg_hi:[0,1,0]
v_exp_f32 v34, v34
v_exp_f32 v35, v35
v_pk_fma_f32 v[42:43], v[158:159], v[242:243], v[42:43] op_sel_hi:[1,0,1] neg_lo:[0,1,0] neg_hi:[0,1,0]
v_pk_fma_f32 v[16:17], v[16:17], v[236:237], v[236:237] op_sel:[0,1,1] op_sel_hi:[1,1,1]
v_pk_fma_f32 v[18:19], v[18:19], v[236:237], v[236:237] op_sel:[0,1,1] op_sel_hi:[1,1,1]
v_pk_fma_f32 v[32:33], v[32:33], v[236:237], v[236:237] op_sel:[0,1,1] op_sel_hi:[1,1,1]
v_pk_fma_f32 v[34:35], v[34:35], v[236:237], v[236:237] op_sel:[0,1,1] op_sel_hi:[1,1,1]
v_rcp_f32 v16, v16
v_rcp_f32 v17, v17
v_rcp_f32 v18, v18
v_rcp_f32 v19, v19
v_rcp_f32 v32, v32
v_rcp_f32 v33, v33
v_rcp_f32 v34, v34
v_rcp_f32 v35, v35
v_pk_mul_f32 v[24:25], v[24:25], v[16:17]
v_pk_mul_f32 v[26:27], v[26:27], v[18:19]
v_pk_mul_f32 v[40:41], v[40:41], v[32:33]
v_pk_mul_f32 v[42:43], v[42:43], v[34:35]
v_cvt_pk_bf16_f32 v112, v24, v25
v_cvt_pk_bf16_f32 v113, v26, v27
v_cvt_pk_bf16_f32 v114, v40, v41
v_cvt_pk_bf16_f32 v115, v42, v43
buffer_store_dwordx4 v[112:115], v0, s[4:7], s39 offen offset:0
v_pk_fma_f32 v[20:21], v[144:145], v[244:245], v[20:21] op_sel_hi:[1,0,1] neg_lo:[0,1,0] neg_hi:[0,1,0]
v_pk_fma_f32 v[22:23], v[146:147], v[244:245], v[22:23] op_sel_hi:[1,0,1] neg_lo:[0,1,0] neg_hi:[0,1,0]
v_pk_fma_f32 v[36:37], v[152:153], v[244:245], v[36:37] op_sel_hi:[1,0,1] neg_lo:[0,1,0] neg_hi:[0,1,0]
v_pk_fma_f32 v[38:39], v[154:155], v[244:245], v[38:39] op_sel_hi:[1,0,1] neg_lo:[0,1,0] neg_hi:[0,1,0]
v_pk_mul_f32 v[20:21], v[20:21], v[240:241] op_sel_hi:[1,0]
v_pk_mul_f32 v[22:23], v[22:23], v[240:241] op_sel_hi:[1,0]
v_pk_mul_f32 v[36:37], v[36:37], v[240:241] op_sel_hi:[1,0]
v_pk_mul_f32 v[38:39], v[38:39], v[240:241] op_sel_hi:[1,0]
v_exp_f32 v20, v20
v_exp_f32 v21, v21
v_pk_fma_f32 v[28:29], v[148:149], v[244:245], v[28:29] op_sel_hi:[1,0,1] neg_lo:[0,1,0] neg_hi:[0,1,0]
v_exp_f32 v22, v22
v_exp_f32 v23, v23
v_pk_fma_f32 v[30:31], v[150:151], v[244:245], v[30:31] op_sel_hi:[1,0,1] neg_lo:[0,1,0] neg_hi:[0,1,0]
v_exp_f32 v36, v36
v_exp_f32 v37, v37
v_pk_fma_f32 v[44:45], v[156:157], v[244:245], v[44:45] op_sel_hi:[1,0,1] neg_lo:[0,1,0] neg_hi:[0,1,0]
v_exp_f32 v38, v38
v_exp_f32 v39, v39
v_pk_fma_f32 v[46:47], v[158:159], v[244:245], v[46:47] op_sel_hi:[1,0,1] neg_lo:[0,1,0] neg_hi:[0,1,0]
v_pk_fma_f32 v[20:21], v[20:21], v[240:241], v[240:241] op_sel:[0,1,1] op_sel_hi:[1,1,1]
v_pk_fma_f32 v[22:23], v[22:23], v[240:241], v[240:241] op_sel:[0,1,1] op_sel_hi:[1,1,1]
v_pk_fma_f32 v[36:37], v[36:37], v[240:241], v[240:241] op_sel:[0,1,1] op_sel_hi:[1,1,1]
v_pk_fma_f32 v[38:39], v[38:39], v[240:241], v[240:241] op_sel:[0,1,1] op_sel_hi:[1,1,1]
v_rcp_f32 v20, v20
v_rcp_f32 v21, v21
v_rcp_f32 v22, v22
v_rcp_f32 v23, v23
v_rcp_f32 v36, v36
v_rcp_f32 v37, v37
v_rcp_f32 v38, v38
v_rcp_f32 v39, v39
v_pk_mul_f32 v[28:29], v[28:29], v[20:21]
v_pk_mul_f32 v[30:31], v[30:31], v[22:23]
v_pk_mul_f32 v[44:45], v[44:45], v[36:37]
v_pk_mul_f32 v[46:47], v[46:47], v[38:39]
v_cvt_pk_bf16_f32 v116, v28, v29
v_cvt_pk_bf16_f32 v117, v30, v31
v_cvt_pk_bf16_f32 v118, v44, v45
v_cvt_pk_bf16_f32 v119, v46, v47
buffer_store_dwordx4 v[116:119], v12, s[4:7], s39 offen offset:0
v_pk_fma_f32 v[48:49], v[192:193], v[242:243], v[48:49] op_sel_hi:[1,0,1] neg_lo:[0,1,0] neg_hi:[0,1,0]
v_pk_fma_f32 v[50:51], v[194:195], v[242:243], v[50:51] op_sel_hi:[1,0,1] neg_lo:[0,1,0] neg_hi:[0,1,0]
v_pk_fma_f32 v[64:65], v[200:201], v[242:243], v[64:65] op_sel_hi:[1,0,1] neg_lo:[0,1,0] neg_hi:[0,1,0]
v_pk_fma_f32 v[66:67], v[202:203], v[242:243], v[66:67] op_sel_hi:[1,0,1] neg_lo:[0,1,0] neg_hi:[0,1,0]
v_pk_mul_f32 v[48:49], v[48:49], v[236:237] op_sel_hi:[1,0]
v_pk_mul_f32 v[50:51], v[50:51], v[236:237] op_sel_hi:[1,0]
v_pk_mul_f32 v[64:65], v[64:65], v[236:237] op_sel_hi:[1,0]
v_pk_mul_f32 v[66:67], v[66:67], v[236:237] op_sel_hi:[1,0]
v_exp_f32 v48, v48
v_exp_f32 v49, v49
v_pk_fma_f32 v[56:57], v[196:197], v[242:243], v[56:57] op_sel_hi:[1,0,1] neg_lo:[0,1,0] neg_hi:[0,1,0]
v_exp_f32 v50, v50
v_exp_f32 v51, v51
v_pk_fma_f32 v[58:59], v[198:199], v[242:243], v[58:59] op_sel_hi:[1,0,1] neg_lo:[0,1,0] neg_hi:[0,1,0]
v_exp_f32 v64, v64
v_exp_f32 v65, v65
v_pk_fma_f32 v[72:73], v[204:205], v[242:243], v[72:73] op_sel_hi:[1,0,1] neg_lo:[0,1,0] neg_hi:[0,1,0]
v_exp_f32 v66, v66
v_exp_f32 v67, v67
v_pk_fma_f32 v[74:75], v[206:207], v[242:243], v[74:75] op_sel_hi:[1,0,1] neg_lo:[0,1,0] neg_hi:[0,1,0]
v_pk_fma_f32 v[48:49], v[48:49], v[236:237], v[236:237] op_sel:[0,1,1] op_sel_hi:[1,1,1]
v_pk_fma_f32 v[50:51], v[50:51], v[236:237], v[236:237] op_sel:[0,1,1] op_sel_hi:[1,1,1]
v_pk_fma_f32 v[64:65], v[64:65], v[236:237], v[236:237] op_sel:[0,1,1] op_sel_hi:[1,1,1]
v_pk_fma_f32 v[66:67], v[66:67], v[236:237], v[236:237] op_sel:[0,1,1] op_sel_hi:[1,1,1]
v_rcp_f32 v48, v48
v_rcp_f32 v49, v49
v_rcp_f32 v50, v50
v_rcp_f32 v51, v51
v_rcp_f32 v64, v64
v_rcp_f32 v65, v65
v_rcp_f32 v66, v66
v_rcp_f32 v67, v67
v_pk_mul_f32 v[56:57], v[56:57], v[48:49]
v_pk_mul_f32 v[58:59], v[58:59], v[50:51]
v_pk_mul_f32 v[72:73], v[72:73], v[64:65]
v_pk_mul_f32 v[74:75], v[74:75], v[66:67]
v_cvt_pk_bf16_f32 v120, v56, v57
v_cvt_pk_bf16_f32 v121, v58, v59
v_cvt_pk_bf16_f32 v122, v72, v73
v_cvt_pk_bf16_f32 v123, v74, v75
buffer_store_dwordx4 v[120:123], v0, s[4:7], s39 offen offset:1024
v_pk_fma_f32 v[52:53], v[192:193], v[244:245], v[52:53] op_sel_hi:[1,0,1] neg_lo:[0,1,0] neg_hi:[0,1,0]
v_pk_fma_f32 v[54:55], v[194:195], v[244:245], v[54:55] op_sel_hi:[1,0,1] neg_lo:[0,1,0] neg_hi:[0,1,0]
v_pk_fma_f32 v[68:69], v[200:201], v[244:245], v[68:69] op_sel_hi:[1,0,1] neg_lo:[0,1,0] neg_hi:[0,1,0]
v_pk_fma_f32 v[70:71], v[202:203], v[244:245], v[70:71] op_sel_hi:[1,0,1] neg_lo:[0,1,0] neg_hi:[0,1,0]
v_pk_mul_f32 v[52:53], v[52:53], v[240:241] op_sel_hi:[1,0]
v_pk_mul_f32 v[54:55], v[54:55], v[240:241] op_sel_hi:[1,0]
v_pk_mul_f32 v[68:69], v[68:69], v[240:241] op_sel_hi:[1,0]
v_pk_mul_f32 v[70:71], v[70:71], v[240:241] op_sel_hi:[1,0]
v_exp_f32 v52, v52
v_exp_f32 v53, v53
v_pk_fma_f32 v[60:61], v[196:197], v[244:245], v[60:61] op_sel_hi:[1,0,1] neg_lo:[0,1,0] neg_hi:[0,1,0]
v_exp_f32 v54, v54
v_exp_f32 v55, v55
v_pk_fma_f32 v[62:63], v[198:199], v[244:245], v[62:63] op_sel_hi:[1,0,1] neg_lo:[0,1,0] neg_hi:[0,1,0]
v_exp_f32 v68, v68
v_exp_f32 v69, v69
v_pk_fma_f32 v[76:77], v[204:205], v[244:245], v[76:77] op_sel_hi:[1,0,1] neg_lo:[0,1,0] neg_hi:[0,1,0]
v_exp_f32 v70, v70
v_exp_f32 v71, v71
v_pk_fma_f32 v[78:79], v[206:207], v[244:245], v[78:79] op_sel_hi:[1,0,1] neg_lo:[0,1,0] neg_hi:[0,1,0]
v_pk_fma_f32 v[52:53], v[52:53], v[240:241], v[240:241] op_sel:[0,1,1] op_sel_hi:[1,1,1]
v_pk_fma_f32 v[54:55], v[54:55], v[240:241], v[240:241] op_sel:[0,1,1] op_sel_hi:[1,1,1]
v_pk_fma_f32 v[68:69], v[68:69], v[240:241], v[240:241] op_sel:[0,1,1] op_sel_hi:[1,1,1]
v_pk_fma_f32 v[70:71], v[70:71], v[240:241], v[240:241] op_sel:[0,1,1] op_sel_hi:[1,1,1]
v_rcp_f32 v52, v52
v_rcp_f32 v53, v53
v_rcp_f32 v54, v54
v_rcp_f32 v55, v55
v_rcp_f32 v68, v68
v_rcp_f32 v69, v69
v_rcp_f32 v70, v70
v_rcp_f32 v71, v71
v_pk_mul_f32 v[60:61], v[60:61], v[52:53]
v_pk_mul_f32 v[62:63], v[62:63], v[54:55]
v_pk_mul_f32 v[76:77], v[76:77], v[68:69]
v_pk_mul_f32 v[78:79], v[78:79], v[70:71]
v_cvt_pk_bf16_f32 v124, v60, v61
v_cvt_pk_bf16_f32 v125, v62, v63
v_cvt_pk_bf16_f32 v126, v76, v77
v_cvt_pk_bf16_f32 v127, v78, v79
buffer_store_dwordx4 v[124:127], v12, s[4:7], s39 offen offset:1024
v_pk_fma_f32 v[80:81], v[208:209], v[242:243], v[80:81] op_sel_hi:[1,0,1] neg_lo:[0,1,0] neg_hi:[0,1,0]
v_pk_fma_f32 v[82:83], v[210:211], v[242:243], v[82:83] op_sel_hi:[1,0,1] neg_lo:[0,1,0] neg_hi:[0,1,0]
v_pk_fma_f32 v[96:97], v[216:217], v[242:243], v[96:97] op_sel_hi:[1,0,1] neg_lo:[0,1,0] neg_hi:[0,1,0]
v_pk_fma_f32 v[98:99], v[218:219], v[242:243], v[98:99] op_sel_hi:[1,0,1] neg_lo:[0,1,0] neg_hi:[0,1,0]
v_pk_mul_f32 v[80:81], v[80:81], v[236:237] op_sel_hi:[1,0]
v_pk_mul_f32 v[82:83], v[82:83], v[236:237] op_sel_hi:[1,0]
v_pk_mul_f32 v[96:97], v[96:97], v[236:237] op_sel_hi:[1,0]
v_pk_mul_f32 v[98:99], v[98:99], v[236:237] op_sel_hi:[1,0]
v_exp_f32 v80, v80
v_exp_f32 v81, v81
v_pk_fma_f32 v[88:89], v[212:213], v[242:243], v[88:89] op_sel_hi:[1,0,1] neg_lo:[0,1,0] neg_hi:[0,1,0]
v_exp_f32 v82, v82
v_exp_f32 v83, v83
v_pk_fma_f32 v[90:91], v[214:215], v[242:243], v[90:91] op_sel_hi:[1,0,1] neg_lo:[0,1,0] neg_hi:[0,1,0]
v_exp_f32 v96, v96
v_exp_f32 v97, v97
v_pk_fma_f32 v[104:105], v[220:221], v[242:243], v[104:105] op_sel_hi:[1,0,1] neg_lo:[0,1,0] neg_hi:[0,1,0]
v_exp_f32 v98, v98
v_exp_f32 v99, v99
v_pk_fma_f32 v[106:107], v[222:223], v[242:243], v[106:107] op_sel_hi:[1,0,1] neg_lo:[0,1,0] neg_hi:[0,1,0]
v_pk_fma_f32 v[80:81], v[80:81], v[236:237], v[236:237] op_sel:[0,1,1] op_sel_hi:[1,1,1]
v_pk_fma_f32 v[82:83], v[82:83], v[236:237], v[236:237] op_sel:[0,1,1] op_sel_hi:[1,1,1]
v_pk_fma_f32 v[96:97], v[96:97], v[236:237], v[236:237] op_sel:[0,1,1] op_sel_hi:[1,1,1]
v_pk_fma_f32 v[98:99], v[98:99], v[236:237], v[236:237] op_sel:[0,1,1] op_sel_hi:[1,1,1]
v_rcp_f32 v80, v80
v_rcp_f32 v81, v81
v_rcp_f32 v82, v82
v_rcp_f32 v83, v83
v_rcp_f32 v96, v96
v_rcp_f32 v97, v97
v_rcp_f32 v98, v98
v_rcp_f32 v99, v99
v_pk_mul_f32 v[88:89], v[88:89], v[80:81]
v_pk_mul_f32 v[90:91], v[90:91], v[82:83]
v_pk_mul_f32 v[104:105], v[104:105], v[96:97]
v_pk_mul_f32 v[106:107], v[106:107], v[98:99]
v_cvt_pk_bf16_f32 v128, v88, v89
v_cvt_pk_bf16_f32 v129, v90, v91
v_cvt_pk_bf16_f32 v130, v104, v105
v_cvt_pk_bf16_f32 v131, v106, v107
buffer_store_dwordx4 v[128:131], v0, s[4:7], s39 offen offset:2048
v_pk_fma_f32 v[84:85], v[208:209], v[244:245], v[84:85] op_sel_hi:[1,0,1] neg_lo:[0,1,0] neg_hi:[0,1,0]
v_pk_fma_f32 v[86:87], v[210:211], v[244:245], v[86:87] op_sel_hi:[1,0,1] neg_lo:[0,1,0] neg_hi:[0,1,0]
v_pk_fma_f32 v[100:101], v[216:217], v[244:245], v[100:101] op_sel_hi:[1,0,1] neg_lo:[0,1,0] neg_hi:[0,1,0]
v_pk_fma_f32 v[102:103], v[218:219], v[244:245], v[102:103] op_sel_hi:[1,0,1] neg_lo:[0,1,0] neg_hi:[0,1,0]
v_pk_mul_f32 v[84:85], v[84:85], v[240:241] op_sel_hi:[1,0]
v_pk_mul_f32 v[86:87], v[86:87], v[240:241] op_sel_hi:[1,0]
v_pk_mul_f32 v[100:101], v[100:101], v[240:241] op_sel_hi:[1,0]
v_pk_mul_f32 v[102:103], v[102:103], v[240:241] op_sel_hi:[1,0]
v_exp_f32 v84, v84
v_exp_f32 v85, v85
v_pk_fma_f32 v[92:93], v[212:213], v[244:245], v[92:93] op_sel_hi:[1,0,1] neg_lo:[0,1,0] neg_hi:[0,1,0]
v_exp_f32 v86, v86
v_exp_f32 v87, v87
v_pk_fma_f32 v[94:95], v[214:215], v[244:245], v[94:95] op_sel_hi:[1,0,1] neg_lo:[0,1,0] neg_hi:[0,1,0]
v_exp_f32 v100, v100
v_exp_f32 v101, v101
v_pk_fma_f32 v[108:109], v[220:221], v[244:245], v[108:109] op_sel_hi:[1,0,1] neg_lo:[0,1,0] neg_hi:[0,1,0]
v_exp_f32 v102, v102
v_exp_f32 v103, v103
v_pk_fma_f32 v[110:111], v[222:223], v[244:245], v[110:111] op_sel_hi:[1,0,1] neg_lo:[0,1,0] neg_hi:[0,1,0]
v_pk_fma_f32 v[84:85], v[84:85], v[240:241], v[240:241] op_sel:[0,1,1] op_sel_hi:[1,1,1]
v_pk_fma_f32 v[86:87], v[86:87], v[240:241], v[240:241] op_sel:[0,1,1] op_sel_hi:[1,1,1]
v_pk_fma_f32 v[100:101], v[100:101], v[240:241], v[240:241] op_sel:[0,1,1] op_sel_hi:[1,1,1]
v_pk_fma_f32 v[102:103], v[102:103], v[240:241], v[240:241] op_sel:[0,1,1] op_sel_hi:[1,1,1]
v_rcp_f32 v84, v84
v_rcp_f32 v85, v85
v_rcp_f32 v86, v86
v_rcp_f32 v87, v87
v_rcp_f32 v100, v100
v_rcp_f32 v101, v101
v_rcp_f32 v102, v102
v_rcp_f32 v103, v103
v_pk_mul_f32 v[92:93], v[92:93], v[84:85]
v_pk_mul_f32 v[94:95], v[94:95], v[86:87]
v_pk_mul_f32 v[108:109], v[108:109], v[100:101]
v_pk_mul_f32 v[110:111], v[110:111], v[102:103]
v_cvt_pk_bf16_f32 v132, v92, v93
v_cvt_pk_bf16_f32 v133, v94, v95
v_cvt_pk_bf16_f32 v134, v108, v109
v_cvt_pk_bf16_f32 v135, v110, v111
buffer_store_dwordx4 v[132:135], v12, s[4:7], s39 offen offset:2048
s_add_u32 s48, s12, 1
s_and_b32 s48, s48, 3
s_mul_i32 s48, s48, 15360
s_add_u32 s48, s48, 98304
s_waitcnt vmcnt(7)
v_add_u32 v228, s48, v0
s_add_u32 s48, s12, 2
s_and_b32 s48, s48, 3
s_mul_i32 s48, s48, 15360
s_add_u32 s48, s48, 103424
v_add_u32 v229, s48, v0
s_add_u32 s48, s12, 3
s_and_b32 s48, s48, 3
s_mul_i32 s48, s48, 15360
s_add_u32 s48, s48, 108544
v_add_u32 v230, s48, v0
s_mul_i32 s48, s12, 15360
s_add_u32 s48, s48, 98304
v_add_u32 v231, s48, v0
v_lshlrev_b32 v232, 5, v9
v_and_b32 v233, 0x180, v232
s_lshl_b32 s54, s14, 2
s_add_u32 s54, s54, s40
s_add_u32 s54, s54, 12288
s_waitcnt vmcnt(0)
s_barrier
s_cmp_lg_u32 s12, 0
s_cbranch_scc1 SY52
s_mov_b64 exec, 1
s_cmp_eq_u32 s15, 0
s_cbranch_scc1 SY54
buffer_store_dword v10, off, s[4:7], s54
s_branch SY55
SY54:
buffer_wbl2 sc1
s_waitcnt vmcnt(0)
buffer_store_dword v10, off, s[4:7], s54 sc1
SY55:
s_mov_b64 exec, -1
s_add_u32 s48, s40, 12288
PL56:
buffer_load_dword v18, v9, s[4:7], s48 offen sc1
s_waitcnt vmcnt(0)
v_cmp_ne_u32 vcc, s89, v18
s_nop 1
s_cmp_eq_u64 vcc, 0
s_cbranch_scc1 PL57
s_sub_u32 s45, s45, 1
s_cbranch_scc0 PL56
s_mov_b32 s45, 0
PL57:
s_cmp_lg_u32 s15, 0
s_cbranch_scc1 SY53
buffer_inv sc1
s_waitcnt vmcnt(0)
s_branch SY53
SY52:
SY53:
s_barrier
s_add_u32 s51, s26, 5242880
buffer_load_dwordx4 v[56:59], v0, s[4:7], s51 offen offset:0 sc1
buffer_load_dwordx4 v[60:63], v0, s[4:7], s51 offen offset:1024 sc1
buffer_load_dwordx4 v[64:67], v0, s[4:7], s51 offen offset:2048 sc1
buffer_load_dwordx4 v[68:71], v0, s[4:7], s51 offen offset:3072 sc1
s_add_u32 s51, s26, 5246976
buffer_load_dwordx4 v[72:75], v0, s[4:7], s51 offen offset:0 sc1
buffer_load_dwordx4 v[76:79], v0, s[4:7], s51 offen offset:1024 sc1
s_waitcnt vmcnt(5)
v_mfma_f32_16x16x32_bf16 v[16:19], a[0:3], v[56:59], 0
buffer_load_dwordx4 v[80:83], v0, s[4:7], s51 offen offset:2048 sc1
v_mfma_f32_16x16x32_bf16 v[20:23], a[4:7], v[56:59], 0
v_mfma_f32_16x16x32_bf16 v[24:27], a[8:11], v[56:59], 0
v_mfma_f32_16x16x32_bf16 v[28:31], a[12:15], v[56:59], 0
v_mfma_f32_16x16x32_bf16 v[32:35], a[16:19], v[56:59], 0
s_waitcnt vmcnt(5)
v_mfma_f32_16x16x32_bf16 v[16:19], a[20:23], v[60:63], v[16:19]
buffer_load_dwordx4 v[84:87], v0, s[4:7], s51 offen offset:3072 sc1
v_mfma_f32_16x16x32_bf16 v[20:23], a[24:27], v[60:63], v[20:23]
s_add_u32 s51, s26, 5251072
v_mfma_f32_16x16x32_bf16 v[24:27], a[28:31], v[60:63], v[24:27]
v_mfma_f32_16x16x32_bf16 v[28:31], a[32:35], v[60:63], v[28:31]
v_mfma_f32_16x16x32_bf16 v[32:35], a[36:39], v[60:63], v[32:35]
s_waitcnt vmcnt(5)
v_mfma_f32_16x16x32_bf16 v[16:19], a[40:43], v[64:67], v[16:19]
buffer_load_dwordx4 v[88:91], v0, s[4:7], s51 offen offset:0 sc1
v_mfma_f32_16x16x32_bf16 v[20:23], a[44:47], v[64:67], v[20:23]
v_mfma_f32_16x16x32_bf16 v[24:27], a[48:51], v[64:67], v[24:27]
v_mfma_f32_16x16x32_bf16 v[28:31], a[52:55], v[64:67], v[28:31]
v_mfma_f32_16x16x32_bf16 v[32:35], a[56:59], v[64:67], v[32:35]
s_waitcnt vmcnt(5)
v_mfma_f32_16x16x32_bf16 v[16:19], a[60:63], v[68:71], v[16:19]
buffer_load_dwordx4 v[92:95], v0, s[4:7], s51 offen offset:1024 sc1
v_mfma_f32_16x16x32_bf16 v[20:23], a[64:67], v[68:71], v[20:23]
v_mfma_f32_16x16x32_bf16 v[24:27], a[68:71], v[68:71], v[24:27]
v_mfma_f32_16x16x32_bf16 v[28:31], a[72:75], v[68:71], v[28:31]
v_mfma_f32_16x16x32_bf16 v[32:35], a[76:79], v[68:71], v[32:35]
s_waitcnt vmcnt(5)
v_mfma_f32_16x16x32_bf16 v[16:19], a[80:83], v[72:75], v[16:19]
buffer_load_dwordx4 v[96:99], v0, s[4:7], s51 offen offset:2048 sc1
v_mfma_f32_16x16x32_bf16 v[20:23], a[84:87], v[72:75], v[20:23]
v_mfma_f32_16x16x32_bf16 v[24:27], a[88:91], v[72:75], v[24:27]
v_mfma_f32_16x16x32_bf16 v[28:31], a[92:95], v[72:75], v[28:31]
v_mfma_f32_16x16x32_bf16 v[32:35], a[96:99], v[72:75], v[32:35]
s_waitcnt vmcnt(5)
v_mfma_f32_16x16x32_bf16 v[16:19], a[100:103], v[76:79], v[16:19]
buffer_load_dwordx4 v[100:103], v0, s[4:7], s51 offen offset:3072 sc1
v_mfma_f32_16x16x32_bf16 v[20:23], a[104:107], v[76:79], v[20:23]
s_add_u32 s51, s27, 5242880
v_mfma_f32_16x16x32_bf16 v[24:27], a[108:111], v[76:79], v[24:27]
v_mfma_f32_16x16x32_bf16 v[28:31], a[112:115], v[76:79], v[28:31]
v_mfma_f32_16x16x32_bf16 v[32:35], a[116:119], v[76:79], v[32:35]
s_waitcnt vmcnt(5)
v_mfma_f32_16x16x32_bf16 v[16:19], a[120:123], v[80:83], v[16:19]
buffer_load_dwordx4 v[104:107], v0, s[4:7], s51 offen offset:0 sc1
v_mfma_f32_16x16x32_bf16 v[20:23], a[124:127], v[80:83], v[20:23]
v_mfma_f32_16x16x32_bf16 v[24:27], a[128:131], v[80:83], v[24:27]
v_mfma_f32_16x16x32_bf16 v[28:31], a[132:135], v[80:83], v[28:31]
v_mfma_f32_16x16x32_bf16 v[32:35], a[136:139], v[80:83], v[32:35]
s_waitcnt vmcnt(5)
v_mfma_f32_16x16x32_bf16 v[16:19], a[140:143], v[84:87], v[16:19]
buffer_load_dwordx4 v[108:111], v0, s[4:7], s51 offen offset:1024 sc1
v_mfma_f32_16x16x32_bf16 v[20:23], a[144:147], v[84:87], v[20:23]
v_mfma_f32_16x16x32_bf16 v[24:27], a[148:151], v[84:87], v[24:27]
v_mfma_f32_16x16x32_bf16 v[28:31], a[152:155], v[84:87], v[28:31]
v_mfma_f32_16x16x32_bf16 v[32:35], a[156:159], v[84:87], v[32:35]
s_waitcnt vmcnt(5)
v_mfma_f32_16x16x32_bf16 v[16:19], a[160:163], v[88:91], v[16:19]
buffer_load_dwordx4 v[112:115], v0, s[4:7], s51 offen offset:2048 sc1
v_mfma_f32_16x16x32_bf16 v[20:23], a[164:167], v[88:91], v[20:23]
v_mfma_f32_16x16x32_bf16 v[24:27], a[168:171], v[88:91], v[24:27]
v_mfma_f32_16x16x32_bf16 v[28:31], a[172:175], v[88:91], v[28:31]
v_mfma_f32_16x16x32_bf16 v[32:35], a[176:179], v[88:91], v[32:35]
s_waitcnt vmcnt(5)
v_mfma_f32_16x16x32_bf16 v[16:19], a[180:183], v[92:95], v[16:19]
buffer_load_dwordx4 v[116:119], v0, s[4:7], s51 offen offset:3072 sc1
v_mfma_f32_16x16x32_bf16 v[20:23], a[184:187], v[92:95], v[20:23]
s_add_u32 s51, s27, 5246976
v_mfma_f32_16x16x32_bf16 v[24:27], a[188:191], v[92:95], v[24:27]
v_mfma_f32_16x16x32_bf16 v[28:31], a[192:195], v[92:95], v[28:31]
v_mfma_f32_16x16x32_bf16 v[32:35], a[196:199], v[92:95], v[32:35]
s_waitcnt vmcnt(5)
v_mfma_f32_16x16x32_bf16 v[16:19], a[200:203], v[96:99], v[16:19]
buffer_load_dwordx4 v[120:123], v0, s[4:7], s51 offen offset:0 sc1
v_mfma_f32_16x16x32_bf16 v[20:23], a[204:207], v[96:99], v[20:23]
v_mfma_f32_16x16x32_bf16 v[24:27], a[208:211], v[96:99], v[24:27]
v_mfma_f32_16x16x32_bf16 v[28:31], a[212:215], v[96:99], v[28:31]
v_mfma_f32_16x16x32_bf16 v[32:35], a[216:219], v[96:99], v[32:35]
s_waitcnt vmcnt(5)
v_mfma_f32_16x16x32_bf16 v[16:19], a[220:223], v[100:103], v[16:19]
buffer_load_dwordx4 v[124:127], v0, s[4:7], s51 offen offset:1024 sc1
v_mfma_f32_16x16x32_bf16 v[20:23], a[224:227], v[100:103], v[20:23]
v_mfma_f32_16x16x32_bf16 v[24:27], a[228:231], v[100:103], v[24:27]
v_mfma_f32_16x16x32_bf16 v[28:31], a[232:235], v[100:103], v[28:31]
v_mfma_f32_16x16x32_bf16 v[32:35], a[236:239], v[100:103], v[32:35]
s_waitcnt vmcnt(5)
v_mfma_f32_16x16x32_bf16 v[36:39], a[0:3], v[104:107], 0
buffer_load_dwordx4 v[128:131], v0, s[4:7], s51 offen offset:2048 sc1
v_mfma_f32_16x16x32_bf16 v[40:43], a[4:7], v[104:107], 0
v_mfma_f32_16x16x32_bf16 v[44:47], a[8:11], v[104:107], 0
v_mfma_f32_16x16x32_bf16 v[48:51], a[12:15], v[104:107], 0
ds_write_b128 v228, v[16:19] offset:0
v_mfma_f32_16x16x32_bf16 v[52:55], a[16:19], v[104:107], 0
s_waitcnt vmcnt(5)
v_mfma_f32_16x16x32_bf16 v[36:39], a[20:23], v[108:111], v[36:39]
buffer_load_dwordx4 v[132:135], v0, s[4:7], s51 offen offset:3072 sc1
v_mfma_f32_16x16x32_bf16 v[40:43], a[24:27], v[108:111], v[40:43]
s_add_u32 s51, s27, 5251072
v_mfma_f32_16x16x32_bf16 v[44:47], a[28:31], v[108:111], v[44:47]
ds_write_b128 v228, v[20:23] offset:1024
v_mfma_f32_16x16x32_bf16 v[48:51], a[32:35], v[108:111], v[48:51]
ds_write_b128 v228, v[24:27] offset:2048
v_mfma_f32_16x16x32_bf16 v[52:55], a[36:39], v[108:111], v[52:55]
s_waitcnt vmcnt(5)
v_mfma_f32_16x16x32_bf16 v[36:39], a[40:43], v[112:115], v[36:39]
buffer_load_dwordx4 v[136:139], v0, s[4:7], s51 offen offset:0 sc1
v_mfma_f32_16x16x32_bf16 v[40:43], a[44:47], v[112:115], v[40:43]
ds_write_b128 v228, v[28:31] offset:3072
v_mfma_f32_16x16x32_bf16 v[44:47], a[48:51], v[112:115], v[44:47]
ds_write_b128 v228, v[32:35] offset:4096
v_mfma_f32_16x16x32_bf16 v[48:51], a[52:55], v[112:115], v[48:51]
v_mfma_f32_16x16x32_bf16 v[52:55], a[56:59], v[112:115], v[52:55]
s_waitcnt vmcnt(5)
v_mfma_f32_16x16x32_bf16 v[36:39], a[60:63], v[116:119], v[36:39]
buffer_load_dwordx4 v[140:143], v0, s[4:7], s51 offen offset:1024 sc1
v_mfma_f32_16x16x32_bf16 v[40:43], a[64:67], v[116:119], v[40:43]
v_mfma_f32_16x16x32_bf16 v[44:47], a[68:71], v[116:119], v[44:47]
v_mfma_f32_16x16x32_bf16 v[48:51], a[72:75], v[116:119], v[48:51]
v_mfma_f32_16x16x32_bf16 v[52:55], a[76:79], v[116:119], v[52:55]
s_waitcnt vmcnt(5)
v_mfma_f32_16x16x32_bf16 v[36:39], a[80:83], v[120:123], v[36:39]
buffer_load_dwordx4 v[144:147], v0, s[4:7], s51 offen offset:2048 sc1
v_mfma_f32_16x16x32_bf16 v[40:43], a[84:87], v[120:123], v[40:43]
v_mfma_f32_16x16x32_bf16 v[44:47], a[88:91], v[120:123], v[44:47]
v_mfma_f32_16x16x32_bf16 v[48:51], a[92:95], v[120:123], v[48:51]
v_mfma_f32_16x16x32_bf16 v[52:55], a[96:99], v[120:123], v[52:55]
s_waitcnt vmcnt(5)
v_mfma_f32_16x16x32_bf16 v[36:39], a[100:103], v[124:127], v[36:39]
buffer_load_dwordx4 v[148:151], v0, s[4:7], s51 offen offset:3072 sc1
v_mfma_f32_16x16x32_bf16 v[40:43], a[104:107], v[124:127], v[40:43]
s_add_u32 s51, s28, 5242880
v_mfma_f32_16x16x32_bf16 v[44:47], a[108:111], v[124:127], v[44:47]
v_mfma_f32_16x16x32_bf16 v[48:51], a[112:115], v[124:127], v[48:51]
v_mfma_f32_16x16x32_bf16 v[52:55], a[116:119], v[124:127], v[52:55]
s_waitcnt vmcnt(5)
v_mfma_f32_16x16x32_bf16 v[36:39], a[120:123], v[128:131], v[36:39]
buffer_load_dwordx4 v[56:59], v0, s[4:7], s51 offen offset:0 sc1
v_mfma_f32_16x16x32_bf16 v[40:43], a[124:127], v[128:131], v[40:43]
v_mfma_f32_16x16x32_bf16 v[44:47], a[128:131], v[128:131], v[44:47]
v_mfma_f32_16x16x32_bf16 v[48:51], a[132:135], v[128:131], v[48:51]
v_mfma_f32_16x16x32_bf16 v[52:55], a[136:139], v[128:131], v[52:55]
s_waitcnt vmcnt(5)
v_mfma_f32_16x16x32_bf16 v[36:39], a[140:143], v[132:135], v[36:39]
buffer_load_dwordx4 v[60:63], v0, s[4:7], s51 offen offset:1024 sc1
v_mfma_f32_16x16x32_bf16 v[40:43], a[144:147], v[132:135], v[40:43]
v_mfma_f32_16x16x32_bf16 v[44:47], a[148:151], v[132:135], v[44:47]
v_mfma_f32_16x16x32_bf16 v[48:51], a[152:155], v[132:135], v[48:51]
v_mfma_f32_16x16x32_bf16 v[52:55], a[156:159], v[132:135], v[52:55]
s_waitcnt vmcnt(5)
v_mfma_f32_16x16x32_bf16 v[36:39], a[160:163], v[136:139], v[36:39]
buffer_load_dwordx4 v[64:67], v0, s[4:7], s51 offen offset:2048 sc1
v_mfma_f32_16x16x32_bf16 v[40:43], a[164:167], v[136:139], v[40:43]
v_mfma_f32_16x16x32_bf16 v[44:47], a[168:171], v[136:139], v[44:47]
v_mfma_f32_16x16x32_bf16 v[48:51], a[172:175], v[136:139], v[48:51]
v_mfma_f32_16x16x32_bf16 v[52:55], a[176:179], v[136:139], v[52:55]
s_waitcnt vmcnt(5)
v_mfma_f32_16x16x32_bf16 v[36:39], a[180:183], v[140:143], v[36:39]
buffer_load_dwordx4 v[68:71], v0, s[4:7], s51 offen offset:3072 sc1
v_mfma_f32_16x16x32_bf16 v[40:43], a[184:187], v[140:143], v[40:43]
s_add_u32 s51, s28, 5246976
v_mfma_f32_16x16x32_bf16 v[44:47], a[188:191], v[140:143], v[44:47]
v_mfma_f32_16x16x32_bf16 v[48:51], a[192:195], v[140:143], v[48:51]
v_mfma_f32_16x16x32_bf16 v[52:55], a[196:199], v[140:143], v[52:55]
s_waitcnt vmcnt(5)
v_mfma_f32_16x16x32_bf16 v[36:39], a[200:203], v[144:147], v[36:39]
buffer_load_dwordx4 v[72:75], v0, s[4:7], s51 offen offset:0 sc1
v_mfma_f32_16x16x32_bf16 v[40:43], a[204:207], v[144:147], v[40:43]
v_mfma_f32_16x16x32_bf16 v[44:47], a[208:211], v[144:147], v[44:47]
v_mfma_f32_16x16x32_bf16 v[48:51], a[212:215], v[144:147], v[48:51]
v_mfma_f32_16x16x32_bf16 v[52:55], a[216:219], v[144:147], v[52:55]
s_waitcnt vmcnt(5)
v_mfma_f32_16x16x32_bf16 v[36:39], a[220:223], v[148:151], v[36:39]
buffer_load_dwordx4 v[76:79], v0, s[4:7], s51 offen offset:1024 sc1
v_mfma_f32_16x16x32_bf16 v[40:43], a[224:227], v[148:151], v[40:43]
v_mfma_f32_16x16x32_bf16 v[44:47], a[228:231], v[148:151], v[44:47]
v_mfma_f32_16x16x32_bf16 v[48:51], a[232:235], v[148:151], v[48:51]
v_mfma_f32_16x16x32_bf16 v[52:55], a[236:239], v[148:151], v[52:55]
s_waitcnt vmcnt(5)
v_mfma_f32_16x16x32_bf16 v[16:19], a[0:3], v[56:59], 0
buffer_load_dwordx4 v[80:83], v0, s[4:7], s51 offen offset:2048 sc1
v_mfma_f32_16x16x32_bf16 v[20:23], a[4:7], v[56:59], 0
v_mfma_f32_16x16x32_bf16 v[24:27], a[8:11], v[56:59], 0
v_mfma_f32_16x16x32_bf16 v[28:31], a[12:15], v[56:59], 0
ds_write_b128 v229, v[36:39] offset:0
v_mfma_f32_16x16x32_bf16 v[32:35], a[16:19], v[56:59], 0
s_waitcnt vmcnt(5)
v_mfma_f32_16x16x32_bf16 v[16:19], a[20:23], v[60:63], v[16:19]
buffer_load_dwordx4 v[84:87], v0, s[4:7], s51 offen offset:3072 sc1
v_mfma_f32_16x16x32_bf16 v[20:23], a[24:27], v[60:63], v[20:23]
s_add_u32 s51, s28, 5251072
v_mfma_f32_16x16x32_bf16 v[24:27], a[28:31], v[60:63], v[24:27]
ds_write_b128 v229, v[40:43] offset:1024
v_mfma_f32_16x16x32_bf16 v[28:31], a[32:35], v[60:63], v[28:31]
ds_write_b128 v229, v[44:47] offset:2048
v_mfma_f32_16x16x32_bf16 v[32:35], a[36:39], v[60:63], v[32:35]
s_waitcnt vmcnt(5)
v_mfma_f32_16x16x32_bf16 v[16:19], a[40:43], v[64:67], v[16:19]
buffer_load_dwordx4 v[88:91], v0, s[4:7], s51 offen offset:0 sc1
v_mfma_f32_16x16x32_bf16 v[20:23], a[44:47], v[64:67], v[20:23]
ds_write_b128 v229, v[48:51] offset:3072
v_mfma_f32_16x16x32_bf16 v[24:27], a[48:51], v[64:67], v[24:27]
ds_write_b128 v229, v[52:55] offset:4096
v_mfma_f32_16x16x32_bf16 v[28:31], a[52:55], v[64:67], v[28:31]
v_lshlrev_b32 v36, 16, v246
v_and_b32 v37, 0xffff0000, v246
v_mfma_f32_16x16x32_bf16 v[32:35], a[56:59], v[64:67], v[32:35]
v_lshlrev_b32 v38, 16, v247
s_waitcnt vmcnt(5)
v_mfma_f32_16x16x32_bf16 v[16:19], a[60:63], v[68:71], v[16:19]
buffer_load_dwordx4 v[92:95], v0, s[4:7], s51 offen offset:1024 sc1
v_mfma_f32_16x16x32_bf16 v[20:23], a[64:67], v[68:71], v[20:23]
v_and_b32 v39, 0xffff0000, v247
v_lshlrev_b32 v40, 16, v248
v_mfma_f32_16x16x32_bf16 v[24:27], a[68:71], v[68:71], v[24:27]
v_and_b32 v41, 0xffff0000, v248
v_lshlrev_b32 v42, 16, v249
v_mfma_f32_16x16x32_bf16 v[28:31], a[72:75], v[68:71], v[28:31]
v_and_b32 v43, 0xffff0000, v249
v_lshlrev_b32 v44, 16, v250
v_mfma_f32_16x16x32_bf16 v[32:35], a[76:79], v[68:71], v[32:35]
v_and_b32 v45, 0xffff0000, v250
s_waitcnt vmcnt(5)
v_mfma_f32_16x16x32_bf16 v[16:19], a[80:83], v[72:75], v[16:19]
buffer_load_dwordx4 v[96:99], v0, s[4:7], s51 offen offset:2048 sc1
v_mfma_f32_16x16x32_bf16 v[20:23], a[84:87], v[72:75], v[20:23]
v_lshlrev_b32 v46, 16, v251
v_and_b32 v47, 0xffff0000, v251
v_mfma_f32_16x16x32_bf16 v[24:27], a[88:91], v[72:75], v[24:27]
v_lshlrev_b32 v48, 16, v252
v_and_b32 v49, 0xffff0000, v252
v_mfma_f32_16x16x32_bf16 v[28:31], a[92:95], v[72:75], v[28:31]
v_lshlrev_b32 v50, 16, v253
v_and_b32 v51, 0xffff0000, v253
v_mfma_f32_16x16x32_bf16 v[32:35], a[96:99], v[72:75], v[32:35]
v_lshlrev_b32 v52, 16, v254
s_waitcnt vmcnt(5)
v_mfma_f32_16x16x32_bf16 v[16:19], a[100:103], v[76:79], v[16:19]
buffer_load_dwordx4 v[100:103], v0, s[4:7], s51 offen offset:3072 sc1
v_mfma_f32_16x16x32_bf16 v[20:23], a[104:107], v[76:79], v[20:23]
s_add_u32 s51, s29, 5242880
v_and_b32 v53, 0xffff0000, v254
v_mfma_f32_16x16x32_bf16 v[24:27], a[108:111], v[76:79], v[24:27]
v_lshlrev_b32 v54, 16, v255
v_and_b32 v55, 0xffff0000, v255
v_mfma_f32_16x16x32_bf16 v[28:31], a[112:115], v[76:79], v[28:31]
v_mfma_f32_16x16x32_bf16 v[32:35], a[116:119], v[76:79], v[32:35]
s_waitcnt vmcnt(5)
v_mfma_f32_16x16x32_bf16 v[16:19], a[120:123], v[80:83], v[16:19]
buffer_load_dwordx4 v[104:107], v0, s[4:7], s51 offen offset:0 sc1
v_mfma_f32_16x16x32_bf16 v[20:23], a[124:127], v[80:83], v[20:23]
v_mfma_f32_16x16x32_bf16 v[24:27], a[128:131], v[80:83], v[24:27]
v_mfma_f32_16x16x32_bf16 v[28:31], a[132:135], v[80:83], v[28:31]
v_mfma_f32_16x16x32_bf16 v[32:35], a[136:139], v[80:83], v[32:35]
s_waitcnt vmcnt(5)
v_mfma_f32_16x16x32_bf16 v[16:19], a[140:143], v[84:87], v[16:19]
buffer_load_dwordx4 v[108:111], v0, s[4:7], s51 offen offset:1024 sc1
v_mfma_f32_16x16x32_bf16 v[20:23], a[144:147], v[84:87], v[20:23]
v_mfma_f32_16x16x32_bf16 v[24:27], a[148:151], v[84:87], v[24:27]
v_mfma_f32_16x16x32_bf16 v[28:31], a[152:155], v[84:87], v[28:31]
v_mfma_f32_16x16x32_bf16 v[32:35], a[156:159], v[84:87], v[32:35]
s_waitcnt vmcnt(5)
v_mfma_f32_16x16x32_bf16 v[16:19], a[160:163], v[88:91], v[16:19]
buffer_load_dwordx4 v[112:115], v0, s[4:7], s51 offen offset:2048 sc1
v_mfma_f32_16x16x32_bf16 v[20:23], a[164:167], v[88:91], v[20:23]
v_mfma_f32_16x16x32_bf16 v[24:27], a[168:171], v[88:91], v[24:27]
v_mfma_f32_16x16x32_bf16 v[28:31], a[172:175], v[88:91], v[28:31]
v_mfma_f32_16x16x32_bf16 v[32:35], a[176:179], v[88:91], v[32:35]
s_waitcnt vmcnt(5)
v_mfma_f32_16x16x32_bf16 v[16:19], a[180:183], v[92:95], v[16:19]
buffer_load_dwordx4 v[116:119], v0, s[4:7], s51 offen offset:3072 sc1
v_mfma_f32_16x16x32_bf16 v[20:23], a[184:187], v[92:95], v[20:23]
s_add_u32 s51, s29, 5246976
v_mfma_f32_16x16x32_bf16 v[24:27], a[188:191], v[92:95], v[24:27]
v_mfma_f32_16x16x32_bf16 v[28:31], a[192:195], v[92:95], v[28:31]
v_mfma_f32_16x16x32_bf16 v[32:35], a[196:199], v[92:95], v[32:35]
s_waitcnt vmcnt(5)
v_mfma_f32_16x16x32_bf16 v[16:19], a[200:203], v[96:99], v[16:19]
buffer_load_dwordx4 v[120:123], v0, s[4:7], s51 offen offset:0 sc1
v_mfma_f32_16x16x32_bf16 v[20:23], a[204:207], v[96:99], v[20:23]
v_mfma_f32_16x16x32_bf16 v[24:27], a[208:211], v[96:99], v[24:27]
v_mfma_f32_16x16x32_bf16 v[28:31], a[212:215], v[96:99], v[28:31]
v_mfma_f32_16x16x32_bf16 v[32:35], a[216:219], v[96:99], v[32:35]
s_waitcnt vmcnt(5)
v_mfma_f32_16x16x32_bf16 v[16:19], a[220:223], v[100:103], v[16:19]
buffer_load_dwordx4 v[124:127], v0, s[4:7], s51 offen offset:1024 sc1
v_mfma_f32_16x16x32_bf16 v[20:23], a[224:227], v[100:103], v[20:23]
v_mfma_f32_16x16x32_bf16 v[24:27], a[228:231], v[100:103], v[24:27]
v_mfma_f32_16x16x32_bf16 v[28:31], a[232:235], v[100:103], v[28:31]
v_mfma_f32_16x16x32_bf16 v[32:35], a[236:239], v[100:103], v[32:35]
s_waitcnt vmcnt(5)
v_mfma_f32_16x16x32_bf16 v[36:39], a[0:3], v[104:107], v[36:39]
buffer_load_dwordx4 v[128:131], v0, s[4:7], s51 offen offset:2048 sc1
v_mfma_f32_16x16x32_bf16 v[40:43], a[4:7], v[104:107], v[40:43]
v_mfma_f32_16x16x32_bf16 v[44:47], a[8:11], v[104:107], v[44:47]
v_mfma_f32_16x16x32_bf16 v[48:51], a[12:15], v[104:107], v[48:51]
ds_write_b128 v230, v[16:19] offset:0
v_mfma_f32_16x16x32_bf16 v[52:55], a[16:19], v[104:107], v[52:55]
s_waitcnt vmcnt(5)
v_mfma_f32_16x16x32_bf16 v[36:39], a[20:23], v[108:111], v[36:39]
buffer_load_dwordx4 v[132:135], v0, s[4:7], s51 offen offset:3072 sc1
v_mfma_f32_16x16x32_bf16 v[40:43], a[24:27], v[108:111], v[40:43]
s_add_u32 s51, s29, 5251072
v_mfma_f32_16x16x32_bf16 v[44:47], a[28:31], v[108:111], v[44:47]
ds_write_b128 v230, v[20:23] offset:1024
v_mfma_f32_16x16x32_bf16 v[48:51], a[32:35], v[108:111], v[48:51]
ds_write_b128 v230, v[24:27] offset:2048
v_mfma_f32_16x16x32_bf16 v[52:55], a[36:39], v[108:111], v[52:55]
s_waitcnt vmcnt(5)
v_mfma_f32_16x16x32_bf16 v[36:39], a[40:43], v[112:115], v[36:39]
buffer_load_dwordx4 v[136:139], v0, s[4:7], s51 offen offset:0 sc1
v_mfma_f32_16x16x32_bf16 v[40:43], a[44:47], v[112:115], v[40:43]
ds_write_b128 v230, v[28:31] offset:3072
v_mfma_f32_16x16x32_bf16 v[44:47], a[48:51], v[112:115], v[44:47]
ds_write_b128 v230, v[32:35] offset:4096
v_mfma_f32_16x16x32_bf16 v[48:51], a[52:55], v[112:115], v[48:51]
s_waitcnt lgkmcnt(0)
s_barrier
v_mfma_f32_16x16x32_bf16 v[52:55], a[56:59], v[112:115], v[52:55]
ds_read_b128 v[152:155], v231 offset:0
s_waitcnt vmcnt(5)
v_mfma_f32_16x16x32_bf16 v[36:39], a[60:63], v[116:119], v[36:39]
buffer_load_dwordx4 v[140:143], v0, s[4:7], s51 offen offset:1024 sc1
v_mfma_f32_16x16x32_bf16 v[40:43], a[64:67], v[116:119], v[40:43]
ds_read_b128 v[172:175], v231 offset:5120
ds_read_b128 v[192:195], v231 offset:10240
v_mfma_f32_16x16x32_bf16 v[44:47], a[68:71], v[116:119], v[44:47]
ds_read_b128 v[156:159], v231 offset:1024
ds_read_b128 v[176:179], v231 offset:6144
v_mfma_f32_16x16x32_bf16 v[48:51], a[72:75], v[116:119], v[48:51]
ds_read_b128 v[196:199], v231 offset:11264
ds_read_b128 v[160:163], v231 offset:2048
v_mfma_f32_16x16x32_bf16 v[52:55], a[76:79], v[116:119], v[52:55]
ds_read_b128 v[180:183], v231 offset:7168
s_waitcnt vmcnt(5)
v_mfma_f32_16x16x32_bf16 v[36:39], a[80:83], v[120:123], v[36:39]
buffer_load_dwordx4 v[144:147], v0, s[4:7], s51 offen offset:2048 sc1
v_mfma_f32_16x16x32_bf16 v[40:43], a[84:87], v[120:123], v[40:43]
ds_read_b128 v[200:203], v231 offset:12288
ds_read_b128 v[164:167], v231 offset:3072
v_mfma_f32_16x16x32_bf16 v[44:47], a[88:91], v[120:123], v[44:47]
ds_read_b128 v[184:187], v231 offset:8192
ds_read_b128 v[204:207], v231 offset:13312
v_mfma_f32_16x16x32_bf16 v[48:51], a[92:95], v[120:123], v[48:51]
ds_read_b128 v[168:171], v231 offset:4096
ds_read_b128 v[188:191], v231 offset:9216
v_mfma_f32_16x16x32_bf16 v[52:55], a[96:99], v[120:123], v[52:55]
ds_read_b128 v[208:211], v231 offset:14336
s_waitcnt vmcnt(5)
v_mfma_f32_16x16x32_bf16 v[36:39], a[100:103], v[124:127], v[36:39]
buffer_load_dwordx4 v[148:151], v0, s[4:7], s51 offen offset:3072 sc1
v_mfma_f32_16x16x32_bf16 v[40:43], a[104:107], v[124:127], v[40:43]
v_mfma_f32_16x16x32_bf16 v[44:47], a[108:111], v[124:127], v[44:47]
v_mfma_f32_16x16x32_bf16 v[48:51], a[112:115], v[124:127], v[48:51]
v_mfma_f32_16x16x32_bf16 v[52:55], a[116:119], v[124:127], v[52:55]
s_waitcnt vmcnt(5)
v_mfma_f32_16x16x32_bf16 v[36:39], a[120:123], v[128:131], v[36:39]
v_mfma_f32_16x16x32_bf16 v[40:43], a[124:127], v[128:131], v[40:43]
v_mfma_f32_16x16x32_bf16 v[44:47], a[128:131], v[128:131], v[44:47]
s_waitcnt lgkmcnt(13)
v_add_f32 v152, v152, v172
v_add_f32 v153, v153, v173
v_mfma_f32_16x16x32_bf16 v[48:51], a[132:135], v[128:131], v[48:51]
v_add_f32 v154, v154, v174
v_add_f32 v155, v155, v175
v_mfma_f32_16x16x32_bf16 v[52:55], a[136:139], v[128:131], v[52:55]
s_waitcnt lgkmcnt(10)
v_add_f32 v156, v156, v176
s_waitcnt vmcnt(4)
v_mfma_f32_16x16x32_bf16 v[36:39], a[140:143], v[132:135], v[36:39]
v_add_f32 v157, v157, v177
v_add_f32 v158, v158, v178
v_mfma_f32_16x16x32_bf16 v[40:43], a[144:147], v[132:135], v[40:43]
v_add_f32 v159, v159, v179
s_waitcnt lgkmcnt(7)
v_add_f32 v160, v160, v180
v_mfma_f32_16x16x32_bf16 v[44:47], a[148:151], v[132:135], v[44:47]
v_add_f32 v161, v161, v181
v_add_f32 v162, v162, v182
v_mfma_f32_16x16x32_bf16 v[48:51], a[152:155], v[132:135], v[48:51]
v_add_f32 v163, v163, v183
s_waitcnt lgkmcnt(4)
v_add_f32 v164, v164, v184
v_mfma_f32_16x16x32_bf16 v[52:55], a[156:159], v[132:135], v[52:55]
v_add_f32 v165, v165, v185
s_waitcnt vmcnt(3)
v_mfma_f32_16x16x32_bf16 v[36:39], a[160:163], v[136:139], v[36:39]
v_add_f32 v166, v166, v186
v_add_f32 v167, v167, v187
v_mfma_f32_16x16x32_bf16 v[40:43], a[164:167], v[136:139], v[40:43]
s_waitcnt lgkmcnt(1)
v_add_f32 v168, v168, v188
v_add_f32 v169, v169, v189
v_mfma_f32_16x16x32_bf16 v[44:47], a[168:171], v[136:139], v[44:47]
v_add_f32 v170, v170, v190
v_add_f32 v171, v171, v191
v_mfma_f32_16x16x32_bf16 v[48:51], a[172:175], v[136:139], v[48:51]
v_add_f32 v152, v152, v192
v_add_f32 v153, v153, v193
v_mfma_f32_16x16x32_bf16 v[52:55], a[176:179], v[136:139], v[52:55]
v_add_f32 v154, v154, v194
s_waitcnt vmcnt(2)
v_mfma_f32_16x16x32_bf16 v[36:39], a[180:183], v[140:143], v[36:39]
v_add_f32 v155, v155, v195
v_add_f32 v156, v156, v196
v_mfma_f32_16x16x32_bf16 v[40:43], a[184:187], v[140:143], v[40:43]
v_add_f32 v157, v157, v197
v_add_f32 v158, v158, v198
v_mfma_f32_16x16x32_bf16 v[44:47], a[188:191], v[140:143], v[44:47]
v_add_f32 v159, v159, v199
v_add_f32 v160, v160, v200
v_mfma_f32_16x16x32_bf16 v[48:51], a[192:195], v[140:143], v[48:51]
v_add_f32 v161, v161, v201
v_add_f32 v162, v162, v202
v_mfma_f32_16x16x32_bf16 v[52:55], a[196:199], v[140:143], v[52:55]
v_add_f32 v163, v163, v203
s_waitcnt vmcnt(1)
v_mfma_f32_16x16x32_bf16 v[36:39], a[200:203], v[144:147], v[36:39]
v_add_f32 v164, v164, v204
v_add_f32 v165, v165, v205
v_mfma_f32_16x16x32_bf16 v[40:43], a[204:207], v[144:147], v[40:43]
v_add_f32 v166, v166, v206
v_add_f32 v167, v167, v207
v_mfma_f32_16x16x32_bf16 v[44:47], a[208:211], v[144:147], v[44:47]
s_waitcnt lgkmcnt(0)
v_add_f32 v168, v168, v208
v_add_f32 v169, v169, v209
v_mfma_f32_16x16x32_bf16 v[48:51], a[212:215], v[144:147], v[48:51]
v_add_f32 v170, v170, v210
v_add_f32 v171, v171, v211
v_mfma_f32_16x16x32_bf16 v[52:55], a[216:219], v[144:147], v[52:55]
s_waitcnt vmcnt(0)
v_mfma_f32_16x16x32_bf16 v[36:39], a[220:223], v[148:151], v[36:39]
v_mfma_f32_16x16x32_bf16 v[40:43], a[224:227], v[148:151], v[40:43]
v_mfma_f32_16x16x32_bf16 v[44:47], a[228:231], v[148:151], v[44:47]
v_mfma_f32_16x16x32_bf16 v[48:51], a[232:235], v[148:151], v[48:51]
v_mfma_f32_16x16x32_bf16 v[52:55], a[236:239], v[148:151], v[52:55]
v_lshrrev_b32 v16, 8, v0
v_lshrrev_b32 v17, 2, v9
s_movk_i32 s48, 2560
v_and_b32 v18, 1, v16
v_lshlrev_b32 v18, 5, v18
v_lshrrev_b32 v19, 1, v16
v_lshl_add_u32 v18, v19, 4, v18
v_mad_u32_u24 v18, v17, s48, v18
v_lshlrev_b32 v16, 3, v16
v_mad_u32_u24 v16, v17, s48, v16
v_pk_add_f32 v[36:37], v[36:37], v[152:153]
v_pk_add_f32 v[38:39], v[38:39], v[154:155]
v_cvt_pk_bf16_f32 v246, v36, v37
v_cvt_pk_bf16_f32 v247, v38, v39
v_pk_add_f32 v[40:41], v[40:41], v[156:157]
v_pk_add_f32 v[42:43], v[42:43], v[158:159]
v_cvt_pk_bf16_f32 v248, v40, v41
v_cvt_pk_bf16_f32 v249, v42, v43
s_nop 0
v_permlane16_swap_b32 v246, v248
v_permlane16_swap_b32 v247, v249
buffer_store_dwordx4 v[246:249], v18, s[8:11], s46 offen offset:0
v_pk_add_f32 v[44:45], v[44:45], v[160:161]
v_pk_add_f32 v[46:47], v[46:47], v[162:163]
v_cvt_pk_bf16_f32 v250, v44, v45
v_cvt_pk_bf16_f32 v251, v46, v47
v_pk_add_f32 v[48:49], v[48:49], v[164:165]
v_pk_add_f32 v[50:51], v[50:51], v[166:167]
v_cvt_pk_bf16_f32 v252, v48, v49
v_cvt_pk_bf16_f32 v253, v50, v51
s_nop 0
v_permlane16_swap_b32 v250, v252
v_permlane16_swap_b32 v251, v253
buffer_store_dwordx4 v[250:253], v18, s[8:11], s46 offen offset:64
v_pk_add_f32 v[52:53], v[52:53], v[168:169]
v_pk_add_f32 v[54:55], v[54:55], v[170:171]
v_cvt_pk_bf16_f32 v254, v52, v53
v_cvt_pk_bf16_f32 v255, v54, v55
buffer_store_dwordx2 v[254:255], v16, s[8:11], s47 offen
s_endpgm
M_last:
.section .rodata,"a"
.p2align 6
.amdhsa_kernel interleave_layers__sliding_local_dilated__glu_gated_glu__prompt_kernel
  .amdhsa_next_free_vgpr 512
  .amdhsa_next_free_sgpr 102
  .amdhsa_accum_offset 256
  .amdhsa_group_segment_fixed_size 0
  .amdhsa_kernarg_size 80
  .amdhsa_user_sgpr_count 2
  .amdhsa_user_sgpr_kernarg_segment_ptr 1
  .amdhsa_system_sgpr_workgroup_id_x 1
  .amdhsa_float_denorm_mode_32 3
.end_amdhsa_kernel
```
